```python
import torch

def _softmax(x, axis=-1):
    return torch.softmax(x, dim=axis)
def _gelu(x):
    return torch.nn.functional.gelu(x, approximate="tanh")
def _silu(x):
    return torch.nn.functional.silu(x)
def _sigmoid(x):
    return torch.sigmoid(x)
def _layernorm(x, axis=-1, eps=1e-5):
    m = x.mean(dim=axis, keepdim=True)
    v = x.var(dim=axis, keepdim=True, unbiased=False)
    return (x - m) / torch.sqrt(v + eps)
def _scatter_add(tgt, idx, src, axis=0):
    return tgt.clone().index_add_(axis, idx, src)
def _segment_sum(src, seg, n):
    out = torch.zeros((n,) + src.shape[1:], dtype=src.dtype)
    return out.index_add_(0, seg, src)
def _pad(x, pw):
    flat = tuple(v for pair in reversed(pw) for v in pair)
    return torch.nn.functional.pad(x, flat)

kernel_name = 'interleave_layers__sliding_local_dilated__glu_gated_glu__prompt'

def setup_inputs():

    _w = (lambda a: (lambda t: t.to(torch.bfloat16) if t.is_floating_point() else t)(torch.as_tensor(a)))
    def _A_setup():
        B, S, D = 1, 2048, 512
        return {
            "x": _w((lambda *s: torch.randn(*s, dtype=torch.bfloat16) * 0.05)(B, S, D)),
            "wqkv": _w((lambda *s: torch.randn(*s, dtype=torch.bfloat16) * 0.05)(D, 3 * D)),
            "wo": _w((lambda *s: torch.randn(*s, dtype=torch.bfloat16) * 0.05)(D, D)),
        }
    _A_in = _A_setup()

    def _B_setup():
        B, S, D, F = 1, 2048, 512, 1376
        return {
            "x": _w((lambda *s: torch.randn(*s, dtype=torch.bfloat16) * 0.05)(B, S, D)),
            "w_gate": _w((lambda *s: torch.randn(*s, dtype=torch.bfloat16) * 0.05)(D, F)),
            "w_up": _w((lambda *s: torch.randn(*s, dtype=torch.bfloat16) * 0.05)(D, F)),
            "w_down": _w((lambda *s: torch.randn(*s, dtype=torch.bfloat16) * 0.05)(F, D)),
        }
    _B_in = _B_setup()

    return {
        "A_x": _A_in["x"],
        "A_wqkv": _A_in["wqkv"],
        "A_wo": _A_in["wo"],
        "B_x": _B_in["x"],
        "B_w_gate": _B_in["w_gate"],
        "B_w_up": _B_in["w_up"],
        "B_w_down": _B_in["w_down"],
    }

def reference(A_x, A_wqkv, A_wo, B_x, B_w_gate, B_w_up, B_w_down):
    def _A_ref(x, wqkv, wo):
        B, S, D = x.shape
        H = 32; Dh = D // H
        W, dil = 8, 2
        qkv = (lambda x, *d: x.permute(*d))((x @ wqkv).reshape(B, S, 3, H, Dh), 2, 0, 3, 1, 4)
        q, k, v = qkv[0], qkv[1], qkv[2]
        scale = Dh ** -0.5
        pos = torch.arange(S)
        off = torch.arange(W) * dil
        idx = pos[:, None] - off[None, :]
        mask = idx >= 0
        idx_c = torch.where(mask, idx, 0).reshape(-1)
        kg = k[:, :, idx_c, :].reshape(B, H, S, W, Dh)
        vg = v[:, :, idx_c, :].reshape(B, H, S, W, Dh)
        logits = torch.einsum("bhsd,bhswd->bhsw", q, kg) * scale
        logits = torch.where(mask[None, None, :, :], logits, -1e9)
        attn = _softmax(logits, axis=-1)
        o = torch.einsum("bhsw,bhswd->bhsd", attn, vg)
        return (lambda x, *d: x.permute(*d))(o, 0, 2, 1, 3).reshape(B, S, D) @ wo

    def _B_ref(x, w_gate, w_up, w_down):
        g = torch.einsum("bsd,df->bsf", x, w_gate)
        u = torch.einsum("bsd,df->bsf", x, w_up)
        h = _sigmoid(g) * u
        return torch.einsum("bsf,fd->bsd", h, w_down)

    x = A_x
    x = x + _A_ref(_layernorm(x, axis=-1), A_wqkv, A_wo)
    x = x + _B_ref(_layernorm(x, axis=-1), B_w_gate, B_w_up, B_w_down)
    x = x + _A_ref(_layernorm(x, axis=-1), A_wqkv, A_wo)
    x = x + _B_ref(_layernorm(x, axis=-1), B_w_gate, B_w_up, B_w_down)
    return x
```

```asm
; @launch grid=(256,1,1) block=(256,1,1) lds=163840
.amdgcn_target "amdgcn-amd-amdhsa--gfx950"
.text
.globl interleave_layers__sliding_local_dilated__glu_gated_glu__prompt_kernel
.p2align 8
.type interleave_layers__sliding_local_dilated__glu_gated_glu__prompt_kernel,@function
interleave_layers__sliding_local_dilated__glu_gated_glu__prompt_kernel:
  s_load_dwordx4 s[16:19], s[0:1], 0
  s_load_dwordx2 s[20:21], s[0:1], 16
  s_load_dwordx4 s[24:27], s[0:1], 32
  s_load_dwordx2 s[28:29], s[0:1], 48
  s_load_dwordx4 s[52:55], s[0:1], 56
  s_load_dwordx2 s[30:31], s[0:1], 72
  s_cmp_ge_u32 s2, 256
  s_cbranch_scc1 M_end
  v_lshrrev_b32 v2, 6, v0
  v_and_b32 v1, 63, v0
  v_readfirstlane_b32 s3, v2
  v_lshlrev_b32 v3, 4, v1
  s_lshl_b32 s4, s2, 2
  s_add_u32 s4, s4, s3
  s_lshl_b32 s5, s3, 12
  s_add_u32 s6, s5, 114688
  s_add_u32 s5, s5, 0
  v_and_b32 v4, 3, v1
  v_lshrrev_b32 v5, 2, v1
  v_and_b32 v5, 3, v5
  v_lshrrev_b32 v6, 4, v1
  v_lshl_add_u32 v7, v6, 3, v5
  v_mov_b32 v40, 0x3f803f80
  v_mov_b32 v41, 0x3f803f80
  v_mov_b32 v42, 0x3f803f80
  v_mov_b32 v43, 0x3f803f80
  v_lshlrev_b32 v62, 2, v1
  v_cmp_gt_u32 vcc, 16, v1
  v_mov_b32 v15, 0x7ffffff0
  s_nop 0
  v_cndmask_b32 v62, v15, v62, vcc
  s_waitcnt lgkmcnt(0)
  s_mov_b32 s8, s30
  s_and_b32 s9, s31, 0xffff
  s_mov_b32 s10, 0x10000000
  s_mov_b32 s11, 0x20000
  s_mov_b32 s15, 0x20000
  s_mov_b32 s35, 0x20000
  s_add_u32 s46, s30, 8241152
  s_addc_u32 s47, s31, 0
  s_load_dword s95, s[46:47], 0
  s_cmp_ge_u32 s4, 384
  s_cbranch_scc1 K_iX
  s_mul_hi_u32 s36, s4, 89478486
  s_mul_i32 s37, s36, 48
  s_sub_u32 s37, s4, s37
  s_mul_hi_u32 s38, s37, 1431655766
  s_mul_i32 s39, s38, 3
  s_sub_u32 s39, s37, s39
  s_mov_b32 s12, s18
  s_and_b32 s13, s19, 0xffff
  s_mov_b32 s14, 1572864
  s_lshl_b32 s41, s39, 10
  s_lshl_b32 s42, s36, 7
  s_add_u32 s41, s41, s42
  s_movk_i32 s43, 3072
  s_lshl_b32 s40, s38, 5
  v_lshrrev_b32 v8, 3, v1
  v_add_u32 v8, s40, v8
  v_mul_lo_u32 v8, v8, s43
  v_and_b32 v9, 7, v1
  v_lshl_add_u32 v8, v9, 4, v8
  v_add_u32 v8, s41, v8
  s_lshl_b32 s40, s43, 3
  s_mov_b32 m0, s5
  s_nop 0
  buffer_load_dwordx4 v8, s[12:15], 0 offen lds
  v_add_u32 v8, s40, v8
  s_add_u32 m0, m0, 1024
  s_nop 0
  buffer_load_dwordx4 v8, s[12:15], 0 offen lds
  v_add_u32 v8, s40, v8
  s_add_u32 m0, m0, 1024
  s_nop 0
  buffer_load_dwordx4 v8, s[12:15], 0 offen lds
  v_add_u32 v8, s40, v8
  s_add_u32 m0, m0, 1024
  s_nop 0
  buffer_load_dwordx4 v8, s[12:15], 0 offen lds
  v_lshlrev_b32 v16, 7, v7
  v_lshl_add_u32 v16, v4, 3, v16
  v_add_u32 v63, s5, v16
  s_mul_i32 s42, s36, 196608
  s_lshl_b32 s43, s37, 10
  s_add_u32 s42, s42, s43
  s_add_u32 s42, s42, 0
  s_waitcnt vmcnt(0) lgkmcnt(0)
  ds_read_b64_tr_b16 v[16:17], v63 offset:0
  ds_read_b64_tr_b16 v[18:19], v63 offset:512
  ds_read_b64_tr_b16 v[20:21], v63 offset:32
  ds_read_b64_tr_b16 v[22:23], v63 offset:544
  ds_read_b64_tr_b16 v[24:25], v63 offset:64
  ds_read_b64_tr_b16 v[26:27], v63 offset:576
  ds_read_b64_tr_b16 v[28:29], v63 offset:96
  ds_read_b64_tr_b16 v[30:31], v63 offset:608
  s_waitcnt lgkmcnt(6)
  buffer_store_dwordx4 v[16:19], v3, s[8:11], s42 offen sc1
  s_add_u32 s42, s42, 49152
  s_waitcnt lgkmcnt(4)
  buffer_store_dwordx4 v[20:23], v3, s[8:11], s42 offen sc1
  s_add_u32 s42, s42, 49152
  s_waitcnt lgkmcnt(2)
  buffer_store_dwordx4 v[24:27], v3, s[8:11], s42 offen sc1
  s_add_u32 s42, s42, 49152
  s_waitcnt lgkmcnt(0)
  buffer_store_dwordx4 v[28:31], v3, s[8:11], s42 offen sc1
  v_mfma_f32_16x16x32_bf16 v[44:47], v[40:43], v[16:19], 0
  v_mfma_f32_16x16x32_bf16 v[48:51], v[40:43], v[20:23], 0
  v_mfma_f32_16x16x32_bf16 v[52:55], v[40:43], v[24:27], 0
  v_mfma_f32_16x16x32_bf16 v[56:59], v[40:43], v[28:31], 0
  s_mul_i32 s42, s36, 12288
  s_lshl_b32 s43, s39, 10
  s_add_u32 s42, s42, s43
  s_lshl_b32 s43, s38, 6
  s_add_u32 s42, s42, s43
  s_add_u32 s42, s42, 7864320
  buffer_store_dword v44, v62, s[8:11], s42 offen sc1
  s_add_u32 s42, s42, 3072
  buffer_store_dword v48, v62, s[8:11], s42 offen sc1
  s_add_u32 s42, s42, 3072
  buffer_store_dword v52, v62, s[8:11], s42 offen sc1
  s_add_u32 s42, s42, 3072
  buffer_store_dword v56, v62, s[8:11], s42 offen sc1
  s_branch K_iG
K_iX:
  s_sub_u32 s46, s4, 384
  s_mov_b32 s12, s16
  s_and_b32 s13, s17, 0xffff
  s_mov_b32 s14, 2097152
  s_lshr_b32 s36, s46, 8
  s_lshr_b32 s37, s46, 2
  s_and_b32 s37, s37, 63
  s_and_b32 s38, s46, 3
  v_and_b32 v8, 15, v1
  s_lshl_b32 s41, s37, 4
  v_add_u32 v8, s41, v8
  v_lshlrev_b32 v8, 1, v8
  v_add_u32 v8, s36, v8
  v_lshlrev_b32 v8, 10, v8
  v_lshl_add_u32 v8, v6, 4, v8
  s_lshl_b32 s41, s38, 8
  v_add_u32 v8, s41, v8
  v_lshlrev_b32 v16, 2, v1
  v_mov_b32 v17, v3
  s_cmp_lt_u32 s46, 512
  s_cbranch_scc1 K_x1
  v_mov_b32 v8, 0x7ffff000
  v_mov_b32 v16, 0x7ffff000
  v_mov_b32 v17, 0x7ffff000
K_x1:
  buffer_load_dwordx4 v[64:67], v8, s[12:15], 0 offen offset:0
  buffer_load_dwordx4 v[68:71], v8, s[12:15], 0 offen offset:64
  buffer_load_dwordx4 v[72:75], v8, s[12:15], 0 offen offset:128
  buffer_load_dwordx4 v[76:79], v8, s[12:15], 0 offen offset:192
  s_lshl_b32 s40, s36, 20
  s_lshl_b32 s41, s37, 14
  s_add_u32 s40, s40, s41
  s_lshl_b32 s41, s38, 12
  s_add_u32 s40, s40, s41
  s_add_u32 s40, s40, 8388608
  s_lshl_b32 s42, s36, 17
  s_lshl_b32 s41, s37, 11
  s_add_u32 s42, s42, s41
  s_lshl_b32 s41, s38, 9
  s_add_u32 s42, s42, s41
  s_add_u32 s42, s42, 16777216
  s_waitcnt vmcnt(0) lgkmcnt(0)
  buffer_store_dwordx4 v[64:67], v17, s[8:11], s40 offen offset:0 sc1
  buffer_store_dwordx4 v[68:71], v17, s[8:11], s40 offen offset:1024 sc1
  buffer_store_dwordx4 v[72:75], v17, s[8:11], s40 offen offset:2048 sc1
  buffer_store_dwordx4 v[76:79], v17, s[8:11], s40 offen offset:3072 sc1
  v_mov_b32 v44, 0
  v_mov_b32 v45, 0
  v_dot2c_f32_bf16 v44, v64, v40
  v_dot2c_f32_bf16 v45, v64, v64
  v_dot2c_f32_bf16 v44, v65, v40
  v_dot2c_f32_bf16 v45, v65, v65
  v_dot2c_f32_bf16 v44, v66, v40
  v_dot2c_f32_bf16 v45, v66, v66
  v_dot2c_f32_bf16 v44, v67, v40
  v_dot2c_f32_bf16 v45, v67, v67
  v_mov_b32 v46, 0
  v_mov_b32 v47, 0
  v_dot2c_f32_bf16 v46, v68, v40
  v_dot2c_f32_bf16 v47, v68, v68
  v_dot2c_f32_bf16 v46, v69, v40
  v_dot2c_f32_bf16 v47, v69, v69
  v_dot2c_f32_bf16 v46, v70, v40
  v_dot2c_f32_bf16 v47, v70, v70
  v_dot2c_f32_bf16 v46, v71, v40
  v_dot2c_f32_bf16 v47, v71, v71
  v_mov_b32 v48, 0
  v_mov_b32 v49, 0
  v_dot2c_f32_bf16 v48, v72, v40
  v_dot2c_f32_bf16 v49, v72, v72
  v_dot2c_f32_bf16 v48, v73, v40
  v_dot2c_f32_bf16 v49, v73, v73
  v_dot2c_f32_bf16 v48, v74, v40
  v_dot2c_f32_bf16 v49, v74, v74
  v_dot2c_f32_bf16 v48, v75, v40
  v_dot2c_f32_bf16 v49, v75, v75
  v_mov_b32 v50, 0
  v_mov_b32 v51, 0
  v_dot2c_f32_bf16 v50, v76, v40
  v_dot2c_f32_bf16 v51, v76, v76
  v_dot2c_f32_bf16 v50, v77, v40
  v_dot2c_f32_bf16 v51, v77, v77
  v_dot2c_f32_bf16 v50, v78, v40
  v_dot2c_f32_bf16 v51, v78, v78
  v_dot2c_f32_bf16 v50, v79, v40
  v_dot2c_f32_bf16 v51, v79, v79
  v_permlane16_swap_b32 v44, v45
  v_add_f32 v44, v44, v45
  v_mov_b32 v45, v44
  s_nop 1
  v_permlane32_swap_b32 v44, v45
  v_add_f32 v44, v44, v45
  v_permlane16_swap_b32 v46, v47
  v_add_f32 v46, v46, v47
  v_mov_b32 v47, v46
  s_nop 1
  v_permlane32_swap_b32 v46, v47
  v_add_f32 v46, v46, v47
  v_permlane16_swap_b32 v48, v49
  v_add_f32 v48, v48, v49
  v_mov_b32 v49, v48
  s_nop 1
  v_permlane32_swap_b32 v48, v49
  v_add_f32 v48, v48, v49
  v_permlane16_swap_b32 v50, v51
  v_add_f32 v50, v50, v51
  v_mov_b32 v51, v50
  s_nop 1
  v_permlane32_swap_b32 v50, v51
  v_add_f32 v50, v50, v51
  s_mov_b32 exec_hi, 0
  buffer_store_dword v44, v16, s[8:11], s42 offen offset:0 sc1
  buffer_store_dword v46, v16, s[8:11], s42 offen offset:128 sc1
  buffer_store_dword v48, v16, s[8:11], s42 offen offset:256 sc1
  buffer_store_dword v50, v16, s[8:11], s42 offen offset:384 sc1
  s_mov_b32 exec_hi, -1
K_iG:
  s_getpc_b64 s[56:57]
M_pc:
  s_lshl_b32 s58, s3, 13
  v_lshlrev_b32 v128, 7, v1
  v_add_u32 v128, s58, v128
  v_min_u32 v129, M_last-M_pc, v128
  global_load_dword v134, v129, s[56:57]
  v_add_u32 v128, 0x8000, v128
  v_min_u32 v129, M_last-M_pc, v128
  global_load_dword v135, v129, s[56:57]
  s_add_u32 s61, s95, 1
  v_mov_b32 v61, s61
  v_cmp_eq_u32 vcc, 0, v0
  v_mov_b32 v60, 0x7ffffff0
  s_nop 0
  v_cndmask_b32 v60, v60, 0, vcc
  s_lshr_b32 s46, s2, 3
  s_lshl_b32 s46, s46, 7
  s_and_b32 s47, s2, 7
  s_lshl_b32 s47, s47, 2
  s_add_u32 s46, s46, s47
  s_add_u32 s59, s46, 8224768
  s_getreg_b32 s46, hwreg(HW_REG_XCC_ID, 0, 4)
  s_lshl_b32 s47, s61, 4
  s_or_b32 s46, s46, s47
  s_and_b32 s47, s2, 7
  s_lshl_b32 s47, s47, 7
  s_lshr_b32 s44, s2, 3
  s_lshl_b32 s44, s44, 2
  s_add_u32 s47, s47, s44
  s_add_u32 s47, s47, 8232960
  s_sub_u32 s47, s47, s59
  v_cmp_eq_u32 vcc, 1, v0
  v_mov_b32 v62, s47
  v_mov_b32 v63, s46
  v_cndmask_b32 v60, v60, v62, vcc
  v_cndmask_b32 v61, v61, v63, vcc
  s_waitcnt vmcnt(2)
  s_barrier
  buffer_store_dword v61, v60, s[8:11], s59 offen sc1
  s_lshr_b32 s48, s2, 4
  s_and_b32 s50, s2, 15
  s_mul_i32 s40, s48, 96
  s_and_b32 s41, s3, 1
  s_mul_i32 s41, s41, 192
  s_cmp_ge_u32 s3, 2
  s_cselect_b32 s32, s26, s24
  s_cselect_b32 s33, s27, s25
  s_and_b32 s33, s33, 0xffff
  s_mov_b32 s34, 1409024
  s_mul_i32 s43, s3, 3072
  s_add_u32 s43, s43, 49152
  v_add_u32 v8, s41, v1
  v_add_u32 v8, 0, v8
  v_mul_u32_u24 v9, 5462, v8
  v_lshrrev_b32 v9, 16, v9
  v_mul_u32_u24 v12, 12, v9
  v_sub_u32 v12, v8, v12
  s_lshl_b32 s42, s50, 5
  v_add_u32 v13, s42, v9
  v_mul_u32_u24 v13, 2752, v13
  v_lshlrev_b32 v14, 3, v12
  v_add_u32 v14, s40, v14
  v_lshl_add_u32 v13, v14, 1, v13
  v_cmp_gt_u32 vcc, 1376, v14
  v_mov_b32 v15, 0x7ffffff0
  s_nop 0
  v_cndmask_b32 v13, v15, v13, vcc
  s_add_u32 m0, s43, 0
  s_nop 0
  buffer_load_dwordx4 v13, s[32:35], 0 offen lds
  v_add_u32 v8, s41, v1
  v_add_u32 v8, 64, v8
  v_mul_u32_u24 v9, 5462, v8
  v_lshrrev_b32 v9, 16, v9
  v_mul_u32_u24 v12, 12, v9
  v_sub_u32 v12, v8, v12
  s_lshl_b32 s42, s50, 5
  v_add_u32 v13, s42, v9
  v_mul_u32_u24 v13, 2752, v13
  v_lshlrev_b32 v14, 3, v12
  v_add_u32 v14, s40, v14
  v_lshl_add_u32 v13, v14, 1, v13
  v_cmp_gt_u32 vcc, 1376, v14
  v_mov_b32 v15, 0x7ffffff0
  s_nop 0
  v_cndmask_b32 v13, v15, v13, vcc
  s_add_u32 m0, s43, 1024
  s_nop 0
  buffer_load_dwordx4 v13, s[32:35], 0 offen lds
  v_add_u32 v8, s41, v1
  v_add_u32 v8, 128, v8
  v_mul_u32_u24 v9, 5462, v8
  v_lshrrev_b32 v9, 16, v9
  v_mul_u32_u24 v12, 12, v9
  v_sub_u32 v12, v8, v12
  s_lshl_b32 s42, s50, 5
  v_add_u32 v13, s42, v9
  v_mul_u32_u24 v13, 2752, v13
  v_lshlrev_b32 v14, 3, v12
  v_add_u32 v14, s40, v14
  v_lshl_add_u32 v13, v14, 1, v13
  v_cmp_gt_u32 vcc, 1376, v14
  v_mov_b32 v15, 0x7ffffff0
  s_nop 0
  v_cndmask_b32 v13, v15, v13, vcc
  s_add_u32 m0, s43, 2048
  s_nop 0
  buffer_load_dwordx4 v13, s[32:35], 0 offen lds
  s_mov_b32 s12, s20
  s_mov_b32 s13, s21
  s_mov_b32 s14, 0
  s_mov_b32 s52, 0
  s_mov_b32 s53, 0
  s_cmp_lt_u32 s4, 544
  s_cbranch_scc1 K_iR
  s_sub_u32 s46, s4, 544
  s_cmp_ge_u32 s46, 128
  s_cbranch_scc1 K_iD
  s_lshr_b32 s52, s46, 4
  s_and_b32 s53, s46, 15
  s_mov_b32 s14, 524288
  s_branch K_iR
K_iD:
  s_sub_u32 s46, s46, 128
  s_mul_hi_u32 s52, s46, 97612894
  s_mul_i32 s47, s52, 44
  s_sub_u32 s53, s46, s47
  s_mov_b32 s12, s28
  s_mov_b32 s13, s29
  s_mov_b32 s14, 1409024
K_iR:
  s_and_b32 s13, s13, 0xffff
  s_lshl_b32 s41, s52, 7
  s_movk_i32 s43, 1024
  s_lshl_b32 s40, s53, 5
  v_lshrrev_b32 v8, 3, v1
  v_add_u32 v8, s40, v8
  v_mul_lo_u32 v8, v8, s43
  v_and_b32 v9, 7, v1
  v_lshl_add_u32 v8, v9, 4, v8
  v_add_u32 v8, s41, v8
  s_lshl_b32 s40, s43, 3
  s_mov_b32 m0, s6
  s_nop 0
  buffer_load_dwordx4 v8, s[12:15], 0 offen lds
  v_add_u32 v8, s40, v8
  s_add_u32 m0, m0, 1024
  s_nop 0
  buffer_load_dwordx4 v8, s[12:15], 0 offen lds
  v_add_u32 v8, s40, v8
  s_add_u32 m0, m0, 1024
  s_nop 0
  buffer_load_dwordx4 v8, s[12:15], 0 offen lds
  v_add_u32 v8, s40, v8
  s_add_u32 m0, m0, 1024
  s_nop 0
  buffer_load_dwordx4 v8, s[12:15], 0 offen lds
K_done:
  s_nop 7
  s_load_dwordx2 s[4:5], s[0:1], 72
  s_load_dwordx2 s[6:7], s[0:1], 56
  v_lshrrev_b32 v20, 6, v0
  v_and_b32 v1, 63, v0
  v_readfirstlane_b32 s16, v20
  v_lshlrev_b32 v2, 4, v1
  s_and_b32 s32, s2, 7
  s_lshr_b32 s33, s2, 3
  s_lshr_b32 s34, s32, 1
  s_and_b32 s35, s32, 1
  s_lshl_b32 s17, s32, 2
  s_lshr_b32 s36, s33, 3
  s_add_u32 s17, s17, s36
  s_and_b32 s18, s33, 7
  s_lshl_b32 s19, s32, 1
  s_lshr_b32 s36, s33, 4
  s_add_u32 s19, s19, s36
  s_and_b32 s20, s33, 15
  s_waitcnt lgkmcnt(0)
  s_mov_b32 s8, s4
  s_and_b32 s9, s5, 0xffff
  s_mov_b32 s10, 0x10000000
  s_mov_b32 s11, 0x20000
  s_mov_b32 s12, s6
  s_and_b32 s13, s7, 0xffff
  s_mov_b32 s14, 0x200000
  s_mov_b32 s15, 0x20000
  s_lshl_b32 s36, s18, 2
  s_add_u32 s36, s36, s16
  s_mul_i32 s41, s36, 49152
  s_add_u32 s41, s41, 0
  s_lshl_b32 s42, s36, 14
  s_add_u32 s42, s42, 2097152
  s_mul_i32 s44, s36, 45056
  s_add_u32 s44, s44, 6291456
  s_lshl_b32 s37, s20, 2
  s_add_u32 s37, s37, s16
  s_mul_i32 s43, s37, 49152
  s_add_u32 s43, s43, 3145728
  s_lshl_b32 s24, s16, 12
  s_lshl_b32 s22, s17, 15
  s_lshl_b32 s23, s19, 16
  s_sub_u32 s21, s22, 16384
  s_max_i32 s21, s21, 0
  s_lshl_b32 s38, s17, 1
  s_add_u32 s38, s38, s16
  s_sub_u32 s38, s38, 1
  s_max_i32 s38, s38, 0
  s_lshl_b32 s25, s38, 11
  s_lshl_b32 s38, s19, 2
  s_add_u32 s38, s38, s16
  s_lshl_b32 s26, s38, 11
  s_lshr_b32 s38, s16, 1
  s_and_b32 s39, s16, 1
  s_lshl_b32 s40, s18, 1
  s_add_u32 s59, s40, s38
  s_lshl_b32 s59, s59, 10
  s_lshl_b32 s60, s39, 9
  s_add_u32 s59, s59, s60
  s_add_u32 s45, s59, s22
  s_lshl_b32 s59, s38, 14
  s_add_u32 s59, s59, s22
  s_add_u32 s46, s59, s24
  s_add_u32 s60, s40, s39
  s_lshl_b32 s61, s60, 10
  s_add_u32 s47, s59, s61
  s_lshr_b32 s57, s59, 3
  s_lshl_b32 s61, s60, 7
  s_add_u32 s57, s57, s61
  s_lshl_b32 s59, s17, 1
  s_add_u32 s59, s59, s38
  s_lshl_b32 s56, s59, 15
  s_lshl_b32 s61, s60, 6
  s_add_u32 s56, s56, s61
  s_mul_i32 s48, s19, 196608
  s_mul_i32 s61, s20, 12
  s_mul_i32 s62, s16, 3
  s_add_u32 s61, s61, s62
  s_lshl_b32 s61, s61, 8
  s_add_u32 s48, s48, s61
  s_mul_i32 s62, s16, 11264
  s_mul_i32 s64, s59, 49152
  s_add_u32 s64, s64, s62
  s_xor_b32 s59, s59, 1
  s_mul_i32 s65, s59, 49152
  s_add_u32 s65, s65, s62
  s_lshl_b32 s27, s16, 10
  s_add_u32 s63, s21, s27
  s_add_u32 s66, s22, s27
  s_add_u32 s67, s23, s27
  s_lshl_b32 s59, s18, 2
  s_lshl_b32 s60, s17, 8
  s_add_u32 s50, s60, s59
  s_lshl_b32 s59, s20, 2
  s_lshl_b32 s61, s19, 8
  s_add_u32 s51, s61, s59
  s_mov_b32 s52, s60
  s_lshl_b32 s53, s19, 9
  s_lshr_b32 s61, s17, 1
  s_lshl_b32 s54, s61, 8
  s_cmp_eq_u32 s17, 0
  s_cselect_b32 s61, 0, 256
  s_sub_u32 s55, s60, s61
  v_lshrrev_b32 v20, 3, v1
  v_mul_lo_u32 v20, v20, s61
  v_and_b32 v21, 7, v1
  v_lshl_add_u32 v0, v21, 2, v20
  s_cmp_eq_u32 s16, 1
  s_cselect_b32 s28, 0xff, 0
  s_mov_b32 s29, 0
  s_cselect_b32 s30, 0x7fff, 0
  s_mov_b32 s31, 0
  s_cselect_b32 s100, 0xffff, 0
  s_mov_b32 s101, 0
  s_mov_b32 s36, 0xffff0000
  s_mov_b32 s37, 0xffff0000
  s_mov_b32 s38, 1.0
  s_mov_b32 s39, 1.0
  s_mov_b32 s96, 0x3b000000
  s_mov_b32 s97, 0x3727c5ac
  s_mov_b32 s98, 0x3eb8aa3b
  s_mov_b32 s99, 0xbfb8aa3b
  v_and_b32 v20, 15, v1
  v_lshrrev_b32 v21, 4, v1
  v_add_u32 v3, 65536, v2
  v_lshlrev_b32 v22, 4, v20
  v_and_b32 v23, 1, v21
  v_lshrrev_b32 v24, 1, v21
  v_lshl_add_u32 v25, v24, 8, v22
  v_lshl_add_u32 v4, v23, 14, v25
  v_mul_u32_u24 v26, 49152, v23
  v_add_u32 v5, v26, v25
  v_mul_u32_u24 v26, 49152, v21
  v_add_u32 v26, v26, v22
  v_add_u32 v6, 512, v26
  s_lshl_b32 s59, s16, 13
  s_add_u32 s59, s59, 65536
  v_add_u32 v7, s59, v2
  v_lshrrev_b32 v26, 3, v1
  v_and_b32 v27, 7, v1
  v_lshlrev_b32 v27, 2, v27
  v_lshl_add_u32 v8, v26, 8, v27
  v_lshlrev_b32 v9, 2, v1
  s_cmp_eq_u32 s16, 1
  s_cselect_b32 s59, 16, 0
  v_cmp_gt_u32 vcc, s59, v1
  v_mov_b32 v27, 0x7ffffff0
  s_nop 0
  v_cndmask_b32 v8, v27, v8, vcc
  v_cndmask_b32 v9, v27, v9, vcc
  v_cndmask_b32 v0, v27, v0, vcc
  v_lshlrev_b32 v10, 7, v1
  v_cmp_gt_u32 vcc, 16, v1
  s_nop 1
  v_cndmask_b32 v10, v27, v10, vcc
  v_mov_b32 v18, 1
  s_lshl_b32 s59, s16, 11
  s_add_u32 s59, s59, 131072
  v_lshlrev_b32 v26, 10, v24
  v_lshl_add_u32 v26, v23, 6, v26
  v_lshl_add_u32 v26, v20, 2, v26
  v_add_u32 v11, s59, v26
  s_lshl_b32 s59, s16, 7
  s_lshl_b32 s60, s16, 6
  v_lshlrev_b32 v26, 3, v20
  v_lshl_add_u32 v26, v23, 2, v26
  v_add_u32 v26, s59, v26
  v_lshlrev_b32 v27, 2, v20
  v_lshl_add_u32 v27, v23, 8, v27
  v_add_u32 v27, s60, v27
  v_add_u32 v27, 512, v27
  v_cmp_gt_u32 vcc, 2, v21
  s_nop 1
  v_cndmask_b32 v26, v27, v26, vcc
  v_add_u32 v12, 147456, v26
  v_lshlrev_b32 v26, 3, v20
  v_add_u32 v13, 147456, v26
  v_lshlrev_b32 v26, 4, v21
  v_add_u32 v14, 147968, v26
  s_mul_i32 s59, s16, 192
  s_add_u32 s59, s59, 149504
  v_add_u32 v15, s59, v26
  v_lshlrev_b32 v27, 2, v20
  v_add_u32 v27, s59, v27
  v_add_u32 v16, 128, v27
  v_lshlrev_b32 v26, 2, v21
  v_sub_u32 v26, v20, v26
  v_mov_b32 v27, 0xf149f2ca
  v_mov_b32 v28, 0
  v_subrev_u32 v29, 0, v26
  v_cmp_gt_u32 vcc, 8, v29
  s_nop 1
  v_cndmask_b32 v32, v27, v28, vcc
  v_cmp_gt_i32 vcc, -8, v29
  s_nop 1
  v_cndmask_b32 v36, v27, v28, vcc
  v_mov_b32 v40, v27
  v_subrev_u32 v29, 1, v26
  v_cmp_gt_u32 vcc, 8, v29
  s_nop 1
  v_cndmask_b32 v33, v27, v28, vcc
  v_cmp_gt_i32 vcc, -8, v29
  s_nop 1
  v_cndmask_b32 v37, v27, v28, vcc
  v_mov_b32 v41, v27
  v_subrev_u32 v29, 2, v26
  v_cmp_gt_u32 vcc, 8, v29
  s_nop 1
  v_cndmask_b32 v34, v27, v28, vcc
  v_cmp_gt_i32 vcc, -8, v29
  s_nop 1
  v_cndmask_b32 v38, v27, v28, vcc
  v_mov_b32 v42, v27
  v_subrev_u32 v29, 3, v26
  v_cmp_gt_u32 vcc, 8, v29
  s_nop 1
  v_cndmask_b32 v35, v27, v28, vcc
  v_cmp_gt_i32 vcc, -8, v29
  s_nop 1
  v_cndmask_b32 v39, v27, v28, vcc
  v_mov_b32 v43, v27
  v_add_u32 v30, 151552, v2
  ds_write_b128 v30, v[32:35]
  ds_write_b128 v30, v[36:39] offset:1024
  ds_write_b128 v30, v[40:43] offset:2048
  s_cmp_eq_u32 s17, 0
  s_cselect_b32 s59, 2, 1
  s_lshl_b32 s59, s59, 10
  v_add_u32 v17, s59, v30
  s_add_u32 s61, s95, 1
  v_mov_b32 v18, s61
  s_cmp_eq_u32 s16, 0
  s_cselect_b32 s59, 1, 0
  v_cmp_gt_u32 vcc, s59, v1
  v_mov_b32 v27, 0x7ffffff0
  s_nop 0
  v_cndmask_b32 v87, v27, 0, vcc
  v_mov_b32 v60, v87
  s_mul_i32 s58, s18, 12
  v_add_u32 v89, s58, v1
  v_subrev_u32 v90, 12, v1
  v_mul_u32_u24 v91, 21846, v90
  v_lshrrev_b32 v91, 16, v91
  v_mul_u32_u24 v92, 3, v91
  v_sub_u32 v92, v90, v92
  s_lshl_b32 s58, s17, 1
  v_add_u32 v92, s58, v92
  v_subrev_u32 v92, 1, v92
  v_max_i32 v92, 0, v92
  v_lshl_add_u32 v92, v91, 6, v92
  v_add_u32 v92, 96, v92
  v_cmp_gt_u32 vcc, 12, v1
  s_nop 1
  v_cndmask_b32 v89, v92, v89, vcc
  v_lshrrev_b32 v90, 3, v89
  v_and_b32 v89, 7, v89
  v_lshlrev_b32 v89, 2, v89
  v_lshl_add_u32 v89, v90, 7, v89
  s_cmp_eq_u32 s16, 1
  s_cselect_b32 s58, 18, 0
  v_cmp_gt_u32 vcc, s58, v1
  v_mov_b32 v90, 0x7ffffff0
  s_nop 0
  v_cndmask_b32 v89, v90, v89, vcc
  s_cselect_b32 s4, 0x3ffff, 0
  s_mov_b32 s5, 0
  s_mov_b32 s35, 8224768
  buffer_load_dword v92, v89, s[8:11], s35 offen sc1
  s_waitcnt vmcnt(0)
  v_cmp_ne_u32 vcc, s61, v92
  s_nop 0
  s_and_b64 vcc, vcc, s[4:5]
  s_cbranch_vccnz SLOW_0
BACK_0:
  s_barrier
  v_and_b32 v68, 15, v1
  v_lshlrev_b32 v68, 2, v68
  v_lshrrev_b32 v69, 4, v1
  v_lshl_add_u32 v68, v69, 8, v68
  s_add_u32 m0, s27, 0
  s_add_u32 s32, s63, 8388608
  buffer_load_dwordx4 v2, s[8:11], s32 offen sc1 lds
  s_add_u32 m0, s27, 16384
  s_add_u32 s32, s66, 8388608
  buffer_load_dwordx4 v2, s[8:11], s32 offen sc1 lds
  s_add_u32 m0, s27, 32768
  s_add_u32 s32, s66, 8404992
  buffer_load_dwordx4 v2, s[8:11], s32 offen sc1 lds
  s_lshl_b32 s33, s16, 11
  s_add_u32 m0, s33, 131072
  s_add_u32 s32, s25, 16777216
  buffer_load_dwordx4 v2, s[8:11], s32 offen offset:0 sc1 lds
  s_lshl_b32 s33, s16, 11
  s_add_u32 m0, s33, 131072
  s_add_u32 s32, s25, 16777216
  buffer_load_dwordx4 v2, s[8:11], s32 offen offset:1024 sc1 lds
  s_add_u32 m0, s27, 4096
  s_add_u32 s32, s63, 8392704
  buffer_load_dwordx4 v2, s[8:11], s32 offen sc1 lds
  s_add_u32 m0, s27, 20480
  s_add_u32 s32, s66, 8392704
  buffer_load_dwordx4 v2, s[8:11], s32 offen sc1 lds
  s_add_u32 m0, s27, 36864
  s_add_u32 s32, s66, 8409088
  buffer_load_dwordx4 v2, s[8:11], s32 offen sc1 lds
  s_lshl_b32 s58, s18, 2
  s_add_u32 s58, s58, s16
  s_mul_i32 s59, s58, 3072
  s_add_u32 s59, s59, 7864320
  buffer_load_dword v120, v68, s[8:11], s59 offen offset:0
  buffer_load_dword v121, v68, s[8:11], s59 offen offset:64
  buffer_load_dword v122, v68, s[8:11], s59 offen offset:128
  buffer_load_dword v123, v68, s[8:11], s59 offen offset:192
  buffer_load_dword v124, v68, s[8:11], s59 offen offset:1024
  buffer_load_dword v125, v68, s[8:11], s59 offen offset:1088
  buffer_load_dword v126, v68, s[8:11], s59 offen offset:1152
  buffer_load_dword v127, v68, s[8:11], s59 offen offset:1216
  buffer_load_dword v128, v68, s[8:11], s59 offen offset:2048
  buffer_load_dword v129, v68, s[8:11], s59 offen offset:2112
  buffer_load_dword v130, v68, s[8:11], s59 offen offset:2176
  buffer_load_dword v131, v68, s[8:11], s59 offen offset:2240
  s_add_u32 s49, s41, 0
  buffer_load_dwordx4 a[0:3], v2, s[8:11], s49 offen offset:0
  buffer_load_dwordx4 a[4:7], v2, s[8:11], s49 offen offset:1024
  buffer_load_dwordx4 a[8:11], v2, s[8:11], s49 offen offset:2048
  buffer_load_dwordx4 a[12:15], v2, s[8:11], s49 offen offset:3072
  s_add_u32 s49, s41, 4096
  buffer_load_dwordx4 a[16:19], v2, s[8:11], s49 offen offset:0
  buffer_load_dwordx4 a[20:23], v2, s[8:11], s49 offen offset:1024
  buffer_load_dwordx4 a[24:27], v2, s[8:11], s49 offen offset:2048
  buffer_load_dwordx4 a[28:31], v2, s[8:11], s49 offen offset:3072
  s_add_u32 s49, s41, 8192
  buffer_load_dwordx4 a[32:35], v2, s[8:11], s49 offen offset:0
  buffer_load_dwordx4 a[36:39], v2, s[8:11], s49 offen offset:1024
  buffer_load_dwordx4 a[40:43], v2, s[8:11], s49 offen offset:2048
  buffer_load_dwordx4 a[44:47], v2, s[8:11], s49 offen offset:3072
  s_add_u32 s49, s41, 12288
  buffer_load_dwordx4 a[48:51], v2, s[8:11], s49 offen offset:0
  buffer_load_dwordx4 a[52:55], v2, s[8:11], s49 offen offset:1024
  buffer_load_dwordx4 a[56:59], v2, s[8:11], s49 offen offset:2048
  buffer_load_dwordx4 a[60:63], v2, s[8:11], s49 offen offset:3072
  s_add_u32 s49, s41, 16384
  buffer_load_dwordx4 a[64:67], v2, s[8:11], s49 offen offset:0
  buffer_load_dwordx4 a[68:71], v2, s[8:11], s49 offen offset:1024
  buffer_load_dwordx4 a[72:75], v2, s[8:11], s49 offen offset:2048
  buffer_load_dwordx4 a[76:79], v2, s[8:11], s49 offen offset:3072
  s_add_u32 s49, s41, 20480
  buffer_load_dwordx4 a[80:83], v2, s[8:11], s49 offen offset:0
  buffer_load_dwordx4 a[84:87], v2, s[8:11], s49 offen offset:1024
  buffer_load_dwordx4 a[88:91], v2, s[8:11], s49 offen offset:2048
  buffer_load_dwordx4 a[92:95], v2, s[8:11], s49 offen offset:3072
  v_lshrrev_b32 v144, 4, v2
  v_and_b32 v145, 3, v144
  v_lshrrev_b32 v146, 2, v144
  v_and_b32 v146, 3, v146
  v_lshrrev_b32 v147, 4, v144
  v_lshl_add_u32 v148, v147, 3, v146
  v_mul_u32_u24 v151, 192, v148
  s_mul_i32 s3, s16, 48
  s_add_u32 s3, s3, 49152
  v_add_u32 v151, s3, v151
  v_lshl_add_u32 v152, v145, 3, v151
  v_and_b32 v153, 1, v145
  v_mul_u32_u24 v153, 6144, v153
  v_lshrrev_b32 v154, 1, v145
  v_lshl_add_u32 v153, v154, 3, v153
  v_add_u32 v153, v153, v151
  ds_read_b64_tr_b16 v[176:177], v152 offset:0
  ds_read_b64_tr_b16 v[180:181], v152 offset:6144
  ds_read_b64_tr_b16 v[184:185], v153 offset:32
  ds_read_b64_tr_b16 v[178:179], v152 offset:768
  ds_read_b64_tr_b16 v[182:183], v152 offset:6912
  ds_read_b64_tr_b16 v[186:187], v153 offset:800
  v_lshlrev_b32 v154, 7, v148
  v_lshl_add_u32 v154, v145, 4, v154
  s_lshl_b32 s3, s16, 12
  s_add_u32 s3, s3, 114688
  v_add_u32 v154, s3, v154
  ds_read_b64_tr_b16 v[160:161], v154 offset:0
  ds_read_b64_tr_b16 v[162:163], v154 offset:512
  ds_read_b64_tr_b16 v[164:165], v154 offset:8
  ds_read_b64_tr_b16 v[166:167], v154 offset:520
  ds_read_b64_tr_b16 v[168:169], v154 offset:64
  ds_read_b64_tr_b16 v[170:171], v154 offset:576
  s_waitcnt lgkmcnt(14)
  ds_read_b64_tr_b16 v[172:173], v154 offset:72
  s_waitcnt lgkmcnt(14)
  ds_read_b64_tr_b16 v[174:175], v154 offset:584
  v_mov_b32 v156, 0x3f803f80
  v_mov_b32 v157, 0x3f803f80
  v_mov_b32 v158, 0x3f803f80
  v_mov_b32 v159, 0x3f803f80
  v_lshlrev_b32 v149, 2, v144
  v_cmp_gt_u32 vcc, 16, v144
  v_mov_b32 v150, 0x7ffffff0
  s_nop 0
  v_cndmask_b32 v149, v150, v149, vcc
  s_lshr_b32 s3, s2, 4
  s_lshl_b32 s3, s3, 2
  s_add_u32 s3, s3, s16
  s_and_b32 s4, s2, 15
  s_mul_i32 s58, s3, 49152
  s_mul_i32 s59, s4, 3072
  s_add_u32 s58, s58, s59
  s_add_u32 s58, s58, 3145728
  s_waitcnt lgkmcnt(10)
  buffer_store_dwordx4 v[176:179], v2, s[8:11], s58 offen offset:0 sc1
  s_waitcnt lgkmcnt(9)
  buffer_store_dwordx4 v[180:183], v2, s[8:11], s58 offen offset:1024 sc1
  s_waitcnt lgkmcnt(8)
  buffer_store_dwordx4 v[184:187], v2, s[8:11], s58 offen offset:2048 sc1
  v_mfma_f32_16x16x32_bf16 v[188:191], v[156:159], v[176:179], 0
  v_mfma_f32_16x16x32_bf16 v[192:195], v[156:159], v[180:183], 0
  v_mfma_f32_16x16x32_bf16 v[196:199], v[156:159], v[184:187], 0
  s_mul_i32 s58, s3, 3072
  s_lshl_b32 s59, s4, 6
  s_add_u32 s58, s58, s59
  s_add_u32 s58, s58, 7995392
  s_nop 1
  buffer_store_dword v188, v149, s[8:11], s58 offen offset:0 sc1
  buffer_store_dword v192, v149, s[8:11], s58 offen offset:1024 sc1
  buffer_store_dword v196, v149, s[8:11], s58 offen offset:2048 sc1
  s_lshl_b32 s3, s2, 2
  s_add_u32 s3, s3, s16
  s_sub_u32 s3, s3, 544
  s_cmp_ge_i32 s3, 0
  s_cselect_b32 s59, 0, 1
  s_lshl_b32 s59, s59, 30
  v_or_b32 v155, s59, v2
  s_max_i32 s3, s3, 0
  s_and_b32 s4, s3, 15
  s_lshr_b32 s4, s4, 2
  s_lshl_b32 s58, s3, 12
  s_add_u32 s58, s58, 2097152
  s_cmp_lt_u32 s3, 128
  s_cbranch_scc1 K_l1
  s_sub_u32 s3, s3, 128
  s_lshl_b32 s58, s3, 12
  s_add_u32 s58, s58, 6291456
  s_mul_hi_u32 s59, s3, 97612894
  s_mul_i32 s59, s59, 44
  s_sub_u32 s3, s3, s59
  s_mul_hi_u32 s4, s3, 390451573
K_l1:
  s_and_b32 s4, s4, 1
  s_xor_b32 s59, s4, 0
  s_lshl_b32 s59, s59, 11
  s_add_u32 s59, s59, s58
  s_waitcnt lgkmcnt(6)
  buffer_store_dwordx4 v[160:163], v155, s[8:11], s59 offen offset:0 sc1
  s_waitcnt lgkmcnt(4)
  buffer_store_dwordx4 v[164:167], v155, s[8:11], s59 offen offset:1024 sc1
  s_xor_b32 s59, s4, 1
  s_lshl_b32 s59, s59, 11
  s_add_u32 s59, s59, s58
  s_waitcnt lgkmcnt(2)
  buffer_store_dwordx4 v[168:171], v155, s[8:11], s59 offen offset:0 sc1
  s_waitcnt lgkmcnt(0)
  buffer_store_dwordx4 v[172:175], v155, s[8:11], s59 offen offset:1024 sc1
  s_waitcnt vmcnt(44)
  v_add_f32 v120, v120, v121
  s_waitcnt vmcnt(42)
  v_add_f32 v122, v122, v123
  v_add_f32 v120, v120, v122
  s_waitcnt vmcnt(40)
  v_add_f32 v124, v124, v125
  s_waitcnt vmcnt(38)
  v_add_f32 v126, v126, v127
  v_add_f32 v124, v124, v126
  s_waitcnt vmcnt(36)
  v_add_f32 v128, v128, v129
  s_waitcnt vmcnt(34)
  v_add_f32 v130, v130, v131
  v_add_f32 v128, v128, v130
  v_mov_b32 v121, v120
  v_mov_b32 v125, v124
  v_mov_b32 v129, v128
  v_permlane16_swap_b32 v120, v121
  v_permlane16_swap_b32 v124, v125
  v_permlane16_swap_b32 v128, v129
  v_add_f32 v120, v120, v121
  v_add_f32 v124, v124, v125
  v_add_f32 v128, v128, v129
  v_mov_b32 v121, v120
  v_mov_b32 v125, v124
  v_mov_b32 v129, v128
  v_permlane32_swap_b32 v120, v121
  v_permlane32_swap_b32 v124, v125
  v_permlane32_swap_b32 v128, v129
  v_add_f32 v120, v120, v121
  v_add_f32 v124, v124, v125
  v_add_f32 v128, v128, v129
  v_and_b32 v130, 0xf0, v2
  v_lshrrev_b32 v130, 2, v130
  s_mul_i32 s59, s16, 192
  s_add_u32 s59, s59, 149504
  v_add_u32 v130, s59, v130
  ds_write_b32 v130, v120 offset:0
  ds_write_b32 v130, v124 offset:64
  ds_write_b32 v130, v128 offset:128
  v_mov_b32 v1, v87
  s_xor_b32 s60, s46, 16384
  ds_read2_b32 v[88:89], v11 offset0:0 offset1:32
  ds_read2_b32 v[90:91], v11 offset0:64 offset1:96
  ds_read2_b32 v[92:93], v11 offset0:128 offset1:160
  ds_read2_b32 v[94:95], v11 offset0:192 offset1:224
  s_waitcnt lgkmcnt(3)
  v_add_f32 v88, v88, v89
  s_waitcnt lgkmcnt(2)
  v_add_f32 v90, v90, v91
  s_waitcnt lgkmcnt(1)
  v_add_f32 v92, v92, v93
  s_waitcnt lgkmcnt(0)
  v_add_f32 v94, v94, v95
  v_add_f32 v88, v88, v90
  v_add_f32 v92, v92, v94
  v_add_f32 v88, v88, v92
  v_mov_b32 v89, v88
  s_nop 1
  v_permlane32_swap_b32 v88, v89
  v_add_f32 v88, v88, v89
  v_mov_b32 v89, v88
  s_nop 1
  v_permlane16_swap_b32 v88, v89
  v_mul_f32 v88, 0xbb000000, v88
  v_mul_f32 v90, v88, v88
  v_fma_f32 v89, v89, s96, -v90
  v_max_f32 v89, 0, v89
  v_add_f32 v89, s97, v89
  v_rsq_f32 v89, v89
  s_nop 0
  v_cndmask_b32 v88, v88, v89, s[36:37]
  ds_write_b32 v12, v88 offset:0
  s_barrier
  ds_read_b128 v[68:71], v2 offset:0
  ds_read_b128 v[72:75], v2 offset:16384
  ds_read_b128 v[76:79], v2 offset:32768
  ds_read_b128 v[80:83], v2 offset:1024
  ds_read_b128 v[84:87], v2 offset:17408
  s_waitcnt vmcnt(32) lgkmcnt(4)
  v_mfma_f32_16x16x32_bf16 v[28:31], a[4:7], v[68:71], 0
  s_add_u32 s49, s41, 24576
  s_waitcnt vmcnt(31)
  v_mfma_f32_16x16x32_bf16 v[40:43], v[68:71], a[8:11], 0
  ds_read_b128 v[68:71], v2 offset:33792
  s_waitcnt lgkmcnt(4)
  v_mfma_f32_16x16x32_bf16 v[20:23], a[0:3], v[72:75], 0
  buffer_load_dwordx4 a[96:99], v2, s[8:11], s49 offen offset:0
  v_mfma_f32_16x16x32_bf16 v[32:35], a[4:7], v[72:75], 0
  v_mfma_f32_16x16x32_bf16 v[44:47], v[72:75], a[8:11], 0
  ds_read_b128 v[72:75], v2 offset:2048
  s_waitcnt lgkmcnt(4)
  v_mfma_f32_16x16x32_bf16 v[24:27], a[0:3], v[76:79], 0
  buffer_load_dwordx4 a[100:103], v2, s[8:11], s49 offen offset:1024
  v_mfma_f32_16x16x32_bf16 v[36:39], a[4:7], v[76:79], 0
  v_mfma_f32_16x16x32_bf16 v[48:51], v[76:79], a[8:11], 0
  ds_read_b128 v[76:79], v2 offset:18432
  s_waitcnt vmcnt(31) lgkmcnt(4)
  v_mfma_f32_16x16x32_bf16 v[28:31], a[16:19], v[80:83], v[28:31]
  buffer_load_dwordx4 a[104:107], v2, s[8:11], s49 offen offset:2048
  s_waitcnt vmcnt(31)
  v_mfma_f32_16x16x32_bf16 v[40:43], v[80:83], a[20:23], v[40:43]
  ds_read_b128 v[80:83], v2 offset:34816
  s_waitcnt lgkmcnt(4)
  v_mfma_f32_16x16x32_bf16 v[20:23], a[12:15], v[84:87], v[20:23]
  buffer_load_dwordx4 a[108:111], v2, s[8:11], s49 offen offset:3072
  v_mfma_f32_16x16x32_bf16 v[32:35], a[16:19], v[84:87], v[32:35]
  s_add_u32 s49, s41, 28672
  v_mfma_f32_16x16x32_bf16 v[44:47], v[84:87], a[20:23], v[44:47]
  ds_read_b128 v[84:87], v2 offset:3072
  s_waitcnt lgkmcnt(4)
  v_mfma_f32_16x16x32_bf16 v[24:27], a[12:15], v[68:71], v[24:27]
  buffer_load_dwordx4 a[112:115], v2, s[8:11], s49 offen offset:0
  v_mfma_f32_16x16x32_bf16 v[36:39], a[16:19], v[68:71], v[36:39]
  v_mfma_f32_16x16x32_bf16 v[48:51], v[68:71], a[20:23], v[48:51]
  ds_read_b128 v[68:71], v2 offset:19456
  s_waitcnt vmcnt(31) lgkmcnt(4)
  v_mfma_f32_16x16x32_bf16 v[28:31], a[28:31], v[72:75], v[28:31]
  buffer_load_dwordx4 a[116:119], v2, s[8:11], s49 offen offset:1024
  s_waitcnt vmcnt(31)
  v_mfma_f32_16x16x32_bf16 v[40:43], v[72:75], a[32:35], v[40:43]
  ds_read_b128 v[72:75], v2 offset:35840
  s_waitcnt lgkmcnt(4)
  v_mfma_f32_16x16x32_bf16 v[20:23], a[24:27], v[76:79], v[20:23]
  s_add_u32 m0, s27, 8192
  s_add_u32 s32, s63, 8396800
  v_mfma_f32_16x16x32_bf16 v[32:35], a[28:31], v[76:79], v[32:35]
  buffer_load_dwordx4 v2, s[8:11], s32 offen sc1 lds
  v_mfma_f32_16x16x32_bf16 v[44:47], v[76:79], a[32:35], v[44:47]
  s_barrier
  ds_read_b128 v[76:79], v2 offset:4096
  s_waitcnt lgkmcnt(4)
  v_mfma_f32_16x16x32_bf16 v[24:27], a[24:27], v[80:83], v[24:27]
  s_add_u32 m0, s27, 24576
  s_add_u32 s32, s66, 8396800
  v_mfma_f32_16x16x32_bf16 v[36:39], a[28:31], v[80:83], v[36:39]
  buffer_load_dwordx4 v2, s[8:11], s32 offen sc1 lds
  v_mfma_f32_16x16x32_bf16 v[48:51], v[80:83], a[32:35], v[48:51]
  ds_read_b128 v[80:83], v2 offset:20480
  s_waitcnt vmcnt(31) lgkmcnt(4)
  v_mfma_f32_16x16x32_bf16 v[28:31], a[40:43], v[84:87], v[28:31]
  s_add_u32 m0, s27, 40960
  s_add_u32 s32, s66, 8413184
  s_waitcnt vmcnt(30)
  v_mfma_f32_16x16x32_bf16 v[40:43], v[84:87], a[44:47], v[40:43]
  ds_read_b128 v[84:87], v2 offset:36864
  s_waitcnt lgkmcnt(4)
  v_mfma_f32_16x16x32_bf16 v[20:23], a[36:39], v[68:71], v[20:23]
  buffer_load_dwordx4 v2, s[8:11], s32 offen sc1 lds
  v_mfma_f32_16x16x32_bf16 v[32:35], a[40:43], v[68:71], v[32:35]
  v_mfma_f32_16x16x32_bf16 v[44:47], v[68:71], a[44:47], v[44:47]
  ds_read_b128 v[68:71], v2 offset:5120
  s_waitcnt lgkmcnt(4)
  v_mfma_f32_16x16x32_bf16 v[24:27], a[36:39], v[72:75], v[24:27]
  buffer_load_dwordx4 a[120:123], v2, s[8:11], s49 offen offset:2048
  v_mfma_f32_16x16x32_bf16 v[36:39], a[40:43], v[72:75], v[36:39]
  v_mfma_f32_16x16x32_bf16 v[48:51], v[72:75], a[44:47], v[48:51]
  ds_read_b128 v[72:75], v2 offset:21504
  s_waitcnt vmcnt(30) lgkmcnt(4)
  v_mfma_f32_16x16x32_bf16 v[28:31], a[52:55], v[76:79], v[28:31]
  buffer_load_dwordx4 a[124:127], v2, s[8:11], s49 offen offset:3072
  s_waitcnt vmcnt(30)
  v_mfma_f32_16x16x32_bf16 v[40:43], v[76:79], a[56:59], v[40:43]
  ds_read_b128 v[76:79], v2 offset:37888
  s_waitcnt lgkmcnt(4)
  v_mfma_f32_16x16x32_bf16 v[20:23], a[48:51], v[80:83], v[20:23]
  s_add_u32 s49, s41, 32768
  v_mfma_f32_16x16x32_bf16 v[32:35], a[52:55], v[80:83], v[32:35]
  buffer_load_dwordx4 a[128:131], v2, s[8:11], s49 offen offset:0
  v_mfma_f32_16x16x32_bf16 v[44:47], v[80:83], a[56:59], v[44:47]
  ds_read_b128 v[80:83], v2 offset:6144
  s_waitcnt lgkmcnt(4)
  v_mfma_f32_16x16x32_bf16 v[24:27], a[48:51], v[84:87], v[24:27]
  buffer_load_dwordx4 a[132:135], v2, s[8:11], s49 offen offset:1024
  v_mfma_f32_16x16x32_bf16 v[36:39], a[52:55], v[84:87], v[36:39]
  v_mfma_f32_16x16x32_bf16 v[48:51], v[84:87], a[56:59], v[48:51]
  ds_read_b128 v[84:87], v2 offset:22528
  s_waitcnt vmcnt(30) lgkmcnt(4)
  v_mfma_f32_16x16x32_bf16 v[28:31], a[64:67], v[68:71], v[28:31]
  buffer_load_dwordx4 a[136:139], v2, s[8:11], s49 offen offset:2048
  s_waitcnt vmcnt(30)
  v_mfma_f32_16x16x32_bf16 v[40:43], v[68:71], a[68:71], v[40:43]
  ds_read_b128 v[68:71], v2 offset:38912
  s_waitcnt lgkmcnt(4)
  v_mfma_f32_16x16x32_bf16 v[20:23], a[60:63], v[72:75], v[20:23]
  buffer_load_dwordx4 a[140:143], v2, s[8:11], s49 offen offset:3072
  v_mfma_f32_16x16x32_bf16 v[32:35], a[64:67], v[72:75], v[32:35]
  s_add_u32 s49, s41, 36864
  v_mfma_f32_16x16x32_bf16 v[44:47], v[72:75], a[68:71], v[44:47]
  ds_read_b128 v[72:75], v2 offset:7168
  s_waitcnt lgkmcnt(4)
  v_mfma_f32_16x16x32_bf16 v[24:27], a[60:63], v[76:79], v[24:27]
  buffer_load_dwordx4 a[144:147], v2, s[8:11], s49 offen offset:0
  v_mfma_f32_16x16x32_bf16 v[36:39], a[64:67], v[76:79], v[36:39]
  v_mfma_f32_16x16x32_bf16 v[48:51], v[76:79], a[68:71], v[48:51]
  ds_read_b128 v[76:79], v2 offset:23552
  s_waitcnt vmcnt(30) lgkmcnt(4)
  v_mfma_f32_16x16x32_bf16 v[28:31], a[76:79], v[80:83], v[28:31]
  buffer_load_dwordx4 a[148:151], v2, s[8:11], s49 offen offset:1024
  s_waitcnt vmcnt(30)
  v_mfma_f32_16x16x32_bf16 v[40:43], v[80:83], a[80:83], v[40:43]
  ds_read_b128 v[80:83], v2 offset:39936
  s_waitcnt lgkmcnt(4)
  v_mfma_f32_16x16x32_bf16 v[20:23], a[72:75], v[84:87], v[20:23]
  buffer_load_dwordx4 a[152:155], v2, s[8:11], s49 offen offset:2048
  v_mfma_f32_16x16x32_bf16 v[32:35], a[76:79], v[84:87], v[32:35]
  s_add_u32 m0, s27, 12288
  s_add_u32 s32, s63, 8400896
  v_mfma_f32_16x16x32_bf16 v[44:47], v[84:87], a[80:83], v[44:47]
  s_waitcnt vmcnt(9)
  s_barrier
  ds_read_b128 v[84:87], v2 offset:8192
  s_waitcnt lgkmcnt(4)
  v_mfma_f32_16x16x32_bf16 v[24:27], a[72:75], v[68:71], v[24:27]
  buffer_load_dwordx4 v2, s[8:11], s32 offen sc1 lds
  v_mfma_f32_16x16x32_bf16 v[36:39], a[76:79], v[68:71], v[36:39]
  s_add_u32 m0, s27, 28672
  s_add_u32 s32, s66, 8400896
  v_mfma_f32_16x16x32_bf16 v[48:51], v[68:71], a[80:83], v[48:51]
  ds_read_b128 v[68:71], v2 offset:24576
  s_waitcnt lgkmcnt(4)
  v_mfma_f32_16x16x32_bf16 v[28:31], a[88:91], v[72:75], v[28:31]
  buffer_load_dwordx4 v2, s[8:11], s32 offen sc1 lds
  v_mfma_f32_16x16x32_bf16 v[40:43], v[72:75], a[92:95], v[40:43]
  ds_read_b128 v[72:75], v2 offset:40960
  s_waitcnt lgkmcnt(4)
  v_mfma_f32_16x16x32_bf16 v[20:23], a[84:87], v[76:79], v[20:23]
  s_add_u32 m0, s27, 45056
  s_add_u32 s32, s66, 8417280
  v_mfma_f32_16x16x32_bf16 v[32:35], a[88:91], v[76:79], v[32:35]
  buffer_load_dwordx4 v2, s[8:11], s32 offen sc1 lds
  v_mfma_f32_16x16x32_bf16 v[44:47], v[76:79], a[92:95], v[44:47]
  ds_read_b128 v[76:79], v2 offset:9216
  s_waitcnt lgkmcnt(4)
  v_mfma_f32_16x16x32_bf16 v[24:27], a[84:87], v[80:83], v[24:27]
  buffer_load_dwordx4 a[156:159], v2, s[8:11], s49 offen offset:3072
  v_mfma_f32_16x16x32_bf16 v[36:39], a[88:91], v[80:83], v[36:39]
  s_add_u32 s49, s41, 40960
  v_mfma_f32_16x16x32_bf16 v[48:51], v[80:83], a[92:95], v[48:51]
  ds_read_b128 v[80:83], v2 offset:25600
  s_waitcnt lgkmcnt(4)
  v_mfma_f32_16x16x32_bf16 v[28:31], a[100:103], v[84:87], v[28:31]
  s_barrier
  s_lshr_b32 s58, s2, 3
  v_mfma_f32_16x16x32_bf16 v[40:43], v[84:87], a[104:107], v[40:43]
  ds_read_b128 v[84:87], v2 offset:41984
  s_waitcnt lgkmcnt(4)
  v_mfma_f32_16x16x32_bf16 v[20:23], a[96:99], v[68:71], v[20:23]
  s_lshl_b32 s58, s58, 7
  s_and_b32 s59, s2, 7
  s_lshl_b32 s59, s59, 2
  v_mfma_f32_16x16x32_bf16 v[32:35], a[100:103], v[68:71], v[32:35]
  s_add_u32 s58, s58, s59
  s_add_u32 s34, s58, 8228864
  v_mfma_f32_16x16x32_bf16 v[44:47], v[68:71], a[104:107], v[44:47]
  ds_read_b128 v[68:71], v2 offset:10240
  s_waitcnt lgkmcnt(4)
  v_mfma_f32_16x16x32_bf16 v[24:27], a[96:99], v[72:75], v[24:27]
  buffer_store_dword v18, v1, s[8:11], s34 offen sc1
  v_mfma_f32_16x16x32_bf16 v[36:39], a[100:103], v[72:75], v[36:39]
  v_mfma_f32_16x16x32_bf16 v[48:51], v[72:75], a[104:107], v[48:51]
  ds_read_b128 v[72:75], v2 offset:26624
  s_waitcnt lgkmcnt(4)
  v_mfma_f32_16x16x32_bf16 v[28:31], a[112:115], v[76:79], v[28:31]
  buffer_load_dwordx4 a[160:163], v2, s[8:11], s49 offen offset:0
  v_mfma_f32_16x16x32_bf16 v[40:43], v[76:79], a[116:119], v[40:43]
  ds_read_b128 v[76:79], v2 offset:43008
  s_waitcnt lgkmcnt(4)
  v_mfma_f32_16x16x32_bf16 v[20:23], a[108:111], v[80:83], v[20:23]
  buffer_load_dwordx4 a[164:167], v2, s[8:11], s49 offen offset:1024
  v_mfma_f32_16x16x32_bf16 v[32:35], a[112:115], v[80:83], v[32:35]
  v_mfma_f32_16x16x32_bf16 v[44:47], v[80:83], a[116:119], v[44:47]
  ds_read_b128 v[80:83], v2 offset:11264
  s_waitcnt lgkmcnt(4)
  v_mfma_f32_16x16x32_bf16 v[24:27], a[108:111], v[84:87], v[24:27]
  buffer_load_dwordx4 a[168:171], v2, s[8:11], s49 offen offset:2048
  v_mfma_f32_16x16x32_bf16 v[36:39], a[112:115], v[84:87], v[36:39]
  v_mfma_f32_16x16x32_bf16 v[48:51], v[84:87], a[116:119], v[48:51]
  ds_read_b128 v[84:87], v2 offset:27648
  s_waitcnt vmcnt(15) lgkmcnt(4)
  v_mfma_f32_16x16x32_bf16 v[28:31], a[124:127], v[68:71], v[28:31]
  buffer_load_dwordx4 a[172:175], v2, s[8:11], s49 offen offset:3072
  s_waitcnt vmcnt(15)
  v_mfma_f32_16x16x32_bf16 v[40:43], v[68:71], a[128:131], v[40:43]
  ds_read_b128 v[68:71], v2 offset:44032
  s_waitcnt lgkmcnt(4)
  v_mfma_f32_16x16x32_bf16 v[20:23], a[120:123], v[72:75], v[20:23]
  s_add_u32 s49, s41, 45056
  v_mfma_f32_16x16x32_bf16 v[32:35], a[124:127], v[72:75], v[32:35]
  buffer_load_dwordx4 a[176:179], v2, s[8:11], s49 offen offset:0
  v_mfma_f32_16x16x32_bf16 v[44:47], v[72:75], a[128:131], v[44:47]
  s_waitcnt vmcnt(7)
  s_barrier
  ds_read_b128 v[72:75], v2 offset:12288
  s_waitcnt lgkmcnt(4)
  v_mfma_f32_16x16x32_bf16 v[24:27], a[120:123], v[76:79], v[24:27]
  buffer_load_dwordx4 a[180:183], v2, s[8:11], s49 offen offset:1024
  v_mfma_f32_16x16x32_bf16 v[36:39], a[124:127], v[76:79], v[36:39]
  v_mfma_f32_16x16x32_bf16 v[48:51], v[76:79], a[128:131], v[48:51]
  ds_read_b128 v[76:79], v2 offset:28672
  s_waitcnt lgkmcnt(4)
  v_mfma_f32_16x16x32_bf16 v[28:31], a[136:139], v[80:83], v[28:31]
  buffer_load_dwordx4 a[184:187], v2, s[8:11], s49 offen offset:2048
  v_mfma_f32_16x16x32_bf16 v[40:43], v[80:83], a[140:143], v[40:43]
  ds_read_b128 v[80:83], v2 offset:45056
  s_waitcnt lgkmcnt(4)
  v_mfma_f32_16x16x32_bf16 v[20:23], a[132:135], v[84:87], v[20:23]
  buffer_load_dwordx4 a[188:191], v2, s[8:11], s49 offen offset:3072
  v_mfma_f32_16x16x32_bf16 v[32:35], a[136:139], v[84:87], v[32:35]
  s_add_u32 m0, s27, 65536
  s_add_u32 s32, s63, 9437184
  v_mfma_f32_16x16x32_bf16 v[44:47], v[84:87], a[140:143], v[44:47]
  ds_read_b128 v[84:87], v2 offset:13312
  s_waitcnt lgkmcnt(4)
  v_mfma_f32_16x16x32_bf16 v[24:27], a[132:135], v[68:71], v[24:27]
  buffer_load_dwordx4 v2, s[8:11], s32 offen sc1 lds
  v_mfma_f32_16x16x32_bf16 v[36:39], a[136:139], v[68:71], v[36:39]
  s_add_u32 m0, s27, 81920
  s_add_u32 s32, s66, 9437184
  v_mfma_f32_16x16x32_bf16 v[48:51], v[68:71], a[140:143], v[48:51]
  ds_read_b128 v[68:71], v2 offset:29696
  s_waitcnt lgkmcnt(4)
  v_mfma_f32_16x16x32_bf16 v[28:31], a[148:151], v[72:75], v[28:31]
  buffer_load_dwordx4 v2, s[8:11], s32 offen sc1 lds
  v_mfma_f32_16x16x32_bf16 v[40:43], v[72:75], a[152:155], v[40:43]
  ds_read_b128 v[72:75], v2 offset:46080
  s_waitcnt lgkmcnt(4)
  v_mfma_f32_16x16x32_bf16 v[20:23], a[144:147], v[76:79], v[20:23]
  s_add_u32 m0, s27, 98304
  s_add_u32 s32, s66, 9453568
  v_mfma_f32_16x16x32_bf16 v[32:35], a[148:151], v[76:79], v[32:35]
  buffer_load_dwordx4 v2, s[8:11], s32 offen sc1 lds
  v_mfma_f32_16x16x32_bf16 v[44:47], v[76:79], a[152:155], v[44:47]
  ds_read_b128 v[76:79], v2 offset:14336
  s_barrier
  s_waitcnt lgkmcnt(4)
  v_mfma_f32_16x16x32_bf16 v[24:27], a[144:147], v[80:83], v[24:27]
  s_lshl_b32 s33, s16, 11
  s_add_u32 m0, s33, 139264
  s_add_u32 s32, s25, 16908288
  v_mfma_f32_16x16x32_bf16 v[36:39], a[148:151], v[80:83], v[36:39]
  buffer_load_dwordx4 v2, s[8:11], s32 offen offset:0 sc1 lds
  v_mfma_f32_16x16x32_bf16 v[48:51], v[80:83], a[152:155], v[48:51]
  ds_read_b128 v[80:83], v2 offset:30720
  ds_read_b128 v[52:55], v14 offset:0
  s_waitcnt vmcnt(11) lgkmcnt(5)
  v_mfma_f32_16x16x32_bf16 v[28:31], a[160:163], v[84:87], v[28:31]
  s_lshl_b32 s33, s16, 11
  s_add_u32 m0, s33, 139264
  s_add_u32 s32, s25, 16908288
  s_waitcnt vmcnt(10)
  v_mfma_f32_16x16x32_bf16 v[40:43], v[84:87], a[164:167], v[40:43]
  ds_read_b128 v[84:87], v2 offset:47104
  ds_read_b128 v[56:59], v14 offset:256
  s_waitcnt lgkmcnt(6)
  v_mfma_f32_16x16x32_bf16 v[20:23], a[156:159], v[68:71], v[20:23]
  buffer_load_dwordx4 v2, s[8:11], s32 offen offset:1024 sc1 lds
  v_mfma_f32_16x16x32_bf16 v[32:35], a[160:163], v[68:71], v[32:35]
  s_add_u32 m0, s27, 69632
  s_add_u32 s32, s63, 9441280
  v_mfma_f32_16x16x32_bf16 v[44:47], v[68:71], a[164:167], v[44:47]
  ds_read_b128 v[68:71], v2 offset:15360
  ds_read_b128 v[60:63], v14 offset:64
  s_waitcnt lgkmcnt(7)
  v_mfma_f32_16x16x32_bf16 v[24:27], a[156:159], v[72:75], v[24:27]
  buffer_load_dwordx4 v2, s[8:11], s32 offen sc1 lds
  v_mfma_f32_16x16x32_bf16 v[36:39], a[160:163], v[72:75], v[36:39]
  s_add_u32 m0, s27, 86016
  s_add_u32 s32, s66, 9441280
  v_mfma_f32_16x16x32_bf16 v[48:51], v[72:75], a[164:167], v[48:51]
  ds_read_b128 v[72:75], v2 offset:31744
  ds_read_b128 v[64:67], v14 offset:320
  s_waitcnt vmcnt(10) lgkmcnt(8)
  v_mfma_f32_16x16x32_bf16 v[28:31], a[172:175], v[76:79], v[28:31]
  buffer_load_dwordx4 v2, s[8:11], s32 offen sc1 lds
  s_waitcnt vmcnt(10)
  v_mfma_f32_16x16x32_bf16 v[40:43], v[76:79], a[176:179], v[40:43]
  ds_read_b128 v[76:79], v2 offset:48128
  s_waitcnt lgkmcnt(8)
  v_mfma_f32_16x16x32_bf16 v[20:23], a[168:171], v[80:83], v[20:23]
  s_add_u32 m0, s27, 102400
  s_add_u32 s32, s66, 9457664
  v_mfma_f32_16x16x32_bf16 v[32:35], a[172:175], v[80:83], v[32:35]
  buffer_load_dwordx4 v2, s[8:11], s32 offen sc1 lds
  v_mfma_f32_16x16x32_bf16 v[44:47], v[80:83], a[176:179], v[44:47]
  ds_read_b128 v[80:83], v15 offset:64
  s_waitcnt lgkmcnt(7)
  v_mfma_f32_16x16x32_bf16 v[24:27], a[168:171], v[84:87], v[24:27]
  s_add_u32 m0, s27, 73728
  s_add_u32 s32, s63, 9445376
  v_mfma_f32_16x16x32_bf16 v[36:39], a[172:175], v[84:87], v[36:39]
  buffer_load_dwordx4 v2, s[8:11], s32 offen sc1 lds
  v_mfma_f32_16x16x32_bf16 v[48:51], v[84:87], a[176:179], v[48:51]
  ds_read_b32 v84, v16
  s_waitcnt vmcnt(10) lgkmcnt(6)
  v_mfma_f32_16x16x32_bf16 v[28:31], a[184:187], v[68:71], v[28:31]
  s_add_u32 m0, s27, 90112
  s_add_u32 s32, s66, 9445376
  s_waitcnt vmcnt(9)
  v_mfma_f32_16x16x32_bf16 v[40:43], v[68:71], a[188:191], v[40:43]
  ds_read_b64 v[68:69], v13 offset:0
  ds_read_b64 v[70:71], v13 offset:128
  s_waitcnt lgkmcnt(6)
  v_mfma_f32_16x16x32_bf16 v[20:23], a[180:183], v[72:75], v[20:23]
  buffer_load_dwordx4 v2, s[8:11], s32 offen sc1 lds
  v_mfma_f32_16x16x32_bf16 v[32:35], a[184:187], v[72:75], v[32:35]
  s_add_u32 m0, s27, 106496
  s_add_u32 s32, s66, 9461760
  v_mfma_f32_16x16x32_bf16 v[44:47], v[72:75], a[188:191], v[44:47]
  ds_read_b64 v[72:73], v13 offset:256
  s_waitcnt lgkmcnt(5)
  v_mfma_f32_16x16x32_bf16 v[24:27], a[180:183], v[76:79], v[24:27]
  buffer_load_dwordx4 v2, s[8:11], s32 offen sc1 lds
  v_mfma_f32_16x16x32_bf16 v[36:39], a[184:187], v[76:79], v[36:39]
  s_add_u32 m0, s27, 77824
  s_add_u32 s32, s63, 9449472
  v_mfma_f32_16x16x32_bf16 v[48:51], v[76:79], a[188:191], v[48:51]
  ds_read_b128 v[76:79], v15 offset:0
  buffer_load_dwordx4 v2, s[8:11], s32 offen sc1 lds
  s_barrier
  s_getreg_b32 s6, hwreg(HW_REG_XCC_ID, 0, 4)
  v_lshrrev_b32 v110, 2, v2
  s_and_b32 s58, s2, 7
  s_lshl_b32 s58, s58, 7
  s_add_u32 s5, s58, 8232960
  buffer_load_dword v111, v110, s[8:11], s5 offen sc1
  s_waitcnt lgkmcnt(0)
  v_pk_fma_f32 v[20:21], v[70:71], v[76:77], v[20:21] op_sel_hi:[0,1,1]
  v_pk_fma_f32 v[22:23], v[70:71], v[78:79], v[22:23] op_sel_hi:[0,1,1]
  v_mul_f32 v86, s98, v71
  v_pk_mul_f32 v[20:21], v[20:21], v[86:87] op_sel_hi:[1,0]
  v_pk_mul_f32 v[22:23], v[22:23], v[86:87] op_sel_hi:[1,0]
  v_cvt_pk_bf16_f32 v20, v20, v21
  v_cvt_pk_bf16_f32 v21, v22, v23
  v_pk_fma_f32 v[24:25], v[72:73], v[76:77], v[24:25] op_sel_hi:[0,1,1]
  v_pk_fma_f32 v[26:27], v[72:73], v[78:79], v[26:27] op_sel_hi:[0,1,1]
  v_mul_f32 v86, s98, v73
  s_add_u32 m0, s27, 94208
  s_add_u32 s32, s66, 9449472
  buffer_load_dwordx4 v2, s[8:11], s32 offen sc1 lds
  v_pk_mul_f32 v[24:25], v[24:25], v[86:87] op_sel_hi:[1,0]
  v_pk_mul_f32 v[26:27], v[26:27], v[86:87] op_sel_hi:[1,0]
  v_cvt_pk_bf16_f32 v24, v24, v25
  v_cvt_pk_bf16_f32 v25, v26, v27
  v_pk_fma_f32 v[28:29], v[68:69], v[80:81], v[28:29] op_sel_hi:[0,1,1]
  v_pk_fma_f32 v[30:31], v[68:69], v[82:83], v[30:31] op_sel_hi:[0,1,1]
  v_pk_mul_f32 v[28:29], v[28:29], v[68:69] op_sel:[0,1] op_sel_hi:[1,1]
  v_pk_mul_f32 v[30:31], v[30:31], v[68:69] op_sel:[0,1] op_sel_hi:[1,1]
  v_cvt_pk_bf16_f32 v28, v28, v29
  v_cvt_pk_bf16_f32 v29, v30, v31
  s_add_u32 m0, s27, 110592
  s_add_u32 s32, s66, 9465856
  buffer_load_dwordx4 v2, s[8:11], s32 offen sc1 lds
  v_pk_fma_f32 v[32:33], v[70:71], v[80:81], v[32:33] op_sel_hi:[0,1,1]
  v_pk_fma_f32 v[34:35], v[70:71], v[82:83], v[34:35] op_sel_hi:[0,1,1]
  v_pk_mul_f32 v[32:33], v[32:33], v[70:71] op_sel:[0,1] op_sel_hi:[1,1]
  v_pk_mul_f32 v[34:35], v[34:35], v[70:71] op_sel:[0,1] op_sel_hi:[1,1]
  v_cvt_pk_bf16_f32 v32, v32, v33
  v_cvt_pk_bf16_f32 v33, v34, v35
  v_pk_fma_f32 v[36:37], v[72:73], v[80:81], v[36:37] op_sel_hi:[0,1,1]
  v_pk_fma_f32 v[38:39], v[72:73], v[82:83], v[38:39] op_sel_hi:[0,1,1]
  v_pk_mul_f32 v[36:37], v[36:37], v[72:73] op_sel:[0,1] op_sel_hi:[1,1]
  v_pk_mul_f32 v[38:39], v[38:39], v[72:73] op_sel:[0,1] op_sel_hi:[1,1]
  v_cvt_pk_bf16_f32 v36, v36, v37
  v_cvt_pk_bf16_f32 v37, v38, v39
  v_add_u32 v138, 151552, v2
  ds_read_b128 v[68:71], v17
  ds_read_b128 v[72:75], v138 offset:1024
  ds_read_b128 v[76:79], v138 offset:0
  v_pk_fma_f32 v[40:41], v[52:53], v[84:85], v[40:41] op_sel_hi:[1,0,1]
  v_pk_fma_f32 v[42:43], v[54:55], v[84:85], v[42:43] op_sel_hi:[1,0,1]
  v_pk_mul_f32 v[40:41], v[40:41], v[56:57]
  v_pk_mul_f32 v[42:43], v[42:43], v[58:59]
  ds_read_b128 v[52:55], v14 offset:128
  ds_read_b128 v[56:59], v14 offset:384
  v_cvt_pk_bf16_f32 v40, v40, v41
  v_cvt_pk_bf16_f32 v41, v42, v43
  v_pk_fma_f32 v[44:45], v[60:61], v[84:85], v[44:45] op_sel_hi:[1,0,1]
  v_pk_fma_f32 v[46:47], v[62:63], v[84:85], v[46:47] op_sel_hi:[1,0,1]
  v_pk_mul_f32 v[44:45], v[44:45], v[64:65]
  v_pk_mul_f32 v[46:47], v[46:47], v[66:67]
  v_cvt_pk_bf16_f32 v44, v44, v45
  v_cvt_pk_bf16_f32 v45, v46, v47
  s_waitcnt lgkmcnt(1)
  v_pk_fma_f32 v[48:49], v[52:53], v[84:85], v[48:49] op_sel_hi:[1,0,1]
  v_pk_fma_f32 v[50:51], v[54:55], v[84:85], v[50:51] op_sel_hi:[1,0,1]
  s_waitcnt lgkmcnt(0)
  v_pk_mul_f32 v[48:49], v[48:49], v[56:57]
  v_pk_mul_f32 v[50:51], v[50:51], v[58:59]
  v_cvt_pk_bf16_f32 v48, v48, v49
  v_cvt_pk_bf16_f32 v49, v50, v51
  v_mfma_f32_16x16x16_bf16 v[52:55], v[28:29], v[20:21], v[68:71]
  v_mfma_f32_16x16x16_bf16 v[56:59], v[32:33], v[20:21], v[76:79]
  v_mfma_f32_16x16x16_bf16 v[60:63], v[32:33], v[24:25], v[72:75]
  v_mfma_f32_16x16x16_bf16 v[64:67], v[36:37], v[24:25], v[76:79]
  s_nop 4
  v_max3_f32 v80, v52, v53, v54
  v_max3_f32 v81, v55, v56, v57
  v_max3_f32 v80, v80, v58, v59
  v_max_f32 v80, v80, v81
  v_max3_f32 v84, v60, v61, v62
  v_max3_f32 v85, v63, v64, v65
  v_max3_f32 v84, v84, v66, v67
  v_max_f32 v84, v84, v85
  v_mov_b32 v81, v80
  v_mov_b32 v85, v84
  s_nop 0
  v_permlane16_swap_b32 v80, v81
  v_permlane16_swap_b32 v84, v85
  v_max_f32 v80, v80, v81
  v_max_f32 v84, v84, v85
  v_mov_b32 v81, v80
  v_mov_b32 v85, v84
  s_nop 0
  v_permlane32_swap_b32 v80, v81
  v_permlane32_swap_b32 v84, v85
  v_max_f32 v80, v80, v81
  v_max_f32 v84, v84, v85
  v_pk_add_f32 v[52:53], v[52:53], v[80:81] op_sel_hi:[1,0] neg_lo:[0,1] neg_hi:[0,1]
  v_pk_add_f32 v[54:55], v[54:55], v[80:81] op_sel_hi:[1,0] neg_lo:[0,1] neg_hi:[0,1]
  v_pk_add_f32 v[56:57], v[56:57], v[80:81] op_sel_hi:[1,0] neg_lo:[0,1] neg_hi:[0,1]
  v_pk_add_f32 v[58:59], v[58:59], v[80:81] op_sel_hi:[1,0] neg_lo:[0,1] neg_hi:[0,1]
  v_pk_add_f32 v[60:61], v[60:61], v[84:85] op_sel_hi:[1,0] neg_lo:[0,1] neg_hi:[0,1]
  v_pk_add_f32 v[62:63], v[62:63], v[84:85] op_sel_hi:[1,0] neg_lo:[0,1] neg_hi:[0,1]
  v_pk_add_f32 v[64:65], v[64:65], v[84:85] op_sel_hi:[1,0] neg_lo:[0,1] neg_hi:[0,1]
  v_pk_add_f32 v[66:67], v[66:67], v[84:85] op_sel_hi:[1,0] neg_lo:[0,1] neg_hi:[0,1]
  v_exp_f32 v52, v52
  v_exp_f32 v56, v56
  v_exp_f32 v53, v53
  v_exp_f32 v57, v57
  v_exp_f32 v54, v54
  v_exp_f32 v58, v58
  v_exp_f32 v55, v55
  v_exp_f32 v59, v59
  v_exp_f32 v60, v60
  v_exp_f32 v64, v64
  v_exp_f32 v61, v61
  v_exp_f32 v65, v65
  v_exp_f32 v62, v62
  v_exp_f32 v66, v66
  v_exp_f32 v63, v63
  v_exp_f32 v67, v67
  v_mov_b32 v76, 0x3f803f80
  v_mov_b32 v77, 0x3f803f80
  v_cvt_pk_bf16_f32 v52, v52, v53
  v_cvt_pk_bf16_f32 v53, v54, v55
  v_cvt_pk_bf16_f32 v56, v56, v57
  v_cvt_pk_bf16_f32 v57, v58, v59
  v_cvt_pk_bf16_f32 v60, v60, v61
  v_cvt_pk_bf16_f32 v61, v62, v63
  v_cvt_pk_bf16_f32 v64, v64, v65
  v_cvt_pk_bf16_f32 v65, v66, v67
  v_mfma_f32_16x16x16_bf16 v[80:83], v[76:77], v[52:53], 0
  v_mfma_f32_16x16x16_bf16 v[84:87], v[76:77], v[60:61], 0
  v_mfma_f32_16x16x16_bf16 v[20:23], v[40:41], v[52:53], 0
  v_mfma_f32_16x16x16_bf16 v[24:27], v[44:45], v[60:61], 0
  v_mfma_f32_16x16x16_bf16 v[80:83], v[76:77], v[56:57], v[80:83]
  v_mfma_f32_16x16x16_bf16 v[84:87], v[76:77], v[64:65], v[84:87]
  v_mfma_f32_16x16x16_bf16 v[20:23], v[44:45], v[56:57], v[20:23]
  v_mfma_f32_16x16x16_bf16 v[24:27], v[48:49], v[64:65], v[24:27]
  s_nop 4
  v_rcp_f32 v80, v80
  v_rcp_f32 v84, v84
  v_pk_mul_f32 v[20:21], v[20:21], v[80:81] op_sel_hi:[1,0]
  v_pk_mul_f32 v[22:23], v[22:23], v[80:81] op_sel_hi:[1,0]
  v_pk_mul_f32 v[24:25], v[24:25], v[84:85] op_sel_hi:[1,0]
  v_pk_mul_f32 v[26:27], v[26:27], v[84:85] op_sel_hi:[1,0]
  v_cvt_pk_bf16_f32 v20, v20, v21
  v_cvt_pk_bf16_f32 v21, v22, v23
  v_cvt_pk_bf16_f32 v22, v24, v25
  v_cvt_pk_bf16_f32 v23, v26, v27
  s_nop 0
  v_permlane16_swap_b32 v20, v22
  v_permlane16_swap_b32 v21, v23
  s_add_u32 s58, s45, 18874368
  buffer_store_dwordx4 v[20:23], v4, s[8:11], s58 offen sc1
  s_lshl_b32 s58, s61, 4
  s_waitcnt vmcnt(3)
  v_xor_b32 v111, s58, v111
  v_cmp_le_u32 vcc, 16, v111
  s_mov_b32 vcc_hi, 0
  s_cbranch_vccnz SLOW_1
BACK_1:
  v_cmp_ne_u32 vcc, s6, v111
  s_nop 0
  s_cmp_lg_u32 vcc_lo, 0
  s_cselect_b32 s58, 1, 0
  s_cmp_eq_u32 s16, 0
  s_cselect_b32 s7, s58, 0
  s_barrier
  ds_read_b128 v[68:71], v3 offset:0
  ds_read_b128 v[72:75], v3 offset:16384
  ds_read_b128 v[76:79], v3 offset:32768
  ds_read_b128 v[80:83], v3 offset:1024
  ds_read_b128 v[84:87], v3 offset:17408
  s_waitcnt lgkmcnt(4)
  v_mfma_f32_16x16x32_bf16 v[28:31], a[4:7], v[68:71], 0
  v_mfma_f32_16x16x32_bf16 v[40:43], v[68:71], a[8:11], 0
  ds_read_b128 v[68:71], v3 offset:33792
  s_waitcnt lgkmcnt(4)
  v_mfma_f32_16x16x32_bf16 v[20:23], a[0:3], v[72:75], 0
  v_mfma_f32_16x16x32_bf16 v[32:35], a[4:7], v[72:75], 0
  v_mfma_f32_16x16x32_bf16 v[44:47], v[72:75], a[8:11], 0
  ds_read_b128 v[72:75], v3 offset:2048
  s_waitcnt lgkmcnt(4)
  v_mfma_f32_16x16x32_bf16 v[24:27], a[0:3], v[76:79], 0
  v_mfma_f32_16x16x32_bf16 v[36:39], a[4:7], v[76:79], 0
  v_add_u32 v96, 8192, v11
  v_mfma_f32_16x16x32_bf16 v[48:51], v[76:79], a[8:11], 0
  ds_read_b128 v[76:79], v3 offset:18432
  s_waitcnt lgkmcnt(4)
  v_mfma_f32_16x16x32_bf16 v[28:31], a[16:19], v[80:83], v[28:31]
  ds_read2_b32 v[88:89], v96 offset0:0 offset1:32
  ds_read2_b32 v[90:91], v96 offset0:64 offset1:96
  v_mfma_f32_16x16x32_bf16 v[40:43], v[80:83], a[20:23], v[40:43]
  ds_read_b128 v[80:83], v3 offset:34816
  s_waitcnt lgkmcnt(6)
  v_mfma_f32_16x16x32_bf16 v[20:23], a[12:15], v[84:87], v[20:23]
  ds_read2_b32 v[92:93], v96 offset0:128 offset1:160
  ds_read2_b32 v[94:95], v96 offset0:192 offset1:224
  v_mfma_f32_16x16x32_bf16 v[32:35], a[16:19], v[84:87], v[32:35]
  v_mfma_f32_16x16x32_bf16 v[44:47], v[84:87], a[20:23], v[44:47]
  ds_read_b128 v[84:87], v3 offset:3072
  s_waitcnt lgkmcnt(8)
  v_mfma_f32_16x16x32_bf16 v[24:27], a[12:15], v[68:71], v[24:27]
  v_mfma_f32_16x16x32_bf16 v[36:39], a[16:19], v[68:71], v[36:39]
  v_mfma_f32_16x16x32_bf16 v[48:51], v[68:71], a[20:23], v[48:51]
  ds_read_b128 v[68:71], v3 offset:19456
  s_waitcnt lgkmcnt(8)
  v_mfma_f32_16x16x32_bf16 v[28:31], a[28:31], v[72:75], v[28:31]
  v_mfma_f32_16x16x32_bf16 v[40:43], v[72:75], a[32:35], v[40:43]
  ds_read_b128 v[72:75], v3 offset:35840
  s_waitcnt lgkmcnt(8)
  v_mfma_f32_16x16x32_bf16 v[20:23], a[24:27], v[76:79], v[20:23]
  v_mfma_f32_16x16x32_bf16 v[32:35], a[28:31], v[76:79], v[32:35]
  v_mfma_f32_16x16x32_bf16 v[44:47], v[76:79], a[32:35], v[44:47]
  s_barrier
  ds_read_b128 v[76:79], v3 offset:4096
  s_waitcnt lgkmcnt(6)
  v_mfma_f32_16x16x32_bf16 v[24:27], a[24:27], v[80:83], v[24:27]
  v_lshrrev_b32 v105, 4, v2
  s_lshl_b32 s58, s18, 2
  v_mfma_f32_16x16x32_bf16 v[36:39], a[28:31], v[80:83], v[36:39]
  s_add_u32 s58, s58, 136
  v_add_u32 v104, s58, v105
  v_mfma_f32_16x16x32_bf16 v[48:51], v[80:83], a[32:35], v[48:51]
  ds_read_b128 v[80:83], v3 offset:20480
  s_waitcnt lgkmcnt(4)
  v_mfma_f32_16x16x32_bf16 v[28:31], a[40:43], v[84:87], v[28:31]
  s_lshl_b32 s58, s20, 4
  s_sub_u32 s58, s58, 4
  v_mfma_f32_16x16x32_bf16 v[40:43], v[84:87], a[44:47], v[40:43]
  ds_read_b128 v[84:87], v3 offset:36864
  s_waitcnt lgkmcnt(4)
  v_mfma_f32_16x16x32_bf16 v[20:23], a[36:39], v[68:71], v[20:23]
  v_add_u32 v106, s58, v105
  v_cmp_lt_u32 vcc, 3, v105
  v_mfma_f32_16x16x32_bf16 v[32:35], a[40:43], v[68:71], v[32:35]
  s_nop 0
  v_cndmask_b32 v104, v104, v106, vcc
  s_mul_i32 s58, s18, 11
  v_mfma_f32_16x16x32_bf16 v[44:47], v[68:71], a[44:47], v[44:47]
  ds_read_b128 v[68:71], v3 offset:5120
  s_waitcnt lgkmcnt(4)
  v_mfma_f32_16x16x32_bf16 v[24:27], a[36:39], v[72:75], v[24:27]
  s_add_u32 s58, s58, 148
  v_add_u32 v106, s58, v105
  v_mfma_f32_16x16x32_bf16 v[36:39], a[40:43], v[72:75], v[36:39]
  v_cmp_lt_u32 vcc, 19, v105
  s_nop 1
  v_cndmask_b32 v104, v104, v106, vcc
  v_mfma_f32_16x16x32_bf16 v[48:51], v[72:75], a[44:47], v[48:51]
  ds_read_b128 v[72:75], v3 offset:21504
  s_waitcnt lgkmcnt(4)
  v_mfma_f32_16x16x32_bf16 v[28:31], a[52:55], v[76:79], v[28:31]
  v_lshrrev_b32 v106, 3, v104
  v_and_b32 v104, 7, v104
  v_mfma_f32_16x16x32_bf16 v[40:43], v[76:79], a[56:59], v[40:43]
  ds_read_b128 v[76:79], v3 offset:37888
  s_waitcnt lgkmcnt(4)
  v_mfma_f32_16x16x32_bf16 v[20:23], a[48:51], v[80:83], v[20:23]
  v_lshlrev_b32 v104, 2, v104
  v_lshl_add_u32 v104, v106, 7, v104
  v_mfma_f32_16x16x32_bf16 v[32:35], a[52:55], v[80:83], v[32:35]
  s_cmp_eq_u32 s16, 1
  s_cselect_b32 s58, 31, 0
  s_cselect_b32 s4, 0x7fffffff, 0
  v_mfma_f32_16x16x32_bf16 v[44:47], v[80:83], a[56:59], v[44:47]
  ds_read_b128 v[80:83], v3 offset:6144
  s_waitcnt lgkmcnt(4)
  v_mfma_f32_16x16x32_bf16 v[24:27], a[48:51], v[84:87], v[24:27]
  s_cselect_b32 s5, 0, 0
  v_cmp_gt_u32 vcc, s58, v105
  v_mfma_f32_16x16x32_bf16 v[36:39], a[52:55], v[84:87], v[36:39]
  v_mov_b32 v106, 0x7ffffff0
  v_cndmask_b32 v104, v106, v104, vcc
  v_mfma_f32_16x16x32_bf16 v[48:51], v[84:87], a[56:59], v[48:51]
  ds_read_b128 v[84:87], v3 offset:22528
  s_waitcnt lgkmcnt(4)
  v_mfma_f32_16x16x32_bf16 v[28:31], a[64:67], v[68:71], v[28:31]
  s_mov_b32 s62, 8228864
  v_add_f32 v88, v88, v89
  v_mfma_f32_16x16x32_bf16 v[40:43], v[68:71], a[68:71], v[40:43]
  ds_read_b128 v[68:71], v3 offset:38912
  s_waitcnt lgkmcnt(4)
  v_mfma_f32_16x16x32_bf16 v[20:23], a[60:63], v[72:75], v[20:23]
  buffer_load_dword v100, v104, s[8:11], s62 offen sc1
  v_mfma_f32_16x16x32_bf16 v[32:35], a[64:67], v[72:75], v[32:35]
  v_add_f32 v90, v90, v91
  v_add_f32 v92, v92, v93
  v_mfma_f32_16x16x32_bf16 v[44:47], v[72:75], a[68:71], v[44:47]
  ds_read_b128 v[72:75], v3 offset:7168
  s_waitcnt vmcnt(1)
  s_waitcnt lgkmcnt(4)
  v_mfma_f32_16x16x32_bf16 v[24:27], a[60:63], v[76:79], v[24:27]
  s_barrier
  s_add_u32 s34, s50, 8257536
  s_cmp_eq_u32 s7, 1
  v_mfma_f32_16x16x32_bf16 v[36:39], a[64:67], v[76:79], v[36:39]
  s_cbranch_scc1 IMP_0
  buffer_store_dword v18, v1, s[8:11], s34 offen
IMPB_0:
  v_add_f32 v94, v94, v95
  v_mfma_f32_16x16x32_bf16 v[48:51], v[76:79], a[68:71], v[48:51]
  ds_read_b128 v[76:79], v3 offset:23552
  s_waitcnt lgkmcnt(4)
  v_mfma_f32_16x16x32_bf16 v[28:31], a[76:79], v[80:83], v[28:31]
  v_add_f32 v88, v88, v90
  v_add_f32 v92, v92, v94
  v_mfma_f32_16x16x32_bf16 v[40:43], v[80:83], a[80:83], v[40:43]
  ds_read_b128 v[80:83], v3 offset:39936
  s_waitcnt lgkmcnt(4)
  v_mfma_f32_16x16x32_bf16 v[20:23], a[72:75], v[84:87], v[20:23]
  v_add_f32 v88, v88, v92
  v_mov_b32 v89, v88
  v_mfma_f32_16x16x32_bf16 v[32:35], a[76:79], v[84:87], v[32:35]
  s_nop 0
  v_permlane32_swap_b32 v88, v89
  v_mfma_f32_16x16x32_bf16 v[44:47], v[84:87], a[80:83], v[44:47]
  s_barrier
  ds_read_b128 v[84:87], v3 offset:8192
  s_waitcnt lgkmcnt(4)
  v_mfma_f32_16x16x32_bf16 v[24:27], a[72:75], v[68:71], v[24:27]
  v_add_f32 v88, v88, v89
  v_mov_b32 v89, v88
  v_mfma_f32_16x16x32_bf16 v[36:39], a[76:79], v[68:71], v[36:39]
  s_nop 0
  v_permlane16_swap_b32 v88, v89
  v_mfma_f32_16x16x32_bf16 v[48:51], v[68:71], a[80:83], v[48:51]
  ds_read_b128 v[68:71], v3 offset:24576
  s_waitcnt lgkmcnt(4)
  v_mfma_f32_16x16x32_bf16 v[28:31], a[88:91], v[72:75], v[28:31]
  s_waitcnt vmcnt(1)
  v_cmp_ne_u32 vcc, s61, v100
  s_nop 0
  s_and_b64 vcc, vcc, s[4:5]
  v_mfma_f32_16x16x32_bf16 v[40:43], v[72:75], a[92:95], v[40:43]
  ds_read_b128 v[72:75], v3 offset:40960
  s_waitcnt lgkmcnt(4)
  v_mfma_f32_16x16x32_bf16 v[20:23], a[84:87], v[76:79], v[20:23]
  s_cbranch_vccnz SLOW_3
BACK_3:
  s_barrier
  v_and_b32 v156, 0xf0, v2
  v_mfma_f32_16x16x32_bf16 v[32:35], a[88:91], v[76:79], v[32:35]
  v_lshrrev_b32 v156, 2, v156
  v_lshrrev_b32 v157, 8, v2
  v_mfma_f32_16x16x32_bf16 v[44:47], v[76:79], a[92:95], v[44:47]
  ds_read_b128 v[76:79], v3 offset:9216
  s_waitcnt lgkmcnt(4)
  v_mfma_f32_16x16x32_bf16 v[24:27], a[84:87], v[80:83], v[24:27]
  v_lshl_add_u32 v156, v157, 8, v156
  s_lshl_b32 s58, s20, 2
  v_mfma_f32_16x16x32_bf16 v[36:39], a[88:91], v[80:83], v[36:39]
  s_add_u32 s58, s58, s16
  s_mul_i32 s59, s58, 3072
  s_add_u32 s59, s59, 7995392
  v_mfma_f32_16x16x32_bf16 v[48:51], v[80:83], a[92:95], v[48:51]
  ds_read_b128 v[80:83], v3 offset:25600
  s_waitcnt lgkmcnt(4)
  v_mfma_f32_16x16x32_bf16 v[28:31], a[100:103], v[84:87], v[28:31]
  buffer_load_dword v144, v156, s[8:11], s59 offen offset:0
  v_mfma_f32_16x16x32_bf16 v[40:43], v[84:87], a[104:107], v[40:43]
  ds_read_b128 v[84:87], v3 offset:41984
  s_waitcnt lgkmcnt(4)
  v_mfma_f32_16x16x32_bf16 v[20:23], a[96:99], v[68:71], v[20:23]
  buffer_load_dword v145, v156, s[8:11], s59 offen offset:64
  v_mfma_f32_16x16x32_bf16 v[32:35], a[100:103], v[68:71], v[32:35]
  buffer_load_dword v146, v156, s[8:11], s59 offen offset:128
  v_mfma_f32_16x16x32_bf16 v[44:47], v[68:71], a[104:107], v[44:47]
  ds_read_b128 v[68:71], v3 offset:10240
  s_waitcnt lgkmcnt(4)
  v_mfma_f32_16x16x32_bf16 v[24:27], a[96:99], v[72:75], v[24:27]
  buffer_load_dword v147, v156, s[8:11], s59 offen offset:192
  v_mfma_f32_16x16x32_bf16 v[36:39], a[100:103], v[72:75], v[36:39]
  buffer_load_dword v148, v156, s[8:11], s59 offen offset:1024
  v_mfma_f32_16x16x32_bf16 v[48:51], v[72:75], a[104:107], v[48:51]
  ds_read_b128 v[72:75], v3 offset:26624
  s_waitcnt lgkmcnt(4)
  v_mfma_f32_16x16x32_bf16 v[28:31], a[112:115], v[76:79], v[28:31]
  buffer_load_dword v149, v156, s[8:11], s59 offen offset:1088
  v_mfma_f32_16x16x32_bf16 v[40:43], v[76:79], a[116:119], v[40:43]
  ds_read_b128 v[76:79], v3 offset:43008
  s_waitcnt lgkmcnt(4)
  v_mfma_f32_16x16x32_bf16 v[20:23], a[108:111], v[80:83], v[20:23]
  buffer_load_dword v150, v156, s[8:11], s59 offen offset:1152
  v_mfma_f32_16x16x32_bf16 v[32:35], a[112:115], v[80:83], v[32:35]
  buffer_load_dword v151, v156, s[8:11], s59 offen offset:1216
  v_mfma_f32_16x16x32_bf16 v[44:47], v[80:83], a[116:119], v[44:47]
  ds_read_b128 v[80:83], v3 offset:11264
  s_waitcnt lgkmcnt(4)
  v_mfma_f32_16x16x32_bf16 v[24:27], a[108:111], v[84:87], v[24:27]
  buffer_load_dword v152, v156, s[8:11], s59 offen offset:2048
  v_mfma_f32_16x16x32_bf16 v[36:39], a[112:115], v[84:87], v[36:39]
  buffer_load_dword v153, v156, s[8:11], s59 offen offset:2112
  v_mfma_f32_16x16x32_bf16 v[48:51], v[84:87], a[116:119], v[48:51]
  ds_read_b128 v[84:87], v3 offset:27648
  s_waitcnt lgkmcnt(4)
  v_mfma_f32_16x16x32_bf16 v[28:31], a[124:127], v[68:71], v[28:31]
  buffer_load_dword v154, v156, s[8:11], s59 offen offset:2176
  v_mfma_f32_16x16x32_bf16 v[40:43], v[68:71], a[128:131], v[40:43]
  ds_read_b128 v[68:71], v3 offset:44032
  s_waitcnt lgkmcnt(4)
  v_mfma_f32_16x16x32_bf16 v[20:23], a[120:123], v[72:75], v[20:23]
  buffer_load_dword v155, v156, s[8:11], s59 offen offset:2240
  v_mfma_f32_16x16x32_bf16 v[32:35], a[124:127], v[72:75], v[32:35]
  s_add_u32 s49, s42, 0
  v_mul_f32 v88, 0xbb000000, v88
  v_mfma_f32_16x16x32_bf16 v[44:47], v[72:75], a[128:131], v[44:47]
  s_barrier
  ds_read_b128 v[72:75], v3 offset:12288
  s_waitcnt lgkmcnt(4)
  v_mfma_f32_16x16x32_bf16 v[24:27], a[120:123], v[76:79], v[24:27]
  v_mul_f32 v90, v88, v88
  v_fma_f32 v89, v89, s96, -v90
  v_mfma_f32_16x16x32_bf16 v[36:39], a[124:127], v[76:79], v[36:39]
  buffer_load_dwordx4 a[192:195], v2, s[8:11], s49 offen offset:0
  v_mfma_f32_16x16x32_bf16 v[48:51], v[76:79], a[128:131], v[48:51]
  ds_read_b128 v[76:79], v3 offset:28672
  s_waitcnt lgkmcnt(4)
  v_mfma_f32_16x16x32_bf16 v[28:31], a[136:139], v[80:83], v[28:31]
  v_max_f32 v89, 0, v89
  v_add_f32 v89, s97, v89
  v_mfma_f32_16x16x32_bf16 v[40:43], v[80:83], a[140:143], v[40:43]
  ds_read_b128 v[80:83], v3 offset:45056
  s_waitcnt lgkmcnt(4)
  v_mfma_f32_16x16x32_bf16 v[20:23], a[132:135], v[84:87], v[20:23]
  buffer_load_dwordx4 a[196:199], v2, s[8:11], s49 offen offset:1024
  v_mfma_f32_16x16x32_bf16 v[32:35], a[136:139], v[84:87], v[32:35]
  v_rsq_f32 v89, v89
  v_mfma_f32_16x16x32_bf16 v[44:47], v[84:87], a[140:143], v[44:47]
  ds_read_b128 v[84:87], v3 offset:13312
  s_waitcnt lgkmcnt(4)
  v_mfma_f32_16x16x32_bf16 v[24:27], a[132:135], v[68:71], v[24:27]
  v_cndmask_b32 v88, v88, v89, s[36:37]
  ds_write_b32 v12, v88 offset:1024
  v_mfma_f32_16x16x32_bf16 v[36:39], a[136:139], v[68:71], v[36:39]
  buffer_load_dwordx4 a[200:203], v2, s[8:11], s49 offen offset:2048
  v_mfma_f32_16x16x32_bf16 v[48:51], v[68:71], a[140:143], v[48:51]
  ds_read_b128 v[68:71], v3 offset:29696
  s_waitcnt lgkmcnt(5)
  v_mfma_f32_16x16x32_bf16 v[28:31], a[148:151], v[72:75], v[28:31]
  s_add_u32 s35, s52, 8257536
  v_mfma_f32_16x16x32_bf16 v[40:43], v[72:75], a[152:155], v[40:43]
  ds_read_b128 v[72:75], v3 offset:46080
  s_waitcnt lgkmcnt(5)
  v_mfma_f32_16x16x32_bf16 v[20:23], a[144:147], v[76:79], v[20:23]
  buffer_load_dword v19, v9, s[8:11], s35 offen sc1
  v_mfma_f32_16x16x32_bf16 v[32:35], a[148:151], v[76:79], v[32:35]
  v_mfma_f32_16x16x32_bf16 v[44:47], v[76:79], a[152:155], v[44:47]
  ds_read_b128 v[76:79], v3 offset:14336
  s_waitcnt lgkmcnt(3)
  s_barrier
  v_mfma_f32_16x16x32_bf16 v[24:27], a[144:147], v[80:83], v[24:27]
  v_mfma_f32_16x16x32_bf16 v[36:39], a[148:151], v[80:83], v[36:39]
  buffer_load_dwordx4 a[204:207], v2, s[8:11], s49 offen offset:3072
  v_mfma_f32_16x16x32_bf16 v[48:51], v[80:83], a[152:155], v[48:51]
  ds_read_b128 v[80:83], v3 offset:30720
  ds_read_b128 v[52:55], v14 offset:1024
  v_mfma_f32_16x16x32_bf16 v[28:31], a[160:163], v[84:87], v[28:31]
  v_mfma_f32_16x16x32_bf16 v[40:43], v[84:87], a[164:167], v[40:43]
  ds_read_b128 v[84:87], v3 offset:47104
  ds_read_b128 v[56:59], v14 offset:1280
  s_waitcnt lgkmcnt(6)
  v_mfma_f32_16x16x32_bf16 v[20:23], a[156:159], v[68:71], v[20:23]
  s_add_u32 s49, s42, 4096
  v_mfma_f32_16x16x32_bf16 v[32:35], a[160:163], v[68:71], v[32:35]
  buffer_load_dwordx4 a[208:211], v2, s[8:11], s49 offen offset:0
  v_mfma_f32_16x16x32_bf16 v[44:47], v[68:71], a[164:167], v[44:47]
  ds_read_b128 v[68:71], v3 offset:15360
  ds_read_b128 v[60:63], v14 offset:1088
  s_waitcnt lgkmcnt(7)
  v_mfma_f32_16x16x32_bf16 v[24:27], a[156:159], v[72:75], v[24:27]
  v_mfma_f32_16x16x32_bf16 v[36:39], a[160:163], v[72:75], v[36:39]
  v_mfma_f32_16x16x32_bf16 v[48:51], v[72:75], a[164:167], v[48:51]
  ds_read_b128 v[72:75], v3 offset:31744
  ds_read_b128 v[64:67], v14 offset:1344
  s_waitcnt lgkmcnt(8)
  v_mfma_f32_16x16x32_bf16 v[28:31], a[172:175], v[76:79], v[28:31]
  buffer_load_dwordx4 a[212:215], v2, s[8:11], s49 offen offset:1024
  v_mfma_f32_16x16x32_bf16 v[40:43], v[76:79], a[176:179], v[40:43]
  ds_read_b128 v[76:79], v3 offset:48128
  s_waitcnt lgkmcnt(8)
  v_mfma_f32_16x16x32_bf16 v[20:23], a[168:171], v[80:83], v[20:23]
  v_mfma_f32_16x16x32_bf16 v[32:35], a[172:175], v[80:83], v[32:35]
  v_mfma_f32_16x16x32_bf16 v[44:47], v[80:83], a[176:179], v[44:47]
  ds_read_b128 v[80:83], v15 offset:64
  s_waitcnt lgkmcnt(7)
  v_mfma_f32_16x16x32_bf16 v[24:27], a[168:171], v[84:87], v[24:27]
  buffer_load_dwordx4 a[216:219], v2, s[8:11], s49 offen offset:2048
  v_mfma_f32_16x16x32_bf16 v[36:39], a[172:175], v[84:87], v[36:39]
  v_mfma_f32_16x16x32_bf16 v[48:51], v[84:87], a[176:179], v[48:51]
  ds_read_b32 v84, v16
  s_waitcnt lgkmcnt(6)
  v_mfma_f32_16x16x32_bf16 v[28:31], a[184:187], v[68:71], v[28:31]
  v_mfma_f32_16x16x32_bf16 v[40:43], v[68:71], a[188:191], v[40:43]
  ds_read_b64 v[68:69], v13 offset:1024
  ds_read_b64 v[70:71], v13 offset:1152
  s_waitcnt lgkmcnt(6)
  v_mfma_f32_16x16x32_bf16 v[20:23], a[180:183], v[72:75], v[20:23]
  buffer_load_dwordx4 a[220:223], v2, s[8:11], s49 offen offset:3072
  v_mfma_f32_16x16x32_bf16 v[32:35], a[184:187], v[72:75], v[32:35]
  v_mfma_f32_16x16x32_bf16 v[44:47], v[72:75], a[188:191], v[44:47]
  ds_read_b64 v[72:73], v13 offset:1280
  s_waitcnt lgkmcnt(5)
  v_mfma_f32_16x16x32_bf16 v[24:27], a[180:183], v[76:79], v[24:27]
  s_add_u32 s49, s42, 8192
  v_mfma_f32_16x16x32_bf16 v[36:39], a[184:187], v[76:79], v[36:39]
  buffer_load_dwordx4 a[224:227], v2, s[8:11], s49 offen offset:0
  v_mfma_f32_16x16x32_bf16 v[48:51], v[76:79], a[188:191], v[48:51]
  ds_read_b128 v[76:79], v15 offset:0
  s_waitcnt vmcnt(6)
  v_cmp_ne_u32 vcc, s61, v19
  s_nop 0
  s_and_b64 vcc, vcc, s[28:29]
  s_cbranch_vccnz SLOW_2
BACK_2:
  s_barrier
  s_barrier
  buffer_load_dwordx4 a[228:231], v2, s[8:11], s49 offen offset:1024
  buffer_load_dwordx4 a[232:235], v2, s[8:11], s49 offen offset:2048
  buffer_load_dwordx4 a[236:239], v2, s[8:11], s49 offen offset:3072
  s_add_u32 s49, s42, 12288
  buffer_load_dwordx4 a[240:243], v2, s[8:11], s49 offen offset:0
  buffer_load_dwordx4 a[244:247], v2, s[8:11], s49 offen offset:1024
  buffer_load_dwordx4 a[248:251], v2, s[8:11], s49 offen offset:2048
  buffer_load_dwordx4 a[252:255], v2, s[8:11], s49 offen offset:3072
  s_waitcnt lgkmcnt(0)
  v_pk_fma_f32 v[20:21], v[70:71], v[76:77], v[20:21] op_sel_hi:[0,1,1]
  v_pk_fma_f32 v[22:23], v[70:71], v[78:79], v[22:23] op_sel_hi:[0,1,1]
  v_mul_f32 v86, s98, v71
  v_pk_mul_f32 v[20:21], v[20:21], v[86:87] op_sel_hi:[1,0]
  v_pk_mul_f32 v[22:23], v[22:23], v[86:87] op_sel_hi:[1,0]
  v_cvt_pk_bf16_f32 v20, v20, v21
  v_cvt_pk_bf16_f32 v21, v22, v23
  v_pk_fma_f32 v[24:25], v[72:73], v[76:77], v[24:25] op_sel_hi:[0,1,1]
  v_pk_fma_f32 v[26:27], v[72:73], v[78:79], v[26:27] op_sel_hi:[0,1,1]
  v_mul_f32 v86, s98, v73
  s_add_u32 s32, s60, 18874368
  buffer_load_dwordx4 v[88:91], v2, s[8:11], s32 offen offset:0 sc1
  v_pk_mul_f32 v[24:25], v[24:25], v[86:87] op_sel_hi:[1,0]
  v_pk_mul_f32 v[26:27], v[26:27], v[86:87] op_sel_hi:[1,0]
  v_cvt_pk_bf16_f32 v24, v24, v25
  v_cvt_pk_bf16_f32 v25, v26, v27
  v_pk_fma_f32 v[28:29], v[68:69], v[80:81], v[28:29] op_sel_hi:[0,1,1]
  v_pk_fma_f32 v[30:31], v[68:69], v[82:83], v[30:31] op_sel_hi:[0,1,1]
  v_pk_mul_f32 v[28:29], v[28:29], v[68:69] op_sel:[0,1] op_sel_hi:[1,1]
  v_pk_mul_f32 v[30:31], v[30:31], v[68:69] op_sel:[0,1] op_sel_hi:[1,1]
  v_cvt_pk_bf16_f32 v28, v28, v29
  v_cvt_pk_bf16_f32 v29, v30, v31
  s_add_u32 s32, s60, 18874368
  buffer_load_dwordx4 v[92:95], v2, s[8:11], s32 offen offset:1024 sc1
  v_pk_fma_f32 v[32:33], v[70:71], v[80:81], v[32:33] op_sel_hi:[0,1,1]
  v_pk_fma_f32 v[34:35], v[70:71], v[82:83], v[34:35] op_sel_hi:[0,1,1]
  v_pk_mul_f32 v[32:33], v[32:33], v[70:71] op_sel:[0,1] op_sel_hi:[1,1]
  v_pk_mul_f32 v[34:35], v[34:35], v[70:71] op_sel:[0,1] op_sel_hi:[1,1]
  v_cvt_pk_bf16_f32 v32, v32, v33
  v_cvt_pk_bf16_f32 v33, v34, v35
  v_pk_fma_f32 v[36:37], v[72:73], v[80:81], v[36:37] op_sel_hi:[0,1,1]
  v_pk_fma_f32 v[38:39], v[72:73], v[82:83], v[38:39] op_sel_hi:[0,1,1]
  v_pk_mul_f32 v[36:37], v[36:37], v[72:73] op_sel:[0,1] op_sel_hi:[1,1]
  v_pk_mul_f32 v[38:39], v[38:39], v[72:73] op_sel:[0,1] op_sel_hi:[1,1]
  s_add_u32 s32, s60, 18874368
  buffer_load_dwordx4 v[96:99], v2, s[8:11], s32 offen offset:2048 sc1
  v_cvt_pk_bf16_f32 v36, v36, v37
  v_cvt_pk_bf16_f32 v37, v38, v39
  v_add_u32 v138, 151552, v2
  ds_read_b128 v[68:71], v17
  ds_read_b128 v[72:75], v138 offset:1024
  ds_read_b128 v[76:79], v138 offset:0
  v_pk_fma_f32 v[40:41], v[52:53], v[84:85], v[40:41] op_sel_hi:[1,0,1]
  v_pk_fma_f32 v[42:43], v[54:55], v[84:85], v[42:43] op_sel_hi:[1,0,1]
  v_pk_mul_f32 v[40:41], v[40:41], v[56:57]
  v_pk_mul_f32 v[42:43], v[42:43], v[58:59]
  ds_read_b128 v[52:55], v14 offset:1152
  ds_read_b128 v[56:59], v14 offset:1408
  v_cvt_pk_bf16_f32 v40, v40, v41
  v_cvt_pk_bf16_f32 v41, v42, v43
  v_pk_fma_f32 v[44:45], v[60:61], v[84:85], v[44:45] op_sel_hi:[1,0,1]
  s_add_u32 s32, s60, 18874368
  buffer_load_dwordx4 v[100:103], v2, s[8:11], s32 offen offset:3072 sc1
  v_pk_fma_f32 v[46:47], v[62:63], v[84:85], v[46:47] op_sel_hi:[1,0,1]
  v_pk_mul_f32 v[44:45], v[44:45], v[64:65]
  v_pk_mul_f32 v[46:47], v[46:47], v[66:67]
  v_cvt_pk_bf16_f32 v44, v44, v45
  v_cvt_pk_bf16_f32 v45, v46, v47
  s_waitcnt lgkmcnt(1)
  v_pk_fma_f32 v[48:49], v[52:53], v[84:85], v[48:49] op_sel_hi:[1,0,1]
  v_pk_fma_f32 v[50:51], v[54:55], v[84:85], v[50:51] op_sel_hi:[1,0,1]
  s_waitcnt lgkmcnt(0)
  v_pk_mul_f32 v[48:49], v[48:49], v[56:57]
  v_pk_mul_f32 v[50:51], v[50:51], v[58:59]
  v_cvt_pk_bf16_f32 v48, v48, v49
  s_add_u32 s32, s47, 8388608
  buffer_load_dwordx4 v[140:143], v2, s[8:11], s32 offen sc1
  v_cvt_pk_bf16_f32 v49, v50, v51
  v_mfma_f32_16x16x16_bf16 v[52:55], v[28:29], v[20:21], v[68:71]
  v_mfma_f32_16x16x16_bf16 v[56:59], v[32:33], v[20:21], v[76:79]
  v_mfma_f32_16x16x16_bf16 v[60:63], v[32:33], v[24:25], v[72:75]
  v_mfma_f32_16x16x16_bf16 v[64:67], v[36:37], v[24:25], v[76:79]
  s_nop 4
  v_max3_f32 v80, v52, v53, v54
  v_max3_f32 v81, v55, v56, v57
  v_max3_f32 v80, v80, v58, v59
  v_max_f32 v80, v80, v81
  v_max3_f32 v84, v60, v61, v62
  s_add_u32 s32, s46, 18874368
  buffer_load_dwordx4 v[104:107], v2, s[8:11], s32 offen offset:0 sc1
  v_max3_f32 v85, v63, v64, v65
  v_max3_f32 v84, v84, v66, v67
  v_max_f32 v84, v84, v85
  v_mov_b32 v81, v80
  v_mov_b32 v85, v84
  s_nop 0
  v_permlane16_swap_b32 v80, v81
  v_permlane16_swap_b32 v84, v85
  v_max_f32 v80, v80, v81
  v_max_f32 v84, v84, v85
  v_mov_b32 v81, v80
  s_add_u32 s32, s46, 18874368
  buffer_load_dwordx4 v[108:111], v2, s[8:11], s32 offen offset:1024 sc1
  v_mov_b32 v85, v84
  v_permlane32_swap_b32 v80, v81
  s_nop 0
  v_permlane32_swap_b32 v84, v85
  v_max_f32 v80, v80, v81
  v_max_f32 v84, v84, v85
  v_pk_add_f32 v[52:53], v[52:53], v[80:81] op_sel_hi:[1,0] neg_lo:[0,1] neg_hi:[0,1]
  v_pk_add_f32 v[54:55], v[54:55], v[80:81] op_sel_hi:[1,0] neg_lo:[0,1] neg_hi:[0,1]
  v_pk_add_f32 v[56:57], v[56:57], v[80:81] op_sel_hi:[1,0] neg_lo:[0,1] neg_hi:[0,1]
  v_pk_add_f32 v[58:59], v[58:59], v[80:81] op_sel_hi:[1,0] neg_lo:[0,1] neg_hi:[0,1]
  v_pk_add_f32 v[60:61], v[60:61], v[84:85] op_sel_hi:[1,0] neg_lo:[0,1] neg_hi:[0,1]
  s_add_u32 s32, s46, 18874368
  buffer_load_dwordx4 v[112:115], v2, s[8:11], s32 offen offset:2048 sc1
  v_pk_add_f32 v[62:63], v[62:63], v[84:85] op_sel_hi:[1,0] neg_lo:[0,1] neg_hi:[0,1]
  v_pk_add_f32 v[64:65], v[64:65], v[84:85] op_sel_hi:[1,0] neg_lo:[0,1] neg_hi:[0,1]
  v_pk_add_f32 v[66:67], v[66:67], v[84:85] op_sel_hi:[1,0] neg_lo:[0,1] neg_hi:[0,1]
  v_exp_f32 v52, v52
  v_exp_f32 v56, v56
  v_exp_f32 v53, v53
  v_exp_f32 v57, v57
  v_exp_f32 v54, v54
  v_exp_f32 v58, v58
  v_exp_f32 v55, v55
  s_add_u32 s32, s46, 18874368
  buffer_load_dwordx4 v[116:119], v2, s[8:11], s32 offen offset:3072 sc1
  v_exp_f32 v59, v59
  v_exp_f32 v60, v60
  v_exp_f32 v64, v64
  v_exp_f32 v61, v61
  v_exp_f32 v65, v65
  v_exp_f32 v62, v62
  v_exp_f32 v66, v66
  v_exp_f32 v63, v63
  v_exp_f32 v67, v67
  v_mov_b32 v76, 0x3f803f80
  s_add_u32 s49, s43, 0
  buffer_load_dwordx4 a[0:3], v2, s[8:11], s49 offen offset:0
  v_mov_b32 v77, 0x3f803f80
  v_cvt_pk_bf16_f32 v52, v52, v53
  v_cvt_pk_bf16_f32 v53, v54, v55
  v_cvt_pk_bf16_f32 v56, v56, v57
  v_cvt_pk_bf16_f32 v57, v58, v59
  v_cvt_pk_bf16_f32 v60, v60, v61
  v_cvt_pk_bf16_f32 v61, v62, v63
  v_cvt_pk_bf16_f32 v64, v64, v65
  v_cvt_pk_bf16_f32 v65, v66, v67
  v_mfma_f32_16x16x16_bf16 v[80:83], v[76:77], v[52:53], 0
  buffer_load_dwordx4 a[4:7], v2, s[8:11], s49 offen offset:1024
  v_mfma_f32_16x16x16_bf16 v[84:87], v[76:77], v[60:61], 0
  v_mfma_f32_16x16x16_bf16 v[20:23], v[40:41], v[52:53], 0
  v_mfma_f32_16x16x16_bf16 v[24:27], v[44:45], v[60:61], 0
  v_mfma_f32_16x16x16_bf16 v[80:83], v[76:77], v[56:57], v[80:83]
  v_mfma_f32_16x16x16_bf16 v[84:87], v[76:77], v[64:65], v[84:87]
  v_mfma_f32_16x16x16_bf16 v[20:23], v[44:45], v[56:57], v[20:23]
  v_mfma_f32_16x16x16_bf16 v[24:27], v[48:49], v[64:65], v[24:27]
  s_nop 4
  v_rcp_f32 v80, v80
  v_rcp_f32 v84, v84
  v_pk_mul_f32 v[20:21], v[20:21], v[80:81] op_sel_hi:[1,0]
  buffer_load_dwordx4 a[8:11], v2, s[8:11], s49 offen offset:2048
  v_pk_mul_f32 v[22:23], v[22:23], v[80:81] op_sel_hi:[1,0]
  v_pk_mul_f32 v[24:25], v[24:25], v[84:85] op_sel_hi:[1,0]
  v_pk_mul_f32 v[26:27], v[26:27], v[84:85] op_sel_hi:[1,0]
  v_cvt_pk_bf16_f32 v20, v20, v21
  v_cvt_pk_bf16_f32 v21, v22, v23
  v_cvt_pk_bf16_f32 v22, v24, v25
  v_cvt_pk_bf16_f32 v23, v26, v27
  s_nop 0
  v_permlane16_swap_b32 v20, v22
  v_permlane16_swap_b32 v21, v23
  s_add_u32 s58, s45, 19922944
  buffer_store_dwordx4 v[20:23], v4, s[8:11], s58 offen sc1
  v_add_f32 v144, v144, v145
  v_add_f32 v146, v146, v147
  v_add_f32 v144, v144, v146
  v_add_f32 v148, v148, v149
  v_add_f32 v150, v150, v151
  v_add_f32 v148, v148, v150
  v_add_f32 v152, v152, v153
  v_add_f32 v154, v154, v155
  v_add_f32 v152, v152, v154
  v_mov_b32 v145, v144
  v_mov_b32 v149, v148
  v_mov_b32 v153, v152
  v_permlane16_swap_b32 v144, v145
  v_permlane16_swap_b32 v148, v149
  v_permlane16_swap_b32 v152, v153
  v_add_f32 v144, v144, v145
  v_add_f32 v148, v148, v149
  v_add_f32 v152, v152, v153
  v_mov_b32 v145, v144
  v_mov_b32 v149, v148
  v_mov_b32 v153, v152
  v_permlane32_swap_b32 v144, v145
  v_permlane32_swap_b32 v148, v149
  v_permlane32_swap_b32 v152, v153
  v_add_f32 v144, v144, v145
  v_add_f32 v148, v148, v149
  v_add_f32 v152, v152, v153
  v_and_b32 v154, 0xf0, v2
  v_lshrrev_b32 v154, 2, v154
  s_mul_i32 s59, s16, 192
  s_add_u32 s59, s59, 149504
  v_add_u32 v154, s59, v154
  ds_write_b32 v154, v144 offset:768
  ds_write_b32 v154, v148 offset:832
  ds_write_b32 v154, v152 offset:896
  s_waitcnt vmcnt(12)
  v_mfma_f32_16x16x32_bf16 v[36:39], a[192:195], v[88:91], 0
  buffer_load_dwordx4 a[12:15], v2, s[8:11], s49 offen offset:3072
  v_mfma_f32_16x16x32_bf16 v[40:43], a[196:199], v[88:91], 0
  v_mfma_f32_16x16x32_bf16 v[44:47], a[200:203], v[88:91], 0
  v_mfma_f32_16x16x32_bf16 v[48:51], a[204:207], v[88:91], 0
  s_add_u32 s49, s43, 4096
  s_waitcnt vmcnt(12)
  v_mfma_f32_16x16x32_bf16 v[36:39], a[208:211], v[92:95], v[36:39]
  buffer_load_dwordx4 a[16:19], v2, s[8:11], s49 offen offset:0
  v_mfma_f32_16x16x32_bf16 v[40:43], a[212:215], v[92:95], v[40:43]
  v_mfma_f32_16x16x32_bf16 v[44:47], a[216:219], v[92:95], v[44:47]
  v_mfma_f32_16x16x32_bf16 v[48:51], a[220:223], v[92:95], v[48:51]
  s_waitcnt vmcnt(12)
  v_mfma_f32_16x16x32_bf16 v[36:39], a[224:227], v[96:99], v[36:39]
  buffer_load_dwordx4 a[20:23], v2, s[8:11], s49 offen offset:1024
  v_mfma_f32_16x16x32_bf16 v[40:43], a[228:231], v[96:99], v[40:43]
  v_mfma_f32_16x16x32_bf16 v[44:47], a[232:235], v[96:99], v[44:47]
  v_mfma_f32_16x16x32_bf16 v[48:51], a[236:239], v[96:99], v[48:51]
  s_waitcnt vmcnt(12)
  v_mfma_f32_16x16x32_bf16 v[36:39], a[240:243], v[100:103], v[36:39]
  buffer_load_dwordx4 a[24:27], v2, s[8:11], s49 offen offset:2048
  v_mfma_f32_16x16x32_bf16 v[40:43], a[244:247], v[100:103], v[40:43]
  v_mfma_f32_16x16x32_bf16 v[44:47], a[248:251], v[100:103], v[44:47]
  v_mfma_f32_16x16x32_bf16 v[48:51], a[252:255], v[100:103], v[48:51]
  s_waitcnt vmcnt(11)
  v_mfma_f32_16x16x32_bf16 v[28:31], a[200:203], v[104:107], 0
  buffer_load_dwordx4 a[28:31], v2, s[8:11], s49 offen offset:3072
  v_mfma_f32_16x16x32_bf16 v[32:35], a[204:207], v[104:107], 0
  s_waitcnt vmcnt(11)
  v_mfma_f32_16x16x32_bf16 v[28:31], a[216:219], v[108:111], v[28:31]
  v_mfma_f32_16x16x32_bf16 v[32:35], a[220:223], v[108:111], v[32:35]
  s_add_u32 s49, s43, 8192
  s_waitcnt vmcnt(10)
  v_mfma_f32_16x16x32_bf16 v[28:31], a[232:235], v[112:115], v[28:31]
  buffer_load_dwordx4 a[32:35], v2, s[8:11], s49 offen offset:0
  v_mfma_f32_16x16x32_bf16 v[32:35], a[236:239], v[112:115], v[32:35]
  s_waitcnt vmcnt(10)
  v_mfma_f32_16x16x32_bf16 v[28:31], a[248:251], v[116:119], v[28:31]
  v_mfma_f32_16x16x32_bf16 v[32:35], a[252:255], v[116:119], v[32:35]
  v_mfma_f32_16x16x32_bf16 v[20:23], a[192:195], v[104:107], 0
  buffer_load_dwordx4 a[36:39], v2, s[8:11], s49 offen offset:1024
  v_mfma_f32_16x16x32_bf16 v[24:27], a[196:199], v[104:107], 0
  v_xor_b32 v137, 16384, v7
  v_xor_b32 v138, 24576, v7
  v_mfma_f32_16x16x32_bf16 v[20:23], a[208:211], v[108:111], v[20:23]
  ds_write_b128 v137, v[36:39] offset:4096
  ds_write_b128 v137, v[40:43] offset:5120
  v_mfma_f32_16x16x32_bf16 v[24:27], a[212:215], v[108:111], v[24:27]
  ds_write_b128 v138, v[44:47] offset:6144
  ds_write_b128 v138, v[48:51] offset:7168
  v_mfma_f32_16x16x32_bf16 v[20:23], a[224:227], v[112:115], v[20:23]
  buffer_load_dwordx4 a[40:43], v2, s[8:11], s49 offen offset:2048
  v_mfma_f32_16x16x32_bf16 v[24:27], a[228:231], v[112:115], v[24:27]
  v_mfma_f32_16x16x32_bf16 v[20:23], a[240:243], v[116:119], v[20:23]
  v_mfma_f32_16x16x32_bf16 v[24:27], a[244:247], v[116:119], v[24:27]
  buffer_load_dwordx4 a[44:47], v2, s[8:11], s49 offen offset:3072
  v_xor_b32 v136, 8192, v7
  ds_write_b128 v136, v[28:31] offset:2048
  ds_write_b128 v136, v[32:35] offset:3072
  s_waitcnt lgkmcnt(0)
  s_barrier
  ds_read_b128 v[28:31], v7 offset:2048
  ds_read_b128 v[32:35], v7 offset:3072
  ds_read_b128 v[36:39], v7 offset:4096
  ds_read_b128 v[40:43], v7 offset:5120
  ds_read_b128 v[44:47], v7 offset:6144
  ds_read_b128 v[48:51], v7 offset:7168
  v_lshlrev_b32 v52, 16, v140
  v_and_b32 v53, 0xffff0000, v140
  v_lshlrev_b32 v54, 16, v141
  v_and_b32 v55, 0xffff0000, v141
  v_lshlrev_b32 v56, 16, v142
  v_and_b32 v57, 0xffff0000, v142
  v_lshlrev_b32 v58, 16, v143
  v_and_b32 v59, 0xffff0000, v143
  v_pk_add_f32 v[20:21], v[20:21], v[52:53]
  v_pk_add_f32 v[22:23], v[22:23], v[54:55]
  v_pk_add_f32 v[24:25], v[24:25], v[56:57]
  v_pk_add_f32 v[26:27], v[26:27], v[58:59]
  s_waitcnt lgkmcnt(5)
  v_pk_add_f32 v[20:21], v[20:21], v[28:29]
  v_pk_add_f32 v[22:23], v[22:23], v[30:31]
  s_waitcnt lgkmcnt(4)
  v_pk_add_f32 v[24:25], v[24:25], v[32:33]
  v_pk_add_f32 v[26:27], v[26:27], v[34:35]
  s_waitcnt lgkmcnt(3)
  v_pk_add_f32 v[20:21], v[20:21], v[36:37]
  v_pk_add_f32 v[22:23], v[22:23], v[38:39]
  s_waitcnt lgkmcnt(2)
  v_pk_add_f32 v[24:25], v[24:25], v[40:41]
  v_pk_add_f32 v[26:27], v[26:27], v[42:43]
  s_waitcnt lgkmcnt(1)
  v_pk_add_f32 v[20:21], v[20:21], v[44:45]
  v_pk_add_f32 v[22:23], v[22:23], v[46:47]
  s_waitcnt lgkmcnt(0)
  v_pk_add_f32 v[24:25], v[24:25], v[48:49]
  v_pk_add_f32 v[26:27], v[26:27], v[50:51]
  v_cvt_pk_bf16_f32 v60, v20, v21
  v_cvt_pk_bf16_f32 v61, v22, v23
  v_cvt_pk_bf16_f32 v62, v24, v25
  v_cvt_pk_bf16_f32 v63, v26, v27
  s_add_u32 s58, s47, 10485760
  buffer_store_dwordx4 v[60:63], v2, s[8:11], s58 offen sc1
  s_waitcnt vmcnt(10)
  s_barrier
  s_add_u32 s34, s50, 8265728
  s_cmp_eq_u32 s7, 1
  s_cbranch_scc1 IMP_1
  buffer_store_dword v18, v1, s[8:11], s34 offen
IMPB_1:
  v_pk_add_f32 v[52:53], v[20:21], v[22:23]
  v_pk_add_f32 v[54:55], v[24:25], v[26:27]
  v_pk_mul_f32 v[56:57], v[20:21], v[20:21]
  v_pk_add_f32 v[52:53], v[52:53], v[54:55]
  v_pk_fma_f32 v[56:57], v[22:23], v[22:23], v[56:57]
  v_pk_fma_f32 v[56:57], v[24:25], v[24:25], v[56:57]
  v_pk_fma_f32 v[56:57], v[26:27], v[26:27], v[56:57]
  v_add_f32 v52, v52, v53
  v_add_f32 v53, v56, v57
  s_nop 1
  v_permlane16_swap_b32 v52, v53
  v_add_f32 v52, v52, v53
  v_mov_b32 v53, v52
  s_nop 1
  v_permlane32_swap_b32 v52, v53
  v_add_f32 v52, v52, v53
  s_add_u32 s58, s57, 17039360
  v_lshrrev_b32 v54, 2, v2
  s_mov_b32 exec_hi, 0
  buffer_store_dword v52, v54, s[8:11], s58 offen sc1
  s_mov_b32 exec_hi, -1
  s_add_u32 s35, s52, 8265728
  buffer_load_dword v19, v9, s[8:11], s35 offen sc1
  s_add_u32 s49, s43, 12288
  buffer_load_dwordx4 a[48:51], v2, s[8:11], s49 offen offset:0
  buffer_load_dwordx4 a[52:55], v2, s[8:11], s49 offen offset:1024
  buffer_load_dwordx4 a[56:59], v2, s[8:11], s49 offen offset:2048
  buffer_load_dwordx4 a[60:63], v2, s[8:11], s49 offen offset:3072
  s_add_u32 s49, s43, 16384
  buffer_load_dwordx4 a[64:67], v2, s[8:11], s49 offen offset:0
  buffer_load_dwordx4 a[68:71], v2, s[8:11], s49 offen offset:1024
  s_waitcnt vmcnt(7)
  s_barrier
  s_add_u32 s34, s50, 8273920
  s_cmp_eq_u32 s7, 1
  s_cbranch_scc1 IMP_2
  buffer_store_dword v18, v1, s[8:11], s34 offen
IMPB_2:
  s_add_u32 s62, s53, 8273920
  buffer_load_dword v139, v8, s[8:11], s62 offen sc1
  s_waitcnt vmcnt(8)
  v_cmp_ne_u32 vcc, s61, v19
  s_nop 0
  s_and_b64 vcc, vcc, s[28:29]
  s_cbranch_vccnz SLOW_4
BACK_4:
  s_barrier
  s_add_u32 s32, s60, 19922944
  buffer_load_dwordx4 v[88:91], v2, s[8:11], s32 offen offset:0 sc1
  s_add_u32 s32, s60, 19922944
  buffer_load_dwordx4 v[92:95], v2, s[8:11], s32 offen offset:1024 sc1
  s_add_u32 s32, s60, 19922944
  buffer_load_dwordx4 v[96:99], v2, s[8:11], s32 offen offset:2048 sc1
  s_add_u32 s32, s60, 19922944
  buffer_load_dwordx4 v[100:103], v2, s[8:11], s32 offen offset:3072 sc1
  s_add_u32 s32, s47, 9437184
  buffer_load_dwordx4 v[140:143], v2, s[8:11], s32 offen sc1
  s_add_u32 s32, s46, 19922944
  buffer_load_dwordx4 v[104:107], v2, s[8:11], s32 offen offset:0 sc1
  s_add_u32 s32, s46, 19922944
  buffer_load_dwordx4 v[108:111], v2, s[8:11], s32 offen offset:1024 sc1
  s_add_u32 s32, s46, 19922944
  buffer_load_dwordx4 v[112:115], v2, s[8:11], s32 offen offset:2048 sc1
  s_add_u32 s32, s46, 19922944
  buffer_load_dwordx4 v[116:119], v2, s[8:11], s32 offen offset:3072 sc1
  buffer_load_dwordx4 a[72:75], v2, s[8:11], s49 offen offset:2048
  buffer_load_dwordx4 a[76:79], v2, s[8:11], s49 offen offset:3072
  s_add_u32 s49, s43, 20480
  buffer_load_dwordx4 a[80:83], v2, s[8:11], s49 offen offset:0
  buffer_load_dwordx4 a[84:87], v2, s[8:11], s49 offen offset:1024
  buffer_load_dwordx4 a[88:91], v2, s[8:11], s49 offen offset:2048
  buffer_load_dwordx4 a[92:95], v2, s[8:11], s49 offen offset:3072
  s_add_u32 s49, s43, 24576
  buffer_load_dwordx4 a[96:99], v2, s[8:11], s49 offen offset:0
  buffer_load_dwordx4 a[100:103], v2, s[8:11], s49 offen offset:1024
  s_waitcnt vmcnt(16)
  v_mfma_f32_16x16x32_bf16 v[36:39], a[192:195], v[88:91], 0
  v_cmp_ne_u32 vcc, s61, v139
  s_nop 0
  s_and_b64 vcc, vcc, s[100:101]
  v_mfma_f32_16x16x32_bf16 v[40:43], a[196:199], v[88:91], 0
  s_cbranch_vccnz SLOW_5
BACK_5:
  s_barrier
  v_mfma_f32_16x16x32_bf16 v[44:47], a[200:203], v[88:91], 0
  buffer_load_dwordx4 a[104:107], v2, s[8:11], s49 offen offset:2048
  v_mfma_f32_16x16x32_bf16 v[48:51], a[204:207], v[88:91], 0
  s_waitcnt vmcnt(16)
  v_mfma_f32_16x16x32_bf16 v[36:39], a[208:211], v[92:95], v[36:39]
  v_mfma_f32_16x16x32_bf16 v[40:43], a[212:215], v[92:95], v[40:43]
  s_add_u32 m0, s27, 0
  s_add_u32 s32, s67, 10485760
  v_mfma_f32_16x16x32_bf16 v[44:47], a[216:219], v[92:95], v[44:47]
  buffer_load_dwordx4 v2, s[8:11], s32 offen sc1 lds
  v_mfma_f32_16x16x32_bf16 v[48:51], a[220:223], v[92:95], v[48:51]
  s_waitcnt vmcnt(16)
  v_mfma_f32_16x16x32_bf16 v[36:39], a[224:227], v[96:99], v[36:39]
  v_mfma_f32_16x16x32_bf16 v[40:43], a[228:231], v[96:99], v[40:43]
  s_add_u32 m0, s27, 16384
  s_add_u32 s32, s67, 10502144
  v_mfma_f32_16x16x32_bf16 v[44:47], a[232:235], v[96:99], v[44:47]
  buffer_load_dwordx4 v2, s[8:11], s32 offen sc1 lds
  v_mfma_f32_16x16x32_bf16 v[48:51], a[236:239], v[96:99], v[48:51]
  s_waitcnt vmcnt(16)
  v_mfma_f32_16x16x32_bf16 v[36:39], a[240:243], v[100:103], v[36:39]
  v_mfma_f32_16x16x32_bf16 v[40:43], a[244:247], v[100:103], v[40:43]
  s_add_u32 m0, s27, 32768
  s_add_u32 s32, s67, 10518528
  v_mfma_f32_16x16x32_bf16 v[44:47], a[248:251], v[100:103], v[44:47]
  buffer_load_dwordx4 v2, s[8:11], s32 offen sc1 lds
  v_mfma_f32_16x16x32_bf16 v[48:51], a[252:255], v[100:103], v[48:51]
  s_waitcnt vmcnt(15)
  v_mfma_f32_16x16x32_bf16 v[28:31], a[200:203], v[104:107], 0
  v_mfma_f32_16x16x32_bf16 v[32:35], a[204:207], v[104:107], 0
  s_add_u32 m0, s27, 49152
  s_add_u32 s32, s67, 10534912
  s_waitcnt vmcnt(14)
  v_mfma_f32_16x16x32_bf16 v[28:31], a[216:219], v[108:111], v[28:31]
  buffer_load_dwordx4 v2, s[8:11], s32 offen sc1 lds
  v_mfma_f32_16x16x32_bf16 v[32:35], a[220:223], v[108:111], v[32:35]
  s_waitcnt vmcnt(14)
  v_mfma_f32_16x16x32_bf16 v[28:31], a[232:235], v[112:115], v[28:31]
  v_mfma_f32_16x16x32_bf16 v[32:35], a[236:239], v[112:115], v[32:35]
  s_lshl_b32 s33, s16, 11
  s_add_u32 m0, s33, 131072
  s_add_u32 s32, s26, 17039360
  s_waitcnt vmcnt(13)
  v_mfma_f32_16x16x32_bf16 v[28:31], a[248:251], v[116:119], v[28:31]
  buffer_load_dwordx4 v2, s[8:11], s32 offen offset:0 sc1 lds
  v_mfma_f32_16x16x32_bf16 v[32:35], a[252:255], v[116:119], v[32:35]
  v_mfma_f32_16x16x32_bf16 v[20:23], a[192:195], v[104:107], 0
  v_mfma_f32_16x16x32_bf16 v[24:27], a[196:199], v[104:107], 0
  v_xor_b32 v137, 16384, v7
  v_xor_b32 v138, 24576, v7
  v_mfma_f32_16x16x32_bf16 v[20:23], a[208:211], v[108:111], v[20:23]
  ds_write_b128 v137, v[36:39] offset:36864
  ds_write_b128 v137, v[40:43] offset:37888
  v_mfma_f32_16x16x32_bf16 v[24:27], a[212:215], v[108:111], v[24:27]
  ds_write_b128 v138, v[44:47] offset:38912
  ds_write_b128 v138, v[48:51] offset:39936
  v_mfma_f32_16x16x32_bf16 v[20:23], a[224:227], v[112:115], v[20:23]
  s_lshl_b32 s33, s16, 11
  s_add_u32 m0, s33, 131072
  s_add_u32 s32, s26, 17039360
  v_mfma_f32_16x16x32_bf16 v[24:27], a[228:231], v[112:115], v[24:27]
  buffer_load_dwordx4 v2, s[8:11], s32 offen offset:1024 sc1 lds
  v_mfma_f32_16x16x32_bf16 v[20:23], a[240:243], v[116:119], v[20:23]
  v_mfma_f32_16x16x32_bf16 v[24:27], a[244:247], v[116:119], v[24:27]
  v_xor_b32 v136, 8192, v7
  ds_write_b128 v136, v[28:31] offset:34816
  ds_write_b128 v136, v[32:35] offset:35840
  s_waitcnt lgkmcnt(0)
  s_barrier
  ds_read_b128 v[28:31], v7 offset:34816
  ds_read_b128 v[32:35], v7 offset:35840
  ds_read_b128 v[36:39], v7 offset:36864
  ds_read_b128 v[40:43], v7 offset:37888
  ds_read_b128 v[44:47], v7 offset:38912
  ds_read_b128 v[48:51], v7 offset:39936
  v_lshlrev_b32 v52, 16, v140
  v_and_b32 v53, 0xffff0000, v140
  v_lshlrev_b32 v54, 16, v141
  v_and_b32 v55, 0xffff0000, v141
  s_add_u32 m0, s27, 4096
  s_add_u32 s32, s67, 10489856
  buffer_load_dwordx4 v2, s[8:11], s32 offen sc1 lds
  v_lshlrev_b32 v56, 16, v142
  v_and_b32 v57, 0xffff0000, v142
  v_lshlrev_b32 v58, 16, v143
  v_and_b32 v59, 0xffff0000, v143
  v_pk_add_f32 v[20:21], v[20:21], v[52:53]
  s_add_u32 m0, s27, 20480
  s_add_u32 s32, s67, 10506240
  buffer_load_dwordx4 v2, s[8:11], s32 offen sc1 lds
  v_pk_add_f32 v[22:23], v[22:23], v[54:55]
  v_pk_add_f32 v[24:25], v[24:25], v[56:57]
  v_pk_add_f32 v[26:27], v[26:27], v[58:59]
  s_waitcnt lgkmcnt(5)
  v_pk_add_f32 v[20:21], v[20:21], v[28:29]
  v_pk_add_f32 v[22:23], v[22:23], v[30:31]
  s_add_u32 m0, s27, 36864
  s_add_u32 s32, s67, 10522624
  buffer_load_dwordx4 v2, s[8:11], s32 offen sc1 lds
  s_waitcnt lgkmcnt(4)
  v_pk_add_f32 v[24:25], v[24:25], v[32:33]
  v_pk_add_f32 v[26:27], v[26:27], v[34:35]
  s_waitcnt lgkmcnt(3)
  v_pk_add_f32 v[20:21], v[20:21], v[36:37]
  v_pk_add_f32 v[22:23], v[22:23], v[38:39]
  s_waitcnt lgkmcnt(2)
  v_pk_add_f32 v[24:25], v[24:25], v[40:41]
  s_add_u32 m0, s27, 53248
  s_add_u32 s32, s67, 10539008
  buffer_load_dwordx4 v2, s[8:11], s32 offen sc1 lds
  v_pk_add_f32 v[26:27], v[26:27], v[42:43]
  s_waitcnt lgkmcnt(1)
  v_pk_add_f32 v[20:21], v[20:21], v[44:45]
  v_pk_add_f32 v[22:23], v[22:23], v[46:47]
  s_waitcnt lgkmcnt(0)
  v_pk_add_f32 v[24:25], v[24:25], v[48:49]
  v_pk_add_f32 v[26:27], v[26:27], v[50:51]
  buffer_load_dwordx4 a[108:111], v2, s[8:11], s49 offen offset:3072
  v_cvt_pk_bf16_f32 v60, v20, v21
  v_cvt_pk_bf16_f32 v61, v22, v23
  v_cvt_pk_bf16_f32 v62, v24, v25
  v_cvt_pk_bf16_f32 v63, v26, v27
  s_add_u32 s58, s47, 11534336
  buffer_store_dwordx4 v[60:63], v2, s[8:11], s58 offen sc1
  v_pk_add_f32 v[52:53], v[20:21], v[22:23]
  s_add_u32 s49, s43, 28672
  buffer_load_dwordx4 a[112:115], v2, s[8:11], s49 offen offset:0
  v_pk_add_f32 v[54:55], v[24:25], v[26:27]
  v_pk_mul_f32 v[56:57], v[20:21], v[20:21]
  v_pk_add_f32 v[52:53], v[52:53], v[54:55]
  v_pk_fma_f32 v[56:57], v[22:23], v[22:23], v[56:57]
  v_pk_fma_f32 v[56:57], v[24:25], v[24:25], v[56:57]
  buffer_load_dwordx4 a[116:119], v2, s[8:11], s49 offen offset:1024
  v_pk_fma_f32 v[56:57], v[26:27], v[26:27], v[56:57]
  v_add_f32 v52, v52, v53
  v_add_f32 v53, v56, v57
  s_nop 1
  v_permlane16_swap_b32 v52, v53
  v_add_f32 v52, v52, v53
  buffer_load_dwordx4 a[120:123], v2, s[8:11], s49 offen offset:2048
  v_mov_b32 v53, v52
  s_nop 1
  v_permlane32_swap_b32 v52, v53
  v_add_f32 v52, v52, v53
  s_add_u32 s58, s57, 17170432
  v_lshrrev_b32 v54, 2, v2
  s_mov_b32 exec_hi, 0
  buffer_store_dword v52, v54, s[8:11], s58 offen sc1
  s_mov_b32 exec_hi, -1
  s_waitcnt vmcnt(12)
  s_barrier
  ds_read_b128 v[68:71], v2 offset:0
  ds_read_b128 v[72:75], v2 offset:16384
  ds_read_b128 v[76:79], v2 offset:32768
  ds_read_b128 v[80:83], v2 offset:49152
  ds_read_b128 v[84:87], v2 offset:1024
  s_waitcnt lgkmcnt(4)
  v_mfma_f32_16x16x32_bf16 v[20:23], a[0:3], v[68:71], 0
  s_add_u32 m0, s27, 8192
  s_add_u32 s32, s67, 10493952
  v_mfma_f32_16x16x32_bf16 v[24:27], a[4:7], v[68:71], 0
  buffer_load_dwordx4 v2, s[8:11], s32 offen sc1 lds
  v_mfma_f32_16x16x32_bf16 v[28:31], a[8:11], v[68:71], 0
  ds_read_b128 v[68:71], v2 offset:17408
  s_waitcnt lgkmcnt(4)
  v_mfma_f32_16x16x32_bf16 v[32:35], a[0:3], v[72:75], 0
  v_mfma_f32_16x16x32_bf16 v[36:39], a[4:7], v[72:75], 0
  s_add_u32 m0, s27, 24576
  s_add_u32 s32, s67, 10510336
  v_mfma_f32_16x16x32_bf16 v[40:43], a[8:11], v[72:75], 0
  ds_read_b128 v[72:75], v2 offset:33792
  s_waitcnt lgkmcnt(4)
  v_mfma_f32_16x16x32_bf16 v[44:47], a[0:3], v[76:79], 0
  buffer_load_dwordx4 v2, s[8:11], s32 offen sc1 lds
  v_mfma_f32_16x16x32_bf16 v[48:51], a[4:7], v[76:79], 0
  s_waitcnt vmcnt(12)
  ds_read2_b32 v[88:89], v11 offset0:0 offset1:32
  v_mfma_f32_16x16x32_bf16 v[52:55], a[8:11], v[76:79], 0
  ds_read_b128 v[76:79], v2 offset:50176
  s_waitcnt lgkmcnt(5)
  v_mfma_f32_16x16x32_bf16 v[56:59], a[0:3], v[80:83], 0
  s_add_u32 m0, s27, 40960
  s_add_u32 s32, s67, 10526720
  v_mfma_f32_16x16x32_bf16 v[60:63], a[4:7], v[80:83], 0
  buffer_load_dwordx4 v2, s[8:11], s32 offen sc1 lds
  v_mfma_f32_16x16x32_bf16 v[64:67], a[8:11], v[80:83], 0
  ds_read_b128 v[80:83], v2 offset:2048
  s_waitcnt lgkmcnt(5)
  v_mfma_f32_16x16x32_bf16 v[20:23], a[12:15], v[84:87], v[20:23]
  ds_read2_b32 v[90:91], v11 offset0:64 offset1:96
  ds_read2_b32 v[92:93], v11 offset0:128 offset1:160
  v_mfma_f32_16x16x32_bf16 v[24:27], a[16:19], v[84:87], v[24:27]
  s_add_u32 m0, s27, 57344
  s_add_u32 s32, s67, 10543104
  v_mfma_f32_16x16x32_bf16 v[28:31], a[20:23], v[84:87], v[28:31]
  ds_read_b128 v[84:87], v2 offset:18432
  s_waitcnt lgkmcnt(7)
  v_mfma_f32_16x16x32_bf16 v[32:35], a[12:15], v[68:71], v[32:35]
  buffer_load_dwordx4 v2, s[8:11], s32 offen sc1 lds
  v_mfma_f32_16x16x32_bf16 v[36:39], a[16:19], v[68:71], v[36:39]
  ds_read2_b32 v[94:95], v11 offset0:192 offset1:224
  v_mfma_f32_16x16x32_bf16 v[40:43], a[20:23], v[68:71], v[40:43]
  ds_read_b128 v[68:71], v2 offset:34816
  s_waitcnt lgkmcnt(8)
  v_mfma_f32_16x16x32_bf16 v[44:47], a[12:15], v[72:75], v[44:47]
  s_add_u32 m0, s27, 12288
  s_add_u32 s32, s67, 10498048
  v_mfma_f32_16x16x32_bf16 v[48:51], a[16:19], v[72:75], v[48:51]
  buffer_load_dwordx4 v2, s[8:11], s32 offen sc1 lds
  v_mfma_f32_16x16x32_bf16 v[52:55], a[20:23], v[72:75], v[52:55]
  ds_read_b128 v[72:75], v2 offset:51200
  s_waitcnt lgkmcnt(7)
  v_mfma_f32_16x16x32_bf16 v[56:59], a[12:15], v[76:79], v[56:59]
  v_mfma_f32_16x16x32_bf16 v[60:63], a[16:19], v[76:79], v[60:63]
  s_add_u32 m0, s27, 28672
  s_add_u32 s32, s67, 10514432
  v_mfma_f32_16x16x32_bf16 v[64:67], a[20:23], v[76:79], v[64:67]
  ds_read_b128 v[76:79], v2 offset:3072
  s_waitcnt lgkmcnt(7)
  v_mfma_f32_16x16x32_bf16 v[20:23], a[24:27], v[80:83], v[20:23]
  buffer_load_dwordx4 v2, s[8:11], s32 offen sc1 lds
  v_mfma_f32_16x16x32_bf16 v[24:27], a[28:31], v[80:83], v[24:27]
  v_mfma_f32_16x16x32_bf16 v[28:31], a[32:35], v[80:83], v[28:31]
  ds_read_b128 v[80:83], v2 offset:19456
  s_waitcnt lgkmcnt(5)
  v_mfma_f32_16x16x32_bf16 v[32:35], a[24:27], v[84:87], v[32:35]
  s_add_u32 m0, s27, 45056
  s_add_u32 s32, s67, 10530816
  v_mfma_f32_16x16x32_bf16 v[36:39], a[28:31], v[84:87], v[36:39]
  buffer_load_dwordx4 v2, s[8:11], s32 offen sc1 lds
  v_mfma_f32_16x16x32_bf16 v[40:43], a[32:35], v[84:87], v[40:43]
  ds_read_b128 v[84:87], v2 offset:35840
  s_waitcnt lgkmcnt(4)
  v_mfma_f32_16x16x32_bf16 v[44:47], a[24:27], v[68:71], v[44:47]
  v_add_f32 v88, v88, v89
  v_add_f32 v90, v90, v91
  v_mfma_f32_16x16x32_bf16 v[48:51], a[28:31], v[68:71], v[48:51]
  s_add_u32 m0, s27, 61440
  s_add_u32 s32, s67, 10547200
  v_mfma_f32_16x16x32_bf16 v[52:55], a[32:35], v[68:71], v[52:55]
  ds_read_b128 v[68:71], v2 offset:52224
  s_waitcnt lgkmcnt(4)
  v_mfma_f32_16x16x32_bf16 v[56:59], a[24:27], v[72:75], v[56:59]
  buffer_load_dwordx4 v2, s[8:11], s32 offen sc1 lds
  v_mfma_f32_16x16x32_bf16 v[60:63], a[28:31], v[72:75], v[60:63]
  v_add_f32 v92, v92, v93
  v_add_f32 v94, v94, v95
  v_mfma_f32_16x16x32_bf16 v[64:67], a[32:35], v[72:75], v[64:67]
  s_waitcnt vmcnt(14)
  s_barrier
  ds_read_b128 v[72:75], v2 offset:4096
  s_waitcnt lgkmcnt(4)
  v_mfma_f32_16x16x32_bf16 v[20:23], a[36:39], v[76:79], v[20:23]
  v_add_f32 v88, v88, v90
  v_add_f32 v92, v92, v94
  v_mfma_f32_16x16x32_bf16 v[24:27], a[40:43], v[76:79], v[24:27]
  buffer_load_dwordx4 a[124:127], v2, s[8:11], s49 offen offset:3072
  v_mfma_f32_16x16x32_bf16 v[28:31], a[44:47], v[76:79], v[28:31]
  ds_read_b128 v[76:79], v2 offset:20480
  s_waitcnt lgkmcnt(4)
  v_mfma_f32_16x16x32_bf16 v[32:35], a[36:39], v[80:83], v[32:35]
  v_add_f32 v88, v88, v92
  v_mov_b32 v89, v88
  v_mfma_f32_16x16x32_bf16 v[36:39], a[40:43], v[80:83], v[36:39]
  s_add_u32 s49, s43, 32768
  v_mfma_f32_16x16x32_bf16 v[40:43], a[44:47], v[80:83], v[40:43]
  ds_read_b128 v[80:83], v2 offset:36864
  s_waitcnt lgkmcnt(4)
  v_mfma_f32_16x16x32_bf16 v[44:47], a[36:39], v[84:87], v[44:47]
  buffer_load_dwordx4 a[128:131], v2, s[8:11], s49 offen offset:0
  v_mfma_f32_16x16x32_bf16 v[48:51], a[40:43], v[84:87], v[48:51]
  v_permlane32_swap_b32 v88, v89
  v_mfma_f32_16x16x32_bf16 v[52:55], a[44:47], v[84:87], v[52:55]
  ds_read_b128 v[84:87], v2 offset:53248
  s_waitcnt lgkmcnt(4)
  v_mfma_f32_16x16x32_bf16 v[56:59], a[36:39], v[68:71], v[56:59]
  v_add_f32 v88, v88, v89
  v_mov_b32 v89, v88
  v_mfma_f32_16x16x32_bf16 v[60:63], a[40:43], v[68:71], v[60:63]
  buffer_load_dwordx4 a[132:135], v2, s[8:11], s49 offen offset:1024
  v_mfma_f32_16x16x32_bf16 v[64:67], a[44:47], v[68:71], v[64:67]
  ds_read_b128 v[68:71], v2 offset:5120
  s_waitcnt lgkmcnt(4)
  v_mfma_f32_16x16x32_bf16 v[20:23], a[48:51], v[72:75], v[20:23]
  s_waitcnt vmcnt(11)
  s_barrier
  s_add_u32 s34, s50, 8282112
  v_mfma_f32_16x16x32_bf16 v[24:27], a[52:55], v[72:75], v[24:27]
  s_cmp_eq_u32 s7, 1
  s_cbranch_scc1 IMP_3
  buffer_store_dword v18, v1, s[8:11], s34 offen
IMPB_3:
  v_mfma_f32_16x16x32_bf16 v[28:31], a[56:59], v[72:75], v[28:31]
  ds_read_b128 v[72:75], v2 offset:21504
  s_waitcnt lgkmcnt(4)
  v_mfma_f32_16x16x32_bf16 v[32:35], a[48:51], v[76:79], v[32:35]
  buffer_load_dwordx4 a[136:139], v2, s[8:11], s49 offen offset:2048
  v_mfma_f32_16x16x32_bf16 v[36:39], a[52:55], v[76:79], v[36:39]
  v_permlane16_swap_b32 v88, v89
  v_mfma_f32_16x16x32_bf16 v[40:43], a[56:59], v[76:79], v[40:43]
  ds_read_b128 v[76:79], v2 offset:37888
  s_waitcnt lgkmcnt(4)
  v_mfma_f32_16x16x32_bf16 v[44:47], a[48:51], v[80:83], v[44:47]
  v_mul_f32 v88, 0xbb000000, v88
  v_mul_f32 v90, v88, v88
  v_mfma_f32_16x16x32_bf16 v[48:51], a[52:55], v[80:83], v[48:51]
  buffer_load_dwordx4 a[140:143], v2, s[8:11], s49 offen offset:3072
  v_mfma_f32_16x16x32_bf16 v[52:55], a[56:59], v[80:83], v[52:55]
  ds_read_b128 v[80:83], v2 offset:54272
  s_waitcnt lgkmcnt(4)
  v_mfma_f32_16x16x32_bf16 v[56:59], a[48:51], v[84:87], v[56:59]
  v_fma_f32 v89, v89, s96, -v90
  v_max_f32 v89, 0, v89
  v_mfma_f32_16x16x32_bf16 v[60:63], a[52:55], v[84:87], v[60:63]
  s_add_u32 s49, s43, 36864
  v_add_f32 v89, s97, v89
  v_mfma_f32_16x16x32_bf16 v[64:67], a[56:59], v[84:87], v[64:67]
  ds_read_b128 v[84:87], v2 offset:6144
  s_waitcnt lgkmcnt(4)
  v_mfma_f32_16x16x32_bf16 v[20:23], a[60:63], v[68:71], v[20:23]
  buffer_load_dwordx4 a[144:147], v2, s[8:11], s49 offen offset:0
  v_mfma_f32_16x16x32_bf16 v[24:27], a[64:67], v[68:71], v[24:27]
  v_rsq_f32 v89, v89
  v_mfma_f32_16x16x32_bf16 v[28:31], a[68:71], v[68:71], v[28:31]
  ds_read_b128 v[68:71], v2 offset:22528
  s_waitcnt lgkmcnt(4)
  v_mfma_f32_16x16x32_bf16 v[32:35], a[60:63], v[72:75], v[32:35]
  v_cndmask_b32 v88, v88, v89, s[36:37]
  ds_write_b32 v12, v88 offset:0
  v_mfma_f32_16x16x32_bf16 v[36:39], a[64:67], v[72:75], v[36:39]
  buffer_load_dwordx4 a[148:151], v2, s[8:11], s49 offen offset:1024
  v_mfma_f32_16x16x32_bf16 v[40:43], a[68:71], v[72:75], v[40:43]
  ds_read_b128 v[72:75], v2 offset:38912
  s_waitcnt lgkmcnt(5)
  v_mfma_f32_16x16x32_bf16 v[44:47], a[60:63], v[76:79], v[44:47]
  v_mfma_f32_16x16x32_bf16 v[48:51], a[64:67], v[76:79], v[48:51]
  v_mfma_f32_16x16x32_bf16 v[52:55], a[68:71], v[76:79], v[52:55]
  ds_read_b128 v[76:79], v2 offset:55296
  s_waitcnt lgkmcnt(5)
  v_mfma_f32_16x16x32_bf16 v[56:59], a[60:63], v[80:83], v[56:59]
  buffer_load_dwordx4 a[152:155], v2, s[8:11], s49 offen offset:2048
  v_mfma_f32_16x16x32_bf16 v[60:63], a[64:67], v[80:83], v[60:63]
  v_mfma_f32_16x16x32_bf16 v[64:67], a[68:71], v[80:83], v[64:67]
  ds_read_b128 v[80:83], v2 offset:7168
  s_waitcnt lgkmcnt(5)
  v_mfma_f32_16x16x32_bf16 v[20:23], a[72:75], v[84:87], v[20:23]
  v_mfma_f32_16x16x32_bf16 v[24:27], a[76:79], v[84:87], v[24:27]
  buffer_load_dwordx4 a[156:159], v2, s[8:11], s49 offen offset:3072
  v_mfma_f32_16x16x32_bf16 v[28:31], a[80:83], v[84:87], v[28:31]
  ds_read_b128 v[84:87], v2 offset:23552
  s_waitcnt lgkmcnt(5)
  v_mfma_f32_16x16x32_bf16 v[32:35], a[72:75], v[68:71], v[32:35]
  v_mfma_f32_16x16x32_bf16 v[36:39], a[76:79], v[68:71], v[36:39]
  s_add_u32 s49, s43, 40960
  v_mfma_f32_16x16x32_bf16 v[40:43], a[80:83], v[68:71], v[40:43]
  ds_read_b128 v[68:71], v2 offset:39936
  s_waitcnt lgkmcnt(4)
  v_mfma_f32_16x16x32_bf16 v[44:47], a[72:75], v[72:75], v[44:47]
  buffer_load_dwordx4 a[160:163], v2, s[8:11], s49 offen offset:0
  v_mfma_f32_16x16x32_bf16 v[48:51], a[76:79], v[72:75], v[48:51]
  v_mfma_f32_16x16x32_bf16 v[52:55], a[80:83], v[72:75], v[52:55]
  ds_read_b128 v[72:75], v2 offset:56320
  s_waitcnt lgkmcnt(4)
  v_mfma_f32_16x16x32_bf16 v[56:59], a[72:75], v[76:79], v[56:59]
  v_mfma_f32_16x16x32_bf16 v[60:63], a[76:79], v[76:79], v[60:63]
  buffer_load_dwordx4 a[164:167], v2, s[8:11], s49 offen offset:1024
  v_mfma_f32_16x16x32_bf16 v[64:67], a[80:83], v[76:79], v[64:67]
  s_waitcnt vmcnt(16)
  s_barrier
  ds_read_b128 v[76:79], v2 offset:8192
  s_waitcnt lgkmcnt(4)
  v_mfma_f32_16x16x32_bf16 v[20:23], a[84:87], v[80:83], v[20:23]
  v_mfma_f32_16x16x32_bf16 v[24:27], a[88:91], v[80:83], v[24:27]
  v_mfma_f32_16x16x32_bf16 v[28:31], a[92:95], v[80:83], v[28:31]
  ds_read_b128 v[80:83], v2 offset:24576
  s_waitcnt lgkmcnt(4)
  v_mfma_f32_16x16x32_bf16 v[32:35], a[84:87], v[84:87], v[32:35]
  buffer_load_dwordx4 a[168:171], v2, s[8:11], s49 offen offset:2048
  v_mfma_f32_16x16x32_bf16 v[36:39], a[88:91], v[84:87], v[36:39]
  v_mfma_f32_16x16x32_bf16 v[40:43], a[92:95], v[84:87], v[40:43]
  ds_read_b128 v[84:87], v2 offset:40960
  s_waitcnt lgkmcnt(4)
  v_mfma_f32_16x16x32_bf16 v[44:47], a[84:87], v[68:71], v[44:47]
  v_mfma_f32_16x16x32_bf16 v[48:51], a[88:91], v[68:71], v[48:51]
  buffer_load_dwordx4 a[172:175], v2, s[8:11], s49 offen offset:3072
  v_mfma_f32_16x16x32_bf16 v[52:55], a[92:95], v[68:71], v[52:55]
  ds_read_b128 v[68:71], v2 offset:57344
  s_waitcnt lgkmcnt(4)
  v_mfma_f32_16x16x32_bf16 v[56:59], a[84:87], v[72:75], v[56:59]
  v_mfma_f32_16x16x32_bf16 v[60:63], a[88:91], v[72:75], v[60:63]
  s_add_u32 s49, s43, 45056
  v_mfma_f32_16x16x32_bf16 v[64:67], a[92:95], v[72:75], v[64:67]
  ds_read_b128 v[72:75], v2 offset:9216
  s_waitcnt lgkmcnt(4)
  v_mfma_f32_16x16x32_bf16 v[20:23], a[96:99], v[76:79], v[20:23]
  buffer_load_dwordx4 a[176:179], v2, s[8:11], s49 offen offset:0
  v_mfma_f32_16x16x32_bf16 v[24:27], a[100:103], v[76:79], v[24:27]
  v_mfma_f32_16x16x32_bf16 v[28:31], a[104:107], v[76:79], v[28:31]
  ds_read_b128 v[76:79], v2 offset:25600
  s_waitcnt lgkmcnt(4)
  v_mfma_f32_16x16x32_bf16 v[32:35], a[96:99], v[80:83], v[32:35]
  v_mfma_f32_16x16x32_bf16 v[36:39], a[100:103], v[80:83], v[36:39]
  buffer_load_dwordx4 a[180:183], v2, s[8:11], s49 offen offset:1024
  v_mfma_f32_16x16x32_bf16 v[40:43], a[104:107], v[80:83], v[40:43]
  ds_read_b128 v[80:83], v2 offset:41984
  s_waitcnt lgkmcnt(4)
  v_mfma_f32_16x16x32_bf16 v[44:47], a[96:99], v[84:87], v[44:47]
  v_mfma_f32_16x16x32_bf16 v[48:51], a[100:103], v[84:87], v[48:51]
  v_mfma_f32_16x16x32_bf16 v[52:55], a[104:107], v[84:87], v[52:55]
  ds_read_b128 v[84:87], v2 offset:58368
  s_waitcnt lgkmcnt(4)
  v_mfma_f32_16x16x32_bf16 v[56:59], a[96:99], v[68:71], v[56:59]
  buffer_load_dwordx4 a[184:187], v2, s[8:11], s49 offen offset:2048
  v_mfma_f32_16x16x32_bf16 v[60:63], a[100:103], v[68:71], v[60:63]
  v_mfma_f32_16x16x32_bf16 v[64:67], a[104:107], v[68:71], v[64:67]
  ds_read_b128 v[68:71], v2 offset:10240
  s_waitcnt lgkmcnt(4)
  v_mfma_f32_16x16x32_bf16 v[20:23], a[108:111], v[72:75], v[20:23]
  s_add_u32 s35, s53, 8282112
  v_mfma_f32_16x16x32_bf16 v[24:27], a[112:115], v[72:75], v[24:27]
  buffer_load_dword v19, v8, s[8:11], s35 offen sc1
  v_mfma_f32_16x16x32_bf16 v[28:31], a[116:119], v[72:75], v[28:31]
  ds_read_b128 v[72:75], v2 offset:26624
  s_waitcnt lgkmcnt(4)
  v_mfma_f32_16x16x32_bf16 v[32:35], a[108:111], v[76:79], v[32:35]
  v_mfma_f32_16x16x32_bf16 v[36:39], a[112:115], v[76:79], v[36:39]
  v_mfma_f32_16x16x32_bf16 v[40:43], a[116:119], v[76:79], v[40:43]
  ds_read_b128 v[76:79], v2 offset:43008
  s_waitcnt lgkmcnt(4)
  v_mfma_f32_16x16x32_bf16 v[44:47], a[108:111], v[80:83], v[44:47]
  buffer_load_dwordx4 a[188:191], v2, s[8:11], s49 offen offset:3072
  v_mfma_f32_16x16x32_bf16 v[48:51], a[112:115], v[80:83], v[48:51]
  v_mfma_f32_16x16x32_bf16 v[52:55], a[116:119], v[80:83], v[52:55]
  ds_read_b128 v[80:83], v2 offset:59392
  s_waitcnt lgkmcnt(4)
  v_mfma_f32_16x16x32_bf16 v[56:59], a[108:111], v[84:87], v[56:59]
  s_add_u32 s49, s44, 0
  v_mfma_f32_16x16x32_bf16 v[60:63], a[112:115], v[84:87], v[60:63]
  buffer_load_dwordx4 a[192:195], v2, s[8:11], s49 offen offset:0
  v_mfma_f32_16x16x32_bf16 v[64:67], a[116:119], v[84:87], v[64:67]
  ds_read_b128 v[84:87], v2 offset:11264
  s_waitcnt lgkmcnt(4)
  v_mfma_f32_16x16x32_bf16 v[20:23], a[120:123], v[68:71], v[20:23]
  s_waitcnt vmcnt(19)
  v_mfma_f32_16x16x32_bf16 v[24:27], a[124:127], v[68:71], v[24:27]
  s_waitcnt vmcnt(18)
  v_mfma_f32_16x16x32_bf16 v[28:31], a[128:131], v[68:71], v[28:31]
  ds_read_b128 v[68:71], v2 offset:27648
  s_waitcnt lgkmcnt(4)
  v_mfma_f32_16x16x32_bf16 v[32:35], a[120:123], v[72:75], v[32:35]
  buffer_load_dwordx4 a[196:199], v2, s[8:11], s49 offen offset:1024
  v_mfma_f32_16x16x32_bf16 v[36:39], a[124:127], v[72:75], v[36:39]
  v_mfma_f32_16x16x32_bf16 v[40:43], a[128:131], v[72:75], v[40:43]
  ds_read_b128 v[72:75], v2 offset:44032
  s_waitcnt lgkmcnt(4)
  v_mfma_f32_16x16x32_bf16 v[44:47], a[120:123], v[76:79], v[44:47]
  v_mfma_f32_16x16x32_bf16 v[48:51], a[124:127], v[76:79], v[48:51]
  buffer_load_dwordx4 a[200:203], v2, s[8:11], s49 offen offset:2048
  v_mfma_f32_16x16x32_bf16 v[52:55], a[128:131], v[76:79], v[52:55]
  ds_read_b128 v[76:79], v2 offset:60416
  s_waitcnt lgkmcnt(4)
  v_mfma_f32_16x16x32_bf16 v[56:59], a[120:123], v[80:83], v[56:59]
  v_mfma_f32_16x16x32_bf16 v[60:63], a[124:127], v[80:83], v[60:63]
  v_mfma_f32_16x16x32_bf16 v[64:67], a[128:131], v[80:83], v[64:67]
  s_barrier
  ds_read_b128 v[80:83], v2 offset:12288
  s_waitcnt vmcnt(19) lgkmcnt(4)
  v_mfma_f32_16x16x32_bf16 v[20:23], a[132:135], v[84:87], v[20:23]
  buffer_load_dwordx4 a[204:207], v2, s[8:11], s49 offen offset:3072
  s_waitcnt vmcnt(18)
  v_mfma_f32_16x16x32_bf16 v[24:27], a[136:139], v[84:87], v[24:27]
  s_waitcnt vmcnt(17)
  v_mfma_f32_16x16x32_bf16 v[28:31], a[140:143], v[84:87], v[28:31]
  ds_read_b128 v[84:87], v2 offset:28672
  s_waitcnt lgkmcnt(4)
  v_mfma_f32_16x16x32_bf16 v[32:35], a[132:135], v[68:71], v[32:35]
  s_add_u32 s49, s44, 4096
  v_mfma_f32_16x16x32_bf16 v[36:39], a[136:139], v[68:71], v[36:39]
  buffer_load_dwordx4 a[208:211], v2, s[8:11], s49 offen offset:0
  v_mfma_f32_16x16x32_bf16 v[40:43], a[140:143], v[68:71], v[40:43]
  ds_read_b128 v[68:71], v2 offset:45056
  s_waitcnt lgkmcnt(4)
  v_mfma_f32_16x16x32_bf16 v[44:47], a[132:135], v[72:75], v[44:47]
  v_mfma_f32_16x16x32_bf16 v[48:51], a[136:139], v[72:75], v[48:51]
  v_mfma_f32_16x16x32_bf16 v[52:55], a[140:143], v[72:75], v[52:55]
  ds_read_b128 v[72:75], v2 offset:61440
  s_waitcnt lgkmcnt(4)
  v_mfma_f32_16x16x32_bf16 v[56:59], a[132:135], v[76:79], v[56:59]
  buffer_load_dwordx4 a[212:215], v2, s[8:11], s49 offen offset:1024
  v_mfma_f32_16x16x32_bf16 v[60:63], a[136:139], v[76:79], v[60:63]
  v_mfma_f32_16x16x32_bf16 v[64:67], a[140:143], v[76:79], v[64:67]
  ds_read_b128 v[76:79], v2 offset:13312
  s_waitcnt vmcnt(18) lgkmcnt(4)
  v_mfma_f32_16x16x32_bf16 v[20:23], a[144:147], v[80:83], v[20:23]
  s_waitcnt vmcnt(17)
  v_mfma_f32_16x16x32_bf16 v[24:27], a[148:151], v[80:83], v[24:27]
  buffer_load_dwordx4 a[216:219], v2, s[8:11], s49 offen offset:2048
  s_waitcnt vmcnt(17)
  v_mfma_f32_16x16x32_bf16 v[28:31], a[152:155], v[80:83], v[28:31]
  ds_read_b128 v[80:83], v2 offset:29696
  s_waitcnt lgkmcnt(4)
  v_mfma_f32_16x16x32_bf16 v[32:35], a[144:147], v[84:87], v[32:35]
  v_mfma_f32_16x16x32_bf16 v[36:39], a[148:151], v[84:87], v[36:39]
  v_mfma_f32_16x16x32_bf16 v[40:43], a[152:155], v[84:87], v[40:43]
  ds_read_b128 v[84:87], v2 offset:46080
  s_waitcnt lgkmcnt(4)
  v_mfma_f32_16x16x32_bf16 v[44:47], a[144:147], v[68:71], v[44:47]
  s_waitcnt vmcnt(8)
  v_cmp_ne_u32 vcc, s61, v19
  s_nop 0
  s_and_b64 vcc, vcc, s[100:101]
  v_mfma_f32_16x16x32_bf16 v[48:51], a[148:151], v[68:71], v[48:51]
  s_cbranch_vccnz SLOW_6
BACK_6:
  s_barrier
  v_mfma_f32_16x16x32_bf16 v[52:55], a[152:155], v[68:71], v[52:55]
  ds_read_b128 v[68:71], v2 offset:62464
  s_waitcnt lgkmcnt(4)
  v_mfma_f32_16x16x32_bf16 v[56:59], a[144:147], v[72:75], v[56:59]
  buffer_load_dwordx4 a[220:223], v2, s[8:11], s49 offen offset:3072
  v_mfma_f32_16x16x32_bf16 v[60:63], a[148:151], v[72:75], v[60:63]
  v_mfma_f32_16x16x32_bf16 v[64:67], a[152:155], v[72:75], v[64:67]
  ds_read_b128 v[72:75], v2 offset:14336
  s_waitcnt lgkmcnt(4)
  v_mfma_f32_16x16x32_bf16 v[20:23], a[156:159], v[76:79], v[20:23]
  s_add_u32 m0, s27, 65536
  s_add_u32 s32, s67, 11534336
  v_mfma_f32_16x16x32_bf16 v[24:27], a[160:163], v[76:79], v[24:27]
  buffer_load_dwordx4 v2, s[8:11], s32 offen sc1 lds
  v_mfma_f32_16x16x32_bf16 v[28:31], a[164:167], v[76:79], v[28:31]
  ds_read_b128 v[76:79], v2 offset:30720
  s_waitcnt lgkmcnt(4)
  v_mfma_f32_16x16x32_bf16 v[32:35], a[156:159], v[80:83], v[32:35]
  v_mfma_f32_16x16x32_bf16 v[36:39], a[160:163], v[80:83], v[36:39]
  s_add_u32 m0, s27, 81920
  s_add_u32 s32, s67, 11550720
  v_mfma_f32_16x16x32_bf16 v[40:43], a[164:167], v[80:83], v[40:43]
  ds_read_b128 v[80:83], v2 offset:47104
  s_waitcnt lgkmcnt(4)
  v_mfma_f32_16x16x32_bf16 v[44:47], a[156:159], v[84:87], v[44:47]
  buffer_load_dwordx4 v2, s[8:11], s32 offen sc1 lds
  v_mfma_f32_16x16x32_bf16 v[48:51], a[160:163], v[84:87], v[48:51]
  v_mfma_f32_16x16x32_bf16 v[52:55], a[164:167], v[84:87], v[52:55]
  ds_read_b128 v[84:87], v2 offset:63488
  s_waitcnt lgkmcnt(4)
  v_mfma_f32_16x16x32_bf16 v[56:59], a[156:159], v[68:71], v[56:59]
  s_add_u32 m0, s27, 98304
  s_add_u32 s32, s67, 11567104
  v_mfma_f32_16x16x32_bf16 v[60:63], a[160:163], v[68:71], v[60:63]
  buffer_load_dwordx4 v2, s[8:11], s32 offen sc1 lds
  v_mfma_f32_16x16x32_bf16 v[64:67], a[164:167], v[68:71], v[64:67]
  ds_read_b128 v[68:71], v2 offset:15360
  s_waitcnt lgkmcnt(4)
  v_mfma_f32_16x16x32_bf16 v[20:23], a[168:171], v[72:75], v[20:23]
  v_mfma_f32_16x16x32_bf16 v[24:27], a[172:175], v[72:75], v[24:27]
  s_add_u32 m0, s27, 114688
  s_add_u32 s32, s67, 11583488
  v_mfma_f32_16x16x32_bf16 v[28:31], a[176:179], v[72:75], v[28:31]
  ds_read_b128 v[72:75], v2 offset:31744
  s_waitcnt lgkmcnt(4)
  v_mfma_f32_16x16x32_bf16 v[32:35], a[168:171], v[76:79], v[32:35]
  buffer_load_dwordx4 v2, s[8:11], s32 offen sc1 lds
  v_mfma_f32_16x16x32_bf16 v[36:39], a[172:175], v[76:79], v[36:39]
  v_mfma_f32_16x16x32_bf16 v[40:43], a[176:179], v[76:79], v[40:43]
  ds_read_b128 v[76:79], v2 offset:48128
  s_waitcnt lgkmcnt(4)
  v_mfma_f32_16x16x32_bf16 v[44:47], a[168:171], v[80:83], v[44:47]
  s_lshl_b32 s33, s16, 11
  s_add_u32 m0, s33, 139264
  s_add_u32 s32, s26, 17170432
  v_mfma_f32_16x16x32_bf16 v[48:51], a[172:175], v[80:83], v[48:51]
  buffer_load_dwordx4 v2, s[8:11], s32 offen offset:0 sc1 lds
  v_mfma_f32_16x16x32_bf16 v[52:55], a[176:179], v[80:83], v[52:55]
  ds_read_b128 v[80:83], v2 offset:64512
  s_barrier
  s_waitcnt lgkmcnt(4)
  v_mfma_f32_16x16x32_bf16 v[56:59], a[168:171], v[84:87], v[56:59]
  v_mfma_f32_16x16x32_bf16 v[60:63], a[172:175], v[84:87], v[60:63]
  s_lshl_b32 s33, s16, 11
  s_add_u32 m0, s33, 139264
  s_add_u32 s32, s26, 17170432
  v_mfma_f32_16x16x32_bf16 v[64:67], a[176:179], v[84:87], v[64:67]
  buffer_load_dwordx4 v2, s[8:11], s32 offen offset:1024 sc1 lds
  s_waitcnt lgkmcnt(3)
  v_mfma_f32_16x16x32_bf16 v[20:23], a[180:183], v[68:71], v[20:23]
  v_mfma_f32_16x16x32_bf16 v[24:27], a[184:187], v[68:71], v[24:27]
  s_waitcnt vmcnt(14)
  v_mfma_f32_16x16x32_bf16 v[28:31], a[188:191], v[68:71], v[28:31]
  ds_read_b128 v[68:71], v15 offset:768
  s_waitcnt lgkmcnt(3)
  v_mfma_f32_16x16x32_bf16 v[32:35], a[180:183], v[72:75], v[32:35]
  s_add_u32 m0, s27, 69632
  s_add_u32 s32, s67, 11538432
  v_mfma_f32_16x16x32_bf16 v[36:39], a[184:187], v[72:75], v[36:39]
  buffer_load_dwordx4 v2, s[8:11], s32 offen sc1 lds
  v_mfma_f32_16x16x32_bf16 v[40:43], a[188:191], v[72:75], v[40:43]
  ds_read_b128 v[72:75], v15 offset:832
  s_waitcnt lgkmcnt(3)
  v_mfma_f32_16x16x32_bf16 v[44:47], a[180:183], v[76:79], v[44:47]
  v_mfma_f32_16x16x32_bf16 v[48:51], a[184:187], v[76:79], v[48:51]
  s_add_u32 m0, s27, 86016
  s_add_u32 s32, s67, 11554816
  v_mfma_f32_16x16x32_bf16 v[52:55], a[188:191], v[76:79], v[52:55]
  ds_read_b128 v[76:79], v15 offset:896
  s_waitcnt lgkmcnt(3)
  v_mfma_f32_16x16x32_bf16 v[56:59], a[180:183], v[80:83], v[56:59]
  buffer_load_dwordx4 v2, s[8:11], s32 offen sc1 lds
  v_mfma_f32_16x16x32_bf16 v[60:63], a[184:187], v[80:83], v[60:63]
  v_mfma_f32_16x16x32_bf16 v[64:67], a[188:191], v[80:83], v[64:67]
  ds_read_b64 v[80:81], v13 offset:0
  s_barrier
  ds_read_b64 v[82:83], v13 offset:128
  s_waitcnt lgkmcnt(1)
  v_pk_fma_f32 v[28:29], v[80:81], v[76:77], v[28:29] op_sel_hi:[0,1,1]
  v_pk_fma_f32 v[30:31], v[80:81], v[78:79], v[30:31] op_sel_hi:[0,1,1]
  v_pk_fma_f32 v[20:21], v[80:81], v[68:69], v[20:21] op_sel_hi:[0,1,1]
  v_pk_fma_f32 v[22:23], v[80:81], v[70:71], v[22:23] op_sel_hi:[0,1,1]
  v_pk_fma_f32 v[24:25], v[80:81], v[72:73], v[24:25] op_sel_hi:[0,1,1]
  v_pk_fma_f32 v[26:27], v[80:81], v[74:75], v[26:27] op_sel_hi:[0,1,1]
  v_mul_f32 v84, s99, v81
  v_permlane16_swap_b32 v28, v30
  v_permlane16_swap_b32 v29, v31
  v_pk_mul_f32 v[20:21], v[20:21], v[84:85] op_sel_hi:[1,0]
  v_pk_mul_f32 v[22:23], v[22:23], v[84:85] op_sel_hi:[1,0]
  v_pk_mul_f32 v[28:29], v[28:29], v[84:85] op_sel_hi:[1,0]
  s_add_u32 m0, s27, 102400
  s_add_u32 s32, s67, 11571200
  buffer_load_dwordx4 v2, s[8:11], s32 offen sc1 lds
  v_exp_f32 v20, v20
  v_exp_f32 v21, v21
  v_exp_f32 v22, v22
  v_exp_f32 v23, v23
  v_exp_f32 v28, v28
  v_exp_f32 v29, v29
  v_pk_mul_f32 v[24:25], v[24:25], v[80:81] op_sel:[0,1] op_sel_hi:[1,1]
  v_pk_mul_f32 v[26:27], v[26:27], v[80:81] op_sel:[0,1] op_sel_hi:[1,1]
  v_pk_mul_f32 v[30:31], v[30:31], v[80:81] op_sel:[0,1] op_sel_hi:[1,1]
  v_pk_add_f32 v[20:21], v[20:21], s[38:39]
  v_pk_add_f32 v[22:23], v[22:23], s[38:39]
  v_pk_add_f32 v[28:29], v[28:29], s[38:39]
  s_add_u32 m0, s27, 118784
  s_add_u32 s32, s67, 11587584
  buffer_load_dwordx4 v2, s[8:11], s32 offen sc1 lds
  v_rcp_f32 v20, v20
  v_rcp_f32 v21, v21
  v_rcp_f32 v22, v22
  v_rcp_f32 v23, v23
  v_rcp_f32 v28, v28
  v_rcp_f32 v29, v29
  v_pk_mul_f32 v[24:25], v[24:25], v[20:21]
  v_pk_mul_f32 v[26:27], v[26:27], v[22:23]
  v_pk_mul_f32 v[30:31], v[30:31], v[28:29]
  v_cvt_pk_bf16_f32 v20, v24, v25
  v_cvt_pk_bf16_f32 v21, v26, v27
  v_cvt_pk_bf16_f32 v136, v30, v31
  s_add_u32 s49, s44, 8192
  buffer_load_dwordx4 a[224:227], v2, s[8:11], s49 offen offset:0
  ds_read_b64 v[80:81], v13 offset:256
  s_waitcnt lgkmcnt(1)
  v_pk_fma_f32 v[40:41], v[82:83], v[76:77], v[40:41] op_sel_hi:[0,1,1]
  v_pk_fma_f32 v[42:43], v[82:83], v[78:79], v[42:43] op_sel_hi:[0,1,1]
  v_pk_fma_f32 v[32:33], v[82:83], v[68:69], v[32:33] op_sel_hi:[0,1,1]
  v_pk_fma_f32 v[34:35], v[82:83], v[70:71], v[34:35] op_sel_hi:[0,1,1]
  v_pk_fma_f32 v[36:37], v[82:83], v[72:73], v[36:37] op_sel_hi:[0,1,1]
  v_pk_fma_f32 v[38:39], v[82:83], v[74:75], v[38:39] op_sel_hi:[0,1,1]
  v_mul_f32 v84, s99, v83
  v_permlane16_swap_b32 v40, v42
  v_permlane16_swap_b32 v41, v43
  v_pk_mul_f32 v[32:33], v[32:33], v[84:85] op_sel_hi:[1,0]
  v_pk_mul_f32 v[34:35], v[34:35], v[84:85] op_sel_hi:[1,0]
  v_pk_mul_f32 v[40:41], v[40:41], v[84:85] op_sel_hi:[1,0]
  buffer_load_dwordx4 a[228:231], v2, s[8:11], s49 offen offset:1024
  v_exp_f32 v32, v32
  v_exp_f32 v33, v33
  v_exp_f32 v34, v34
  v_exp_f32 v35, v35
  v_exp_f32 v40, v40
  v_exp_f32 v41, v41
  v_pk_mul_f32 v[36:37], v[36:37], v[82:83] op_sel:[0,1] op_sel_hi:[1,1]
  v_pk_mul_f32 v[38:39], v[38:39], v[82:83] op_sel:[0,1] op_sel_hi:[1,1]
  v_pk_mul_f32 v[42:43], v[42:43], v[82:83] op_sel:[0,1] op_sel_hi:[1,1]
  v_pk_add_f32 v[32:33], v[32:33], s[38:39]
  v_pk_add_f32 v[34:35], v[34:35], s[38:39]
  v_pk_add_f32 v[40:41], v[40:41], s[38:39]
  buffer_load_dwordx4 a[232:235], v2, s[8:11], s49 offen offset:2048
  v_rcp_f32 v32, v32
  v_rcp_f32 v33, v33
  v_rcp_f32 v34, v34
  v_rcp_f32 v35, v35
  v_rcp_f32 v40, v40
  v_rcp_f32 v41, v41
  v_pk_mul_f32 v[36:37], v[36:37], v[32:33]
  v_pk_mul_f32 v[38:39], v[38:39], v[34:35]
  v_pk_mul_f32 v[42:43], v[42:43], v[40:41]
  v_cvt_pk_bf16_f32 v22, v36, v37
  v_cvt_pk_bf16_f32 v23, v38, v39
  v_cvt_pk_bf16_f32 v137, v42, v43
  buffer_load_dwordx4 a[236:239], v2, s[8:11], s49 offen offset:3072
  ds_read_b64 v[82:83], v13 offset:384
  s_waitcnt lgkmcnt(1)
  v_pk_fma_f32 v[52:53], v[80:81], v[76:77], v[52:53] op_sel_hi:[0,1,1]
  v_pk_fma_f32 v[54:55], v[80:81], v[78:79], v[54:55] op_sel_hi:[0,1,1]
  v_pk_fma_f32 v[44:45], v[80:81], v[68:69], v[44:45] op_sel_hi:[0,1,1]
  v_pk_fma_f32 v[46:47], v[80:81], v[70:71], v[46:47] op_sel_hi:[0,1,1]
  v_pk_fma_f32 v[48:49], v[80:81], v[72:73], v[48:49] op_sel_hi:[0,1,1]
  v_pk_fma_f32 v[50:51], v[80:81], v[74:75], v[50:51] op_sel_hi:[0,1,1]
  v_mul_f32 v84, s99, v81
  v_permlane16_swap_b32 v52, v54
  v_permlane16_swap_b32 v53, v55
  v_pk_mul_f32 v[44:45], v[44:45], v[84:85] op_sel_hi:[1,0]
  v_pk_mul_f32 v[46:47], v[46:47], v[84:85] op_sel_hi:[1,0]
  v_pk_mul_f32 v[52:53], v[52:53], v[84:85] op_sel_hi:[1,0]
  s_add_u32 s49, s44, 12288
  buffer_load_dwordx4 a[240:243], v2, s[8:11], s49 offen offset:0
  v_exp_f32 v44, v44
  v_exp_f32 v45, v45
  v_exp_f32 v46, v46
  v_exp_f32 v47, v47
  v_exp_f32 v52, v52
  v_exp_f32 v53, v53
  v_pk_mul_f32 v[48:49], v[48:49], v[80:81] op_sel:[0,1] op_sel_hi:[1,1]
  v_pk_mul_f32 v[50:51], v[50:51], v[80:81] op_sel:[0,1] op_sel_hi:[1,1]
  v_pk_mul_f32 v[54:55], v[54:55], v[80:81] op_sel:[0,1] op_sel_hi:[1,1]
  v_pk_add_f32 v[44:45], v[44:45], s[38:39]
  v_pk_add_f32 v[46:47], v[46:47], s[38:39]
  v_pk_add_f32 v[52:53], v[52:53], s[38:39]
  buffer_load_dwordx4 a[244:247], v2, s[8:11], s49 offen offset:1024
  v_rcp_f32 v44, v44
  v_rcp_f32 v45, v45
  v_rcp_f32 v46, v46
  v_rcp_f32 v47, v47
  v_rcp_f32 v52, v52
  v_rcp_f32 v53, v53
  v_pk_mul_f32 v[48:49], v[48:49], v[44:45]
  v_pk_mul_f32 v[50:51], v[50:51], v[46:47]
  v_pk_mul_f32 v[54:55], v[54:55], v[52:53]
  v_cvt_pk_bf16_f32 v44, v48, v49
  v_cvt_pk_bf16_f32 v45, v50, v51
  v_cvt_pk_bf16_f32 v138, v54, v55
  buffer_load_dwordx4 a[248:251], v2, s[8:11], s49 offen offset:2048
  s_waitcnt lgkmcnt(0)
  v_pk_fma_f32 v[64:65], v[82:83], v[76:77], v[64:65] op_sel_hi:[0,1,1]
  v_pk_fma_f32 v[66:67], v[82:83], v[78:79], v[66:67] op_sel_hi:[0,1,1]
  v_pk_fma_f32 v[56:57], v[82:83], v[68:69], v[56:57] op_sel_hi:[0,1,1]
  v_pk_fma_f32 v[58:59], v[82:83], v[70:71], v[58:59] op_sel_hi:[0,1,1]
  v_pk_fma_f32 v[60:61], v[82:83], v[72:73], v[60:61] op_sel_hi:[0,1,1]
  v_pk_fma_f32 v[62:63], v[82:83], v[74:75], v[62:63] op_sel_hi:[0,1,1]
  v_mul_f32 v84, s99, v83
  v_permlane16_swap_b32 v64, v66
  v_permlane16_swap_b32 v65, v67
  v_pk_mul_f32 v[56:57], v[56:57], v[84:85] op_sel_hi:[1,0]
  v_pk_mul_f32 v[58:59], v[58:59], v[84:85] op_sel_hi:[1,0]
  v_pk_mul_f32 v[64:65], v[64:65], v[84:85] op_sel_hi:[1,0]
  buffer_load_dwordx4 a[252:255], v2, s[8:11], s49 offen offset:3072
  v_exp_f32 v56, v56
  v_exp_f32 v57, v57
  v_exp_f32 v58, v58
  v_exp_f32 v59, v59
  v_exp_f32 v64, v64
  v_exp_f32 v65, v65
  v_pk_mul_f32 v[60:61], v[60:61], v[82:83] op_sel:[0,1] op_sel_hi:[1,1]
  v_pk_mul_f32 v[62:63], v[62:63], v[82:83] op_sel:[0,1] op_sel_hi:[1,1]
  v_pk_mul_f32 v[66:67], v[66:67], v[82:83] op_sel:[0,1] op_sel_hi:[1,1]
  v_pk_add_f32 v[56:57], v[56:57], s[38:39]
  v_pk_add_f32 v[58:59], v[58:59], s[38:39]
  v_pk_add_f32 v[64:65], v[64:65], s[38:39]
  s_add_u32 s49, s44, 16384
  buffer_load_dwordx4 v[144:147], v2, s[8:11], s49 offen offset:0
  v_rcp_f32 v56, v56
  v_rcp_f32 v57, v57
  v_rcp_f32 v58, v58
  v_rcp_f32 v59, v59
  v_rcp_f32 v64, v64
  v_rcp_f32 v65, v65
  v_pk_mul_f32 v[60:61], v[60:61], v[56:57]
  v_pk_mul_f32 v[62:63], v[62:63], v[58:59]
  v_pk_mul_f32 v[66:67], v[66:67], v[64:65]
  v_cvt_pk_bf16_f32 v46, v60, v61
  v_cvt_pk_bf16_f32 v47, v62, v63
  v_cvt_pk_bf16_f32 v139, v66, v67
  buffer_load_dwordx4 v[148:151], v2, s[8:11], s49 offen offset:1024
  s_add_u32 s58, s48, 23068672
  v_permlane16_swap_b32 v20, v22
  v_permlane16_swap_b32 v21, v23
  buffer_store_dwordx4 v[20:23], v5, s[8:11], s58 offen sc1
  v_permlane16_swap_b32 v44, v46
  v_permlane16_swap_b32 v45, v47
  s_add_u32 s59, s58, 98304
  buffer_store_dwordx4 v[44:47], v5, s[8:11], s59 offen sc1
  v_permlane16_swap_b32 v136, v137
  v_permlane16_swap_b32 v138, v139
  s_nop 1
  v_permlane32_swap_b32 v136, v138
  v_permlane32_swap_b32 v137, v139
  buffer_store_dwordx4 v[136:139], v6, s[8:11], s58 offen sc1
  s_waitcnt vmcnt(19)
  s_barrier
  ds_read_b128 v[68:71], v3 offset:0
  ds_read_b128 v[72:75], v3 offset:16384
  ds_read_b128 v[76:79], v3 offset:32768
  ds_read_b128 v[80:83], v3 offset:49152
  ds_read_b128 v[84:87], v3 offset:1024
  s_waitcnt lgkmcnt(4)
  v_mfma_f32_16x16x32_bf16 v[20:23], a[0:3], v[68:71], 0
  s_add_u32 m0, s27, 73728
  s_add_u32 s32, s67, 11542528
  v_mfma_f32_16x16x32_bf16 v[24:27], a[4:7], v[68:71], 0
  buffer_load_dwordx4 v2, s[8:11], s32 offen sc1 lds
  v_mfma_f32_16x16x32_bf16 v[28:31], a[8:11], v[68:71], 0
  ds_read_b128 v[68:71], v3 offset:17408
  s_waitcnt lgkmcnt(4)
  v_mfma_f32_16x16x32_bf16 v[32:35], a[0:3], v[72:75], 0
  v_mfma_f32_16x16x32_bf16 v[36:39], a[4:7], v[72:75], 0
  s_add_u32 m0, s27, 90112
  s_add_u32 s32, s67, 11558912
  v_mfma_f32_16x16x32_bf16 v[40:43], a[8:11], v[72:75], 0
  ds_read_b128 v[72:75], v3 offset:33792
  s_waitcnt lgkmcnt(4)
  v_mfma_f32_16x16x32_bf16 v[44:47], a[0:3], v[76:79], 0
  buffer_load_dwordx4 v2, s[8:11], s32 offen sc1 lds
  v_mfma_f32_16x16x32_bf16 v[48:51], a[4:7], v[76:79], 0
  v_add_u32 v96, 8192, v11
  s_waitcnt vmcnt(19)
  v_mfma_f32_16x16x32_bf16 v[52:55], a[8:11], v[76:79], 0
  ds_read_b128 v[76:79], v3 offset:50176
  s_waitcnt lgkmcnt(4)
  v_mfma_f32_16x16x32_bf16 v[56:59], a[0:3], v[80:83], 0
  s_add_u32 m0, s27, 106496
  s_add_u32 s32, s67, 11575296
  v_mfma_f32_16x16x32_bf16 v[60:63], a[4:7], v[80:83], 0
  buffer_load_dwordx4 v2, s[8:11], s32 offen sc1 lds
  v_mfma_f32_16x16x32_bf16 v[64:67], a[8:11], v[80:83], 0
  ds_read_b128 v[80:83], v3 offset:2048
  s_waitcnt lgkmcnt(4)
  v_mfma_f32_16x16x32_bf16 v[20:23], a[12:15], v[84:87], v[20:23]
  ds_read2_b32 v[88:89], v96 offset0:0 offset1:32
  ds_read2_b32 v[90:91], v96 offset0:64 offset1:96
  v_mfma_f32_16x16x32_bf16 v[24:27], a[16:19], v[84:87], v[24:27]
  s_add_u32 m0, s27, 122880
  s_add_u32 s32, s67, 11591680
  v_mfma_f32_16x16x32_bf16 v[28:31], a[20:23], v[84:87], v[28:31]
  ds_read_b128 v[84:87], v3 offset:18432
  s_waitcnt lgkmcnt(6)
  v_mfma_f32_16x16x32_bf16 v[32:35], a[12:15], v[68:71], v[32:35]
  buffer_load_dwordx4 v2, s[8:11], s32 offen sc1 lds
  v_mfma_f32_16x16x32_bf16 v[36:39], a[16:19], v[68:71], v[36:39]
  ds_read2_b32 v[92:93], v96 offset0:128 offset1:160
  ds_read2_b32 v[94:95], v96 offset0:192 offset1:224
  v_mfma_f32_16x16x32_bf16 v[40:43], a[20:23], v[68:71], v[40:43]
  ds_read_b128 v[68:71], v3 offset:34816
  s_waitcnt lgkmcnt(8)
  v_mfma_f32_16x16x32_bf16 v[44:47], a[12:15], v[72:75], v[44:47]
  s_add_u32 m0, s27, 77824
  s_add_u32 s32, s67, 11546624
  v_mfma_f32_16x16x32_bf16 v[48:51], a[16:19], v[72:75], v[48:51]
  buffer_load_dwordx4 v2, s[8:11], s32 offen sc1 lds
  v_mfma_f32_16x16x32_bf16 v[52:55], a[20:23], v[72:75], v[52:55]
  ds_read_b128 v[72:75], v3 offset:51200
  s_waitcnt lgkmcnt(8)
  v_mfma_f32_16x16x32_bf16 v[56:59], a[12:15], v[76:79], v[56:59]
  v_mfma_f32_16x16x32_bf16 v[60:63], a[16:19], v[76:79], v[60:63]
  s_add_u32 m0, s27, 94208
  s_add_u32 s32, s67, 11563008
  v_mfma_f32_16x16x32_bf16 v[64:67], a[20:23], v[76:79], v[64:67]
  ds_read_b128 v[76:79], v3 offset:3072
  s_waitcnt lgkmcnt(8)
  v_mfma_f32_16x16x32_bf16 v[20:23], a[24:27], v[80:83], v[20:23]
  buffer_load_dwordx4 v2, s[8:11], s32 offen sc1 lds
  v_mfma_f32_16x16x32_bf16 v[24:27], a[28:31], v[80:83], v[24:27]
  v_mfma_f32_16x16x32_bf16 v[28:31], a[32:35], v[80:83], v[28:31]
  ds_read_b128 v[80:83], v3 offset:19456
  s_waitcnt lgkmcnt(6)
  v_mfma_f32_16x16x32_bf16 v[32:35], a[24:27], v[84:87], v[32:35]
  s_add_u32 m0, s27, 110592
  s_add_u32 s32, s67, 11579392
  v_mfma_f32_16x16x32_bf16 v[36:39], a[28:31], v[84:87], v[36:39]
  buffer_load_dwordx4 v2, s[8:11], s32 offen sc1 lds
  v_mfma_f32_16x16x32_bf16 v[40:43], a[32:35], v[84:87], v[40:43]
  ds_read_b128 v[84:87], v3 offset:35840
  s_waitcnt lgkmcnt(4)
  v_mfma_f32_16x16x32_bf16 v[44:47], a[24:27], v[68:71], v[44:47]
  v_add_f32 v88, v88, v89
  v_add_f32 v90, v90, v91
  v_mfma_f32_16x16x32_bf16 v[48:51], a[28:31], v[68:71], v[48:51]
  s_add_u32 m0, s27, 126976
  s_add_u32 s32, s67, 11595776
  v_mfma_f32_16x16x32_bf16 v[52:55], a[32:35], v[68:71], v[52:55]
  ds_read_b128 v[68:71], v3 offset:52224
  s_waitcnt lgkmcnt(4)
  v_mfma_f32_16x16x32_bf16 v[56:59], a[24:27], v[72:75], v[56:59]
  buffer_load_dwordx4 v2, s[8:11], s32 offen sc1 lds
  v_mfma_f32_16x16x32_bf16 v[60:63], a[28:31], v[72:75], v[60:63]
  v_add_f32 v92, v92, v93
  v_add_f32 v94, v94, v95
  v_mfma_f32_16x16x32_bf16 v[64:67], a[32:35], v[72:75], v[64:67]
  s_waitcnt vmcnt(21)
  s_barrier
  ds_read_b128 v[72:75], v3 offset:4096
  s_waitcnt lgkmcnt(4)
  v_mfma_f32_16x16x32_bf16 v[20:23], a[36:39], v[76:79], v[20:23]
  v_add_f32 v88, v88, v90
  v_add_f32 v92, v92, v94
  v_mfma_f32_16x16x32_bf16 v[24:27], a[40:43], v[76:79], v[24:27]
  buffer_load_dwordx4 v[152:155], v2, s[8:11], s49 offen offset:2048
  v_mfma_f32_16x16x32_bf16 v[28:31], a[44:47], v[76:79], v[28:31]
  ds_read_b128 v[76:79], v3 offset:20480
  s_waitcnt lgkmcnt(4)
  v_mfma_f32_16x16x32_bf16 v[32:35], a[36:39], v[80:83], v[32:35]
  v_add_f32 v88, v88, v92
  v_mov_b32 v89, v88
  v_mfma_f32_16x16x32_bf16 v[36:39], a[40:43], v[80:83], v[36:39]
  s_nop 0
  v_permlane32_swap_b32 v88, v89
  v_mfma_f32_16x16x32_bf16 v[40:43], a[44:47], v[80:83], v[40:43]
  ds_read_b128 v[80:83], v3 offset:36864
  s_waitcnt lgkmcnt(4)
  v_mfma_f32_16x16x32_bf16 v[44:47], a[36:39], v[84:87], v[44:47]
  buffer_load_dwordx4 v[156:159], v2, s[8:11], s49 offen offset:3072
  v_mfma_f32_16x16x32_bf16 v[48:51], a[40:43], v[84:87], v[48:51]
  v_add_f32 v88, v88, v89
  v_mov_b32 v89, v88
  v_mfma_f32_16x16x32_bf16 v[52:55], a[44:47], v[84:87], v[52:55]
  ds_read_b128 v[84:87], v3 offset:53248
  s_waitcnt lgkmcnt(4)
  v_mfma_f32_16x16x32_bf16 v[56:59], a[36:39], v[68:71], v[56:59]
  s_add_u32 s49, s44, 20480
  v_mfma_f32_16x16x32_bf16 v[60:63], a[40:43], v[68:71], v[60:63]
  buffer_load_dwordx4 v[160:163], v2, s[8:11], s49 offen offset:0
  v_mfma_f32_16x16x32_bf16 v[64:67], a[44:47], v[68:71], v[64:67]
  ds_read_b128 v[68:71], v3 offset:5120
  s_waitcnt lgkmcnt(4)
  v_mfma_f32_16x16x32_bf16 v[20:23], a[48:51], v[72:75], v[20:23]
  v_permlane16_swap_b32 v88, v89
  v_mfma_f32_16x16x32_bf16 v[24:27], a[52:55], v[72:75], v[24:27]
  v_mul_f32 v88, 0xbb000000, v88
  v_mul_f32 v90, v88, v88
  v_mfma_f32_16x16x32_bf16 v[28:31], a[56:59], v[72:75], v[28:31]
  ds_read_b128 v[72:75], v3 offset:21504
  s_waitcnt lgkmcnt(4)
  v_mfma_f32_16x16x32_bf16 v[32:35], a[48:51], v[76:79], v[32:35]
  buffer_load_dwordx4 v[164:167], v2, s[8:11], s49 offen offset:1024
  v_mfma_f32_16x16x32_bf16 v[36:39], a[52:55], v[76:79], v[36:39]
  v_fma_f32 v89, v89, s96, -v90
  v_max_f32 v89, 0, v89
  v_mfma_f32_16x16x32_bf16 v[40:43], a[56:59], v[76:79], v[40:43]
  ds_read_b128 v[76:79], v3 offset:37888
  s_waitcnt lgkmcnt(4)
  v_mfma_f32_16x16x32_bf16 v[44:47], a[48:51], v[80:83], v[44:47]
  v_add_f32 v89, s97, v89
  v_mfma_f32_16x16x32_bf16 v[48:51], a[52:55], v[80:83], v[48:51]
  buffer_load_dwordx4 v[168:171], v2, s[8:11], s49 offen offset:2048
  v_mfma_f32_16x16x32_bf16 v[52:55], a[56:59], v[80:83], v[52:55]
  ds_read_b128 v[80:83], v3 offset:54272
  s_waitcnt lgkmcnt(4)
  v_mfma_f32_16x16x32_bf16 v[56:59], a[48:51], v[84:87], v[56:59]
  v_rsq_f32 v89, v89
  v_mfma_f32_16x16x32_bf16 v[60:63], a[52:55], v[84:87], v[60:63]
  v_cndmask_b32 v88, v88, v89, s[36:37]
  ds_write_b32 v12, v88 offset:1024
  v_mfma_f32_16x16x32_bf16 v[64:67], a[56:59], v[84:87], v[64:67]
  ds_read_b128 v[84:87], v3 offset:6144
  s_waitcnt lgkmcnt(5)
  v_mfma_f32_16x16x32_bf16 v[20:23], a[60:63], v[68:71], v[20:23]
  buffer_load_dwordx4 v[172:175], v2, s[8:11], s49 offen offset:3072
  v_mfma_f32_16x16x32_bf16 v[24:27], a[64:67], v[68:71], v[24:27]
  v_mfma_f32_16x16x32_bf16 v[28:31], a[68:71], v[68:71], v[28:31]
  ds_read_b128 v[68:71], v3 offset:22528
  s_waitcnt lgkmcnt(5)
  v_mfma_f32_16x16x32_bf16 v[32:35], a[60:63], v[72:75], v[32:35]
  s_add_u32 s49, s44, 24576
  v_mfma_f32_16x16x32_bf16 v[36:39], a[64:67], v[72:75], v[36:39]
  s_waitcnt vmcnt(14)
  s_barrier
  s_add_u32 s34, s51, 8290304
  v_mfma_f32_16x16x32_bf16 v[40:43], a[68:71], v[72:75], v[40:43]
  ds_read_b128 v[72:75], v3 offset:38912
  s_waitcnt lgkmcnt(5)
  v_mfma_f32_16x16x32_bf16 v[44:47], a[60:63], v[76:79], v[44:47]
  s_cmp_eq_u32 s7, 1
  s_cbranch_scc1 IMP_4
  buffer_store_dword v18, v1, s[8:11], s34 offen
IMPB_4:
  v_mfma_f32_16x16x32_bf16 v[48:51], a[64:67], v[76:79], v[48:51]
  buffer_load_dwordx4 v[176:179], v2, s[8:11], s49 offen offset:0
  v_mfma_f32_16x16x32_bf16 v[52:55], a[68:71], v[76:79], v[52:55]
  ds_read_b128 v[76:79], v3 offset:55296
  s_waitcnt lgkmcnt(5)
  v_mfma_f32_16x16x32_bf16 v[56:59], a[60:63], v[80:83], v[56:59]
  v_mfma_f32_16x16x32_bf16 v[60:63], a[64:67], v[80:83], v[60:63]
  v_mfma_f32_16x16x32_bf16 v[64:67], a[68:71], v[80:83], v[64:67]
  ds_read_b128 v[80:83], v3 offset:7168
  s_waitcnt lgkmcnt(4)
  v_mfma_f32_16x16x32_bf16 v[20:23], a[72:75], v[84:87], v[20:23]
  buffer_load_dwordx4 v[180:183], v2, s[8:11], s49 offen offset:1024
  v_mfma_f32_16x16x32_bf16 v[24:27], a[76:79], v[84:87], v[24:27]
  v_mfma_f32_16x16x32_bf16 v[28:31], a[80:83], v[84:87], v[28:31]
  ds_read_b128 v[84:87], v3 offset:23552
  s_waitcnt lgkmcnt(4)
  v_mfma_f32_16x16x32_bf16 v[32:35], a[72:75], v[68:71], v[32:35]
  v_mfma_f32_16x16x32_bf16 v[36:39], a[76:79], v[68:71], v[36:39]
  buffer_load_dwordx4 v[184:187], v2, s[8:11], s49 offen offset:2048
  v_mfma_f32_16x16x32_bf16 v[40:43], a[80:83], v[68:71], v[40:43]
  ds_read_b128 v[68:71], v3 offset:39936
  s_waitcnt lgkmcnt(4)
  v_mfma_f32_16x16x32_bf16 v[44:47], a[72:75], v[72:75], v[44:47]
  v_mfma_f32_16x16x32_bf16 v[48:51], a[76:79], v[72:75], v[48:51]
  v_mfma_f32_16x16x32_bf16 v[52:55], a[80:83], v[72:75], v[52:55]
  ds_read_b128 v[72:75], v3 offset:56320
  s_waitcnt lgkmcnt(4)
  v_mfma_f32_16x16x32_bf16 v[56:59], a[72:75], v[76:79], v[56:59]
  buffer_load_dwordx4 v[188:191], v2, s[8:11], s49 offen offset:3072
  v_mfma_f32_16x16x32_bf16 v[60:63], a[76:79], v[76:79], v[60:63]
  v_mfma_f32_16x16x32_bf16 v[64:67], a[80:83], v[76:79], v[64:67]
  s_waitcnt vmcnt(15)
  s_barrier
  ds_read_b128 v[76:79], v3 offset:8192
  s_waitcnt lgkmcnt(4)
  v_mfma_f32_16x16x32_bf16 v[20:23], a[84:87], v[80:83], v[20:23]
  s_add_u32 s49, s44, 28672
  v_mfma_f32_16x16x32_bf16 v[24:27], a[88:91], v[80:83], v[24:27]
  buffer_load_dwordx4 v[192:195], v2, s[8:11], s49 offen offset:0
  v_mfma_f32_16x16x32_bf16 v[28:31], a[92:95], v[80:83], v[28:31]
  ds_read_b128 v[80:83], v3 offset:24576
  s_waitcnt lgkmcnt(4)
  v_mfma_f32_16x16x32_bf16 v[32:35], a[84:87], v[84:87], v[32:35]
  v_mfma_f32_16x16x32_bf16 v[36:39], a[88:91], v[84:87], v[36:39]
  v_mfma_f32_16x16x32_bf16 v[40:43], a[92:95], v[84:87], v[40:43]
  ds_read_b128 v[84:87], v3 offset:40960
  s_waitcnt lgkmcnt(4)
  v_mfma_f32_16x16x32_bf16 v[44:47], a[84:87], v[68:71], v[44:47]
  buffer_load_dwordx4 v[196:199], v2, s[8:11], s49 offen offset:1024
  v_mfma_f32_16x16x32_bf16 v[48:51], a[88:91], v[68:71], v[48:51]
  v_mfma_f32_16x16x32_bf16 v[52:55], a[92:95], v[68:71], v[52:55]
  ds_read_b128 v[68:71], v3 offset:57344
  s_waitcnt lgkmcnt(4)
  v_mfma_f32_16x16x32_bf16 v[56:59], a[84:87], v[72:75], v[56:59]
  v_mfma_f32_16x16x32_bf16 v[60:63], a[88:91], v[72:75], v[60:63]
  buffer_load_dwordx4 v[200:203], v2, s[8:11], s49 offen offset:2048
  v_mfma_f32_16x16x32_bf16 v[64:67], a[92:95], v[72:75], v[64:67]
  ds_read_b128 v[72:75], v3 offset:9216
  s_waitcnt lgkmcnt(4)
  v_mfma_f32_16x16x32_bf16 v[20:23], a[96:99], v[76:79], v[20:23]
  v_mfma_f32_16x16x32_bf16 v[24:27], a[100:103], v[76:79], v[24:27]
  v_mfma_f32_16x16x32_bf16 v[28:31], a[104:107], v[76:79], v[28:31]
  ds_read_b128 v[76:79], v3 offset:25600
  s_waitcnt lgkmcnt(4)
  v_mfma_f32_16x16x32_bf16 v[32:35], a[96:99], v[80:83], v[32:35]
  buffer_load_dwordx4 v[204:207], v2, s[8:11], s49 offen offset:3072
  v_mfma_f32_16x16x32_bf16 v[36:39], a[100:103], v[80:83], v[36:39]
  v_mfma_f32_16x16x32_bf16 v[40:43], a[104:107], v[80:83], v[40:43]
  ds_read_b128 v[80:83], v3 offset:41984
  s_waitcnt lgkmcnt(4)
  v_mfma_f32_16x16x32_bf16 v[44:47], a[96:99], v[84:87], v[44:47]
  s_add_u32 s49, s44, 32768
  v_mfma_f32_16x16x32_bf16 v[48:51], a[100:103], v[84:87], v[48:51]
  buffer_load_dwordx4 v[208:211], v2, s[8:11], s49 offen offset:0
  v_mfma_f32_16x16x32_bf16 v[52:55], a[104:107], v[84:87], v[52:55]
  ds_read_b128 v[84:87], v3 offset:58368
  s_waitcnt lgkmcnt(4)
  v_mfma_f32_16x16x32_bf16 v[56:59], a[96:99], v[68:71], v[56:59]
  v_mfma_f32_16x16x32_bf16 v[60:63], a[100:103], v[68:71], v[60:63]
  v_mfma_f32_16x16x32_bf16 v[64:67], a[104:107], v[68:71], v[64:67]
  ds_read_b128 v[68:71], v3 offset:10240
  s_waitcnt lgkmcnt(4)
  v_mfma_f32_16x16x32_bf16 v[20:23], a[108:111], v[72:75], v[20:23]
  buffer_load_dwordx4 v[212:215], v2, s[8:11], s49 offen offset:1024
  v_mfma_f32_16x16x32_bf16 v[24:27], a[112:115], v[72:75], v[24:27]
  v_mfma_f32_16x16x32_bf16 v[28:31], a[116:119], v[72:75], v[28:31]
  ds_read_b128 v[72:75], v3 offset:26624
  s_waitcnt lgkmcnt(4)
  v_mfma_f32_16x16x32_bf16 v[32:35], a[108:111], v[76:79], v[32:35]
  v_mfma_f32_16x16x32_bf16 v[36:39], a[112:115], v[76:79], v[36:39]
  buffer_load_dwordx4 v[216:219], v2, s[8:11], s49 offen offset:2048
  v_mfma_f32_16x16x32_bf16 v[40:43], a[116:119], v[76:79], v[40:43]
  ds_read_b128 v[76:79], v3 offset:43008
  s_waitcnt lgkmcnt(4)
  v_mfma_f32_16x16x32_bf16 v[44:47], a[108:111], v[80:83], v[44:47]
  v_mfma_f32_16x16x32_bf16 v[48:51], a[112:115], v[80:83], v[48:51]
  v_mfma_f32_16x16x32_bf16 v[52:55], a[116:119], v[80:83], v[52:55]
  ds_read_b128 v[80:83], v3 offset:59392
  s_waitcnt lgkmcnt(4)
  v_mfma_f32_16x16x32_bf16 v[56:59], a[108:111], v[84:87], v[56:59]
  buffer_load_dwordx4 v[220:223], v2, s[8:11], s49 offen offset:3072
  v_mfma_f32_16x16x32_bf16 v[60:63], a[112:115], v[84:87], v[60:63]
  v_mfma_f32_16x16x32_bf16 v[64:67], a[116:119], v[84:87], v[64:67]
  ds_read_b128 v[84:87], v3 offset:11264
  s_waitcnt lgkmcnt(4)
  v_mfma_f32_16x16x32_bf16 v[20:23], a[120:123], v[68:71], v[20:23]
  s_add_u32 s35, s54, 8290304
  s_add_u32 s49, s44, 36864
  v_mfma_f32_16x16x32_bf16 v[24:27], a[124:127], v[68:71], v[24:27]
  buffer_load_dword v19, v9, s[8:11], s35 offen sc1
  v_mfma_f32_16x16x32_bf16 v[28:31], a[128:131], v[68:71], v[28:31]
  ds_read_b128 v[68:71], v3 offset:27648
  s_waitcnt lgkmcnt(4)
  v_mfma_f32_16x16x32_bf16 v[32:35], a[120:123], v[72:75], v[32:35]
  v_mfma_f32_16x16x32_bf16 v[36:39], a[124:127], v[72:75], v[36:39]
  v_mfma_f32_16x16x32_bf16 v[40:43], a[128:131], v[72:75], v[40:43]
  ds_read_b128 v[72:75], v3 offset:44032
  s_waitcnt lgkmcnt(4)
  v_mfma_f32_16x16x32_bf16 v[44:47], a[120:123], v[76:79], v[44:47]
  buffer_load_dwordx4 v[224:227], v2, s[8:11], s49 offen offset:0
  v_mfma_f32_16x16x32_bf16 v[48:51], a[124:127], v[76:79], v[48:51]
  v_mfma_f32_16x16x32_bf16 v[52:55], a[128:131], v[76:79], v[52:55]
  ds_read_b128 v[76:79], v3 offset:60416
  s_waitcnt lgkmcnt(4)
  v_mfma_f32_16x16x32_bf16 v[56:59], a[120:123], v[80:83], v[56:59]
  v_mfma_f32_16x16x32_bf16 v[60:63], a[124:127], v[80:83], v[60:63]
  buffer_load_dwordx4 v[228:231], v2, s[8:11], s49 offen offset:1024
  v_mfma_f32_16x16x32_bf16 v[64:67], a[128:131], v[80:83], v[64:67]
  s_waitcnt vmcnt(22)
  s_barrier
  ds_read_b128 v[80:83], v3 offset:12288
  s_waitcnt lgkmcnt(4)
  v_mfma_f32_16x16x32_bf16 v[20:23], a[132:135], v[84:87], v[20:23]
  v_mfma_f32_16x16x32_bf16 v[24:27], a[136:139], v[84:87], v[24:27]
  v_mfma_f32_16x16x32_bf16 v[28:31], a[140:143], v[84:87], v[28:31]
  ds_read_b128 v[84:87], v3 offset:28672
  s_waitcnt lgkmcnt(4)
  v_mfma_f32_16x16x32_bf16 v[32:35], a[132:135], v[68:71], v[32:35]
  buffer_load_dwordx4 v[232:235], v2, s[8:11], s49 offen offset:2048
  v_mfma_f32_16x16x32_bf16 v[36:39], a[136:139], v[68:71], v[36:39]
  v_mfma_f32_16x16x32_bf16 v[40:43], a[140:143], v[68:71], v[40:43]
  ds_read_b128 v[68:71], v3 offset:45056
  s_waitcnt lgkmcnt(4)
  v_mfma_f32_16x16x32_bf16 v[44:47], a[132:135], v[72:75], v[44:47]
  v_mfma_f32_16x16x32_bf16 v[48:51], a[136:139], v[72:75], v[48:51]
  buffer_load_dwordx4 v[236:239], v2, s[8:11], s49 offen offset:3072
  v_mfma_f32_16x16x32_bf16 v[52:55], a[140:143], v[72:75], v[52:55]
  ds_read_b128 v[72:75], v3 offset:61440
  s_waitcnt lgkmcnt(4)
  v_mfma_f32_16x16x32_bf16 v[56:59], a[132:135], v[76:79], v[56:59]
  v_mfma_f32_16x16x32_bf16 v[60:63], a[136:139], v[76:79], v[60:63]
  s_add_u32 s49, s44, 40960
  v_mfma_f32_16x16x32_bf16 v[64:67], a[140:143], v[76:79], v[64:67]
  ds_read_b128 v[76:79], v3 offset:13312
  s_waitcnt lgkmcnt(4)
  v_mfma_f32_16x16x32_bf16 v[20:23], a[144:147], v[80:83], v[20:23]
  buffer_load_dwordx4 v[240:243], v2, s[8:11], s49 offen offset:0
  v_mfma_f32_16x16x32_bf16 v[24:27], a[148:151], v[80:83], v[24:27]
  v_mfma_f32_16x16x32_bf16 v[28:31], a[152:155], v[80:83], v[28:31]
  ds_read_b128 v[80:83], v3 offset:29696
  s_waitcnt lgkmcnt(4)
  v_mfma_f32_16x16x32_bf16 v[32:35], a[144:147], v[84:87], v[32:35]
  v_mfma_f32_16x16x32_bf16 v[36:39], a[148:151], v[84:87], v[36:39]
  buffer_load_dwordx4 v[244:247], v2, s[8:11], s49 offen offset:1024
  v_mfma_f32_16x16x32_bf16 v[40:43], a[152:155], v[84:87], v[40:43]
  ds_read_b128 v[84:87], v3 offset:46080
  s_waitcnt lgkmcnt(4)
  v_mfma_f32_16x16x32_bf16 v[44:47], a[144:147], v[68:71], v[44:47]
  v_mfma_f32_16x16x32_bf16 v[48:51], a[148:151], v[68:71], v[48:51]
  v_mfma_f32_16x16x32_bf16 v[52:55], a[152:155], v[68:71], v[52:55]
  ds_read_b128 v[68:71], v3 offset:62464
  s_waitcnt lgkmcnt(4)
  v_mfma_f32_16x16x32_bf16 v[56:59], a[144:147], v[72:75], v[56:59]
  buffer_load_dwordx4 v[248:251], v2, s[8:11], s49 offen offset:2048
  v_mfma_f32_16x16x32_bf16 v[60:63], a[148:151], v[72:75], v[60:63]
  v_mfma_f32_16x16x32_bf16 v[64:67], a[152:155], v[72:75], v[64:67]
  ds_read_b128 v[72:75], v3 offset:14336
  s_waitcnt lgkmcnt(4)
  v_mfma_f32_16x16x32_bf16 v[20:23], a[156:159], v[76:79], v[20:23]
  v_mfma_f32_16x16x32_bf16 v[24:27], a[160:163], v[76:79], v[24:27]
  buffer_load_dwordx4 v[252:255], v2, s[8:11], s49 offen offset:3072
  v_mfma_f32_16x16x32_bf16 v[28:31], a[164:167], v[76:79], v[28:31]
  ds_read_b128 v[76:79], v3 offset:30720
  s_waitcnt lgkmcnt(4)
  v_mfma_f32_16x16x32_bf16 v[32:35], a[156:159], v[80:83], v[32:35]
  v_mfma_f32_16x16x32_bf16 v[36:39], a[160:163], v[80:83], v[36:39]
  s_waitcnt vmcnt(8)
  v_cmp_ne_u32 vcc, s61, v19
  s_nop 0
  s_and_b64 vcc, vcc, s[30:31]
  v_mfma_f32_16x16x32_bf16 v[40:43], a[164:167], v[80:83], v[40:43]
  ds_read_b128 v[80:83], v3 offset:47104
  s_waitcnt lgkmcnt(4)
  v_mfma_f32_16x16x32_bf16 v[44:47], a[156:159], v[84:87], v[44:47]
  s_cbranch_vccnz SLOW_7
BACK_7:
  s_barrier
  s_add_u32 s49, s41, 0
  v_mfma_f32_16x16x32_bf16 v[48:51], a[160:163], v[84:87], v[48:51]
  buffer_load_dwordx4 a[0:3], v2, s[8:11], s49 offen offset:0
  v_mfma_f32_16x16x32_bf16 v[52:55], a[164:167], v[84:87], v[52:55]
  ds_read_b128 v[84:87], v3 offset:63488
  s_waitcnt lgkmcnt(4)
  v_mfma_f32_16x16x32_bf16 v[56:59], a[156:159], v[68:71], v[56:59]
  v_mfma_f32_16x16x32_bf16 v[60:63], a[160:163], v[68:71], v[60:63]
  s_add_u32 s32, s65, 23068672
  v_mfma_f32_16x16x32_bf16 v[64:67], a[164:167], v[68:71], v[64:67]
  ds_read_b128 v[68:71], v3 offset:15360
  s_waitcnt lgkmcnt(4)
  v_mfma_f32_16x16x32_bf16 v[20:23], a[168:171], v[72:75], v[20:23]
  buffer_load_dwordx4 v[88:91], v2, s[8:11], s32 offen offset:0 sc1
  v_mfma_f32_16x16x32_bf16 v[24:27], a[172:175], v[72:75], v[24:27]
  v_mfma_f32_16x16x32_bf16 v[28:31], a[176:179], v[72:75], v[28:31]
  ds_read_b128 v[72:75], v3 offset:31744
  s_waitcnt lgkmcnt(4)
  v_mfma_f32_16x16x32_bf16 v[32:35], a[168:171], v[76:79], v[32:35]
  s_add_u32 s32, s65, 23068672
  v_mfma_f32_16x16x32_bf16 v[36:39], a[172:175], v[76:79], v[36:39]
  buffer_load_dwordx4 v[92:95], v2, s[8:11], s32 offen offset:1024 sc1
  v_mfma_f32_16x16x32_bf16 v[40:43], a[176:179], v[76:79], v[40:43]
  ds_read_b128 v[76:79], v3 offset:48128
  s_waitcnt lgkmcnt(4)
  v_mfma_f32_16x16x32_bf16 v[44:47], a[168:171], v[80:83], v[44:47]
  v_mfma_f32_16x16x32_bf16 v[48:51], a[172:175], v[80:83], v[48:51]
  s_add_u32 s32, s65, 23068672
  v_mfma_f32_16x16x32_bf16 v[52:55], a[176:179], v[80:83], v[52:55]
  ds_read_b128 v[80:83], v3 offset:64512
  s_barrier
  s_waitcnt lgkmcnt(4)
  v_mfma_f32_16x16x32_bf16 v[56:59], a[168:171], v[84:87], v[56:59]
  buffer_load_dwordx4 v[96:99], v2, s[8:11], s32 offen offset:2048 sc1
  v_mfma_f32_16x16x32_bf16 v[60:63], a[172:175], v[84:87], v[60:63]
  v_mfma_f32_16x16x32_bf16 v[64:67], a[176:179], v[84:87], v[64:67]
  s_waitcnt lgkmcnt(3)
  v_mfma_f32_16x16x32_bf16 v[20:23], a[180:183], v[68:71], v[20:23]
  s_add_u32 s32, s65, 23068672
  v_mfma_f32_16x16x32_bf16 v[24:27], a[184:187], v[68:71], v[24:27]
  buffer_load_dwordx4 v[100:103], v2, s[8:11], s32 offen offset:3072 sc1
  v_mfma_f32_16x16x32_bf16 v[28:31], a[188:191], v[68:71], v[28:31]
  ds_read_b128 v[68:71], v15 offset:768
  s_waitcnt lgkmcnt(3)
  v_mfma_f32_16x16x32_bf16 v[32:35], a[180:183], v[72:75], v[32:35]
  v_mfma_f32_16x16x32_bf16 v[36:39], a[184:187], v[72:75], v[36:39]
  s_add_u32 s32, s47, 10485760
  v_mfma_f32_16x16x32_bf16 v[40:43], a[188:191], v[72:75], v[40:43]
  ds_read_b128 v[72:75], v15 offset:832
  s_waitcnt lgkmcnt(3)
  v_mfma_f32_16x16x32_bf16 v[44:47], a[180:183], v[76:79], v[44:47]
  buffer_load_dwordx4 v[140:143], v2, s[8:11], s32 offen sc1
  v_mfma_f32_16x16x32_bf16 v[48:51], a[184:187], v[76:79], v[48:51]
  v_mfma_f32_16x16x32_bf16 v[52:55], a[188:191], v[76:79], v[52:55]
  ds_read_b128 v[76:79], v15 offset:896
  s_waitcnt lgkmcnt(3)
  v_mfma_f32_16x16x32_bf16 v[56:59], a[180:183], v[80:83], v[56:59]
  s_add_u32 s32, s65, 23072768
  v_mfma_f32_16x16x32_bf16 v[60:63], a[184:187], v[80:83], v[60:63]
  buffer_load_dwordx4 v[104:107], v2, s[8:11], s32 offen offset:0 sc1
  v_mfma_f32_16x16x32_bf16 v[64:67], a[188:191], v[80:83], v[64:67]
  ds_read_b64 v[80:81], v13 offset:1024
  s_barrier
  s_add_u32 s32, s65, 23072768
  buffer_load_dwordx4 v[108:111], v2, s[8:11], s32 offen offset:1024 sc1
  s_add_u32 s32, s65, 23072768
  buffer_load_dwordx4 v[112:115], v2, s[8:11], s32 offen offset:2048 sc1
  s_add_u32 s32, s65, 23072768
  buffer_load_dwordx4 v[116:119], v2, s[8:11], s32 offen offset:3072 sc1
  s_add_u32 s32, s65, 23076864
  buffer_load_dwordx4 v[120:123], v2, s[8:11], s32 offen offset:0 sc1
  s_add_u32 s32, s65, 23076864
  buffer_load_dwordx4 v[124:127], v2, s[8:11], s32 offen offset:1024 sc1
  s_add_u32 s32, s65, 23076864
  buffer_load_dwordx4 v[128:131], v2, s[8:11], s32 offen offset:2048 sc1
  s_add_u32 s32, s64, 23068672
  buffer_load_dwordx4 v[132:135], v2, s[8:11], s32 offen offset:0 sc1
  ds_read_b64 v[82:83], v13 offset:1152
  s_waitcnt lgkmcnt(1)
  v_pk_fma_f32 v[28:29], v[80:81], v[76:77], v[28:29] op_sel_hi:[0,1,1]
  v_pk_fma_f32 v[30:31], v[80:81], v[78:79], v[30:31] op_sel_hi:[0,1,1]
  v_pk_fma_f32 v[20:21], v[80:81], v[68:69], v[20:21] op_sel_hi:[0,1,1]
  v_pk_fma_f32 v[22:23], v[80:81], v[70:71], v[22:23] op_sel_hi:[0,1,1]
  v_pk_fma_f32 v[24:25], v[80:81], v[72:73], v[24:25] op_sel_hi:[0,1,1]
  v_pk_fma_f32 v[26:27], v[80:81], v[74:75], v[26:27] op_sel_hi:[0,1,1]
  v_mul_f32 v84, s99, v81
  v_permlane16_swap_b32 v28, v30
  v_permlane16_swap_b32 v29, v31
  v_pk_mul_f32 v[20:21], v[20:21], v[84:85] op_sel_hi:[1,0]
  v_pk_mul_f32 v[22:23], v[22:23], v[84:85] op_sel_hi:[1,0]
  v_pk_mul_f32 v[28:29], v[28:29], v[84:85] op_sel_hi:[1,0]
  buffer_load_dwordx4 a[4:7], v2, s[8:11], s49 offen offset:1024
  v_exp_f32 v20, v20
  v_exp_f32 v21, v21
  v_exp_f32 v22, v22
  v_exp_f32 v23, v23
  v_exp_f32 v28, v28
  v_exp_f32 v29, v29
  v_pk_mul_f32 v[24:25], v[24:25], v[80:81] op_sel:[0,1] op_sel_hi:[1,1]
  v_pk_mul_f32 v[26:27], v[26:27], v[80:81] op_sel:[0,1] op_sel_hi:[1,1]
  v_pk_mul_f32 v[30:31], v[30:31], v[80:81] op_sel:[0,1] op_sel_hi:[1,1]
  v_pk_add_f32 v[20:21], v[20:21], s[38:39]
  v_pk_add_f32 v[22:23], v[22:23], s[38:39]
  v_pk_add_f32 v[28:29], v[28:29], s[38:39]
  buffer_load_dwordx4 a[8:11], v2, s[8:11], s49 offen offset:2048
  v_rcp_f32 v20, v20
  v_rcp_f32 v21, v21
  v_rcp_f32 v22, v22
  v_rcp_f32 v23, v23
  v_rcp_f32 v28, v28
  v_rcp_f32 v29, v29
  v_pk_mul_f32 v[24:25], v[24:25], v[20:21]
  v_pk_mul_f32 v[26:27], v[26:27], v[22:23]
  v_pk_mul_f32 v[30:31], v[30:31], v[28:29]
  v_cvt_pk_bf16_f32 v20, v24, v25
  v_cvt_pk_bf16_f32 v21, v26, v27
  v_cvt_pk_bf16_f32 v136, v30, v31
  buffer_load_dwordx4 a[12:15], v2, s[8:11], s49 offen offset:3072
  ds_read_b64 v[80:81], v13 offset:1280
  s_waitcnt lgkmcnt(1)
  v_pk_fma_f32 v[40:41], v[82:83], v[76:77], v[40:41] op_sel_hi:[0,1,1]
  v_pk_fma_f32 v[42:43], v[82:83], v[78:79], v[42:43] op_sel_hi:[0,1,1]
  v_pk_fma_f32 v[32:33], v[82:83], v[68:69], v[32:33] op_sel_hi:[0,1,1]
  v_pk_fma_f32 v[34:35], v[82:83], v[70:71], v[34:35] op_sel_hi:[0,1,1]
  v_pk_fma_f32 v[36:37], v[82:83], v[72:73], v[36:37] op_sel_hi:[0,1,1]
  v_pk_fma_f32 v[38:39], v[82:83], v[74:75], v[38:39] op_sel_hi:[0,1,1]
  v_mul_f32 v84, s99, v83
  v_permlane16_swap_b32 v40, v42
  v_permlane16_swap_b32 v41, v43
  v_pk_mul_f32 v[32:33], v[32:33], v[84:85] op_sel_hi:[1,0]
  v_pk_mul_f32 v[34:35], v[34:35], v[84:85] op_sel_hi:[1,0]
  v_pk_mul_f32 v[40:41], v[40:41], v[84:85] op_sel_hi:[1,0]
  s_add_u32 s49, s41, 4096
  buffer_load_dwordx4 a[16:19], v2, s[8:11], s49 offen offset:0
  v_exp_f32 v32, v32
  v_exp_f32 v33, v33
  v_exp_f32 v34, v34
  v_exp_f32 v35, v35
  v_exp_f32 v40, v40
  v_exp_f32 v41, v41
  v_pk_mul_f32 v[36:37], v[36:37], v[82:83] op_sel:[0,1] op_sel_hi:[1,1]
  v_pk_mul_f32 v[38:39], v[38:39], v[82:83] op_sel:[0,1] op_sel_hi:[1,1]
  v_pk_mul_f32 v[42:43], v[42:43], v[82:83] op_sel:[0,1] op_sel_hi:[1,1]
  v_pk_add_f32 v[32:33], v[32:33], s[38:39]
  v_pk_add_f32 v[34:35], v[34:35], s[38:39]
  v_pk_add_f32 v[40:41], v[40:41], s[38:39]
  buffer_load_dwordx4 a[20:23], v2, s[8:11], s49 offen offset:1024
  v_rcp_f32 v32, v32
  v_rcp_f32 v33, v33
  v_rcp_f32 v34, v34
  v_rcp_f32 v35, v35
  v_rcp_f32 v40, v40
  v_rcp_f32 v41, v41
  v_pk_mul_f32 v[36:37], v[36:37], v[32:33]
  v_pk_mul_f32 v[38:39], v[38:39], v[34:35]
  v_pk_mul_f32 v[42:43], v[42:43], v[40:41]
  v_cvt_pk_bf16_f32 v22, v36, v37
  v_cvt_pk_bf16_f32 v23, v38, v39
  v_cvt_pk_bf16_f32 v137, v42, v43
  buffer_load_dwordx4 a[24:27], v2, s[8:11], s49 offen offset:2048
  ds_read_b64 v[82:83], v13 offset:1408
  s_waitcnt lgkmcnt(1)
  v_pk_fma_f32 v[52:53], v[80:81], v[76:77], v[52:53] op_sel_hi:[0,1,1]
  v_pk_fma_f32 v[54:55], v[80:81], v[78:79], v[54:55] op_sel_hi:[0,1,1]
  v_pk_fma_f32 v[44:45], v[80:81], v[68:69], v[44:45] op_sel_hi:[0,1,1]
  v_pk_fma_f32 v[46:47], v[80:81], v[70:71], v[46:47] op_sel_hi:[0,1,1]
  v_pk_fma_f32 v[48:49], v[80:81], v[72:73], v[48:49] op_sel_hi:[0,1,1]
  v_pk_fma_f32 v[50:51], v[80:81], v[74:75], v[50:51] op_sel_hi:[0,1,1]
  v_mul_f32 v84, s99, v81
  v_permlane16_swap_b32 v52, v54
  v_permlane16_swap_b32 v53, v55
  v_pk_mul_f32 v[44:45], v[44:45], v[84:85] op_sel_hi:[1,0]
  v_pk_mul_f32 v[46:47], v[46:47], v[84:85] op_sel_hi:[1,0]
  v_pk_mul_f32 v[52:53], v[52:53], v[84:85] op_sel_hi:[1,0]
  buffer_load_dwordx4 a[28:31], v2, s[8:11], s49 offen offset:3072
  v_exp_f32 v44, v44
  v_exp_f32 v45, v45
  v_exp_f32 v46, v46
  v_exp_f32 v47, v47
  v_exp_f32 v52, v52
  v_exp_f32 v53, v53
  v_pk_mul_f32 v[48:49], v[48:49], v[80:81] op_sel:[0,1] op_sel_hi:[1,1]
  v_pk_mul_f32 v[50:51], v[50:51], v[80:81] op_sel:[0,1] op_sel_hi:[1,1]
  v_pk_mul_f32 v[54:55], v[54:55], v[80:81] op_sel:[0,1] op_sel_hi:[1,1]
  v_pk_add_f32 v[44:45], v[44:45], s[38:39]
  v_pk_add_f32 v[46:47], v[46:47], s[38:39]
  v_pk_add_f32 v[52:53], v[52:53], s[38:39]
  s_add_u32 s49, s41, 8192
  buffer_load_dwordx4 a[32:35], v2, s[8:11], s49 offen offset:0
  v_rcp_f32 v44, v44
  v_rcp_f32 v45, v45
  v_rcp_f32 v46, v46
  v_rcp_f32 v47, v47
  v_rcp_f32 v52, v52
  v_rcp_f32 v53, v53
  v_pk_mul_f32 v[48:49], v[48:49], v[44:45]
  v_pk_mul_f32 v[50:51], v[50:51], v[46:47]
  v_pk_mul_f32 v[54:55], v[54:55], v[52:53]
  v_cvt_pk_bf16_f32 v44, v48, v49
  v_cvt_pk_bf16_f32 v45, v50, v51
  v_cvt_pk_bf16_f32 v138, v54, v55
  buffer_load_dwordx4 a[36:39], v2, s[8:11], s49 offen offset:1024
  s_waitcnt lgkmcnt(0)
  v_pk_fma_f32 v[64:65], v[82:83], v[76:77], v[64:65] op_sel_hi:[0,1,1]
  v_pk_fma_f32 v[66:67], v[82:83], v[78:79], v[66:67] op_sel_hi:[0,1,1]
  v_pk_fma_f32 v[56:57], v[82:83], v[68:69], v[56:57] op_sel_hi:[0,1,1]
  v_pk_fma_f32 v[58:59], v[82:83], v[70:71], v[58:59] op_sel_hi:[0,1,1]
  v_pk_fma_f32 v[60:61], v[82:83], v[72:73], v[60:61] op_sel_hi:[0,1,1]
  v_pk_fma_f32 v[62:63], v[82:83], v[74:75], v[62:63] op_sel_hi:[0,1,1]
  v_mul_f32 v84, s99, v83
  v_permlane16_swap_b32 v64, v66
  v_permlane16_swap_b32 v65, v67
  v_pk_mul_f32 v[56:57], v[56:57], v[84:85] op_sel_hi:[1,0]
  v_pk_mul_f32 v[58:59], v[58:59], v[84:85] op_sel_hi:[1,0]
  v_pk_mul_f32 v[64:65], v[64:65], v[84:85] op_sel_hi:[1,0]
  buffer_load_dwordx4 a[40:43], v2, s[8:11], s49 offen offset:2048
  v_exp_f32 v56, v56
  v_exp_f32 v57, v57
  v_exp_f32 v58, v58
  v_exp_f32 v59, v59
  v_exp_f32 v64, v64
  v_exp_f32 v65, v65
  v_pk_mul_f32 v[60:61], v[60:61], v[82:83] op_sel:[0,1] op_sel_hi:[1,1]
  v_pk_mul_f32 v[62:63], v[62:63], v[82:83] op_sel:[0,1] op_sel_hi:[1,1]
  v_pk_mul_f32 v[66:67], v[66:67], v[82:83] op_sel:[0,1] op_sel_hi:[1,1]
  v_pk_add_f32 v[56:57], v[56:57], s[38:39]
  v_pk_add_f32 v[58:59], v[58:59], s[38:39]
  v_pk_add_f32 v[64:65], v[64:65], s[38:39]
  buffer_load_dwordx4 a[44:47], v2, s[8:11], s49 offen offset:3072
  v_rcp_f32 v56, v56
  v_rcp_f32 v57, v57
  v_rcp_f32 v58, v58
  v_rcp_f32 v59, v59
  v_rcp_f32 v64, v64
  v_rcp_f32 v65, v65
  v_pk_mul_f32 v[60:61], v[60:61], v[56:57]
  v_pk_mul_f32 v[62:63], v[62:63], v[58:59]
  v_pk_mul_f32 v[66:67], v[66:67], v[64:65]
  v_cvt_pk_bf16_f32 v46, v60, v61
  v_cvt_pk_bf16_f32 v47, v62, v63
  v_cvt_pk_bf16_f32 v139, v66, v67
  s_add_u32 s49, s41, 12288
  buffer_load_dwordx4 a[48:51], v2, s[8:11], s49 offen offset:0
  s_add_u32 s58, s48, 26214400
  v_permlane16_swap_b32 v20, v22
  v_permlane16_swap_b32 v21, v23
  buffer_store_dwordx4 v[20:23], v5, s[8:11], s58 offen sc1
  v_permlane16_swap_b32 v44, v46
  v_permlane16_swap_b32 v45, v47
  s_add_u32 s59, s58, 98304
  buffer_store_dwordx4 v[44:47], v5, s[8:11], s59 offen sc1
  v_permlane16_swap_b32 v136, v137
  v_permlane16_swap_b32 v138, v139
  s_nop 1
  v_permlane32_swap_b32 v136, v138
  v_permlane32_swap_b32 v137, v139
  buffer_store_dwordx4 v[136:139], v6, s[8:11], s58 offen sc1
  s_waitcnt vmcnt(27)
  v_mfma_f32_16x16x32_bf16 v[36:39], a[192:195], v[88:91], 0
  buffer_load_dwordx4 a[52:55], v2, s[8:11], s49 offen offset:1024
  v_mfma_f32_16x16x32_bf16 v[40:43], a[196:199], v[88:91], 0
  v_mfma_f32_16x16x32_bf16 v[44:47], a[200:203], v[88:91], 0
  s_add_u32 s3, s64, 23068672
  v_mfma_f32_16x16x32_bf16 v[48:51], a[204:207], v[88:91], 0
  buffer_load_dwordx4 v[88:91], v2, s[8:11], s3 offen offset:1024 sc1
  s_waitcnt vmcnt(28)
  v_mfma_f32_16x16x32_bf16 v[36:39], a[208:211], v[92:95], v[36:39]
  v_mfma_f32_16x16x32_bf16 v[40:43], a[212:215], v[92:95], v[40:43]
  v_mfma_f32_16x16x32_bf16 v[44:47], a[216:219], v[92:95], v[44:47]
  s_add_u32 s3, s64, 23068672
  v_mfma_f32_16x16x32_bf16 v[48:51], a[220:223], v[92:95], v[48:51]
  buffer_load_dwordx4 v[92:95], v2, s[8:11], s3 offen offset:2048 sc1
  s_waitcnt vmcnt(28)
  v_mfma_f32_16x16x32_bf16 v[36:39], a[224:227], v[96:99], v[36:39]
  v_mfma_f32_16x16x32_bf16 v[40:43], a[228:231], v[96:99], v[40:43]
  v_mfma_f32_16x16x32_bf16 v[44:47], a[232:235], v[96:99], v[44:47]
  s_add_u32 s3, s64, 23068672
  v_mfma_f32_16x16x32_bf16 v[48:51], a[236:239], v[96:99], v[48:51]
  buffer_load_dwordx4 v[96:99], v2, s[8:11], s3 offen offset:3072 sc1
  s_waitcnt vmcnt(28)
  v_mfma_f32_16x16x32_bf16 v[36:39], a[240:243], v[100:103], v[36:39]
  v_mfma_f32_16x16x32_bf16 v[40:43], a[244:247], v[100:103], v[40:43]
  v_mfma_f32_16x16x32_bf16 v[44:47], a[248:251], v[100:103], v[44:47]
  s_add_u32 s3, s64, 23072768
  v_mfma_f32_16x16x32_bf16 v[48:51], a[252:255], v[100:103], v[48:51]
  buffer_load_dwordx4 v[100:103], v2, s[8:11], s3 offen offset:0 sc1
  s_waitcnt vmcnt(27)
  v_mfma_f32_16x16x32_bf16 v[36:39], v[144:147], v[104:107], v[36:39]
  v_mfma_f32_16x16x32_bf16 v[40:43], v[148:151], v[104:107], v[40:43]
  v_mfma_f32_16x16x32_bf16 v[44:47], v[152:155], v[104:107], v[44:47]
  s_add_u32 s3, s64, 23072768
  v_mfma_f32_16x16x32_bf16 v[48:51], v[156:159], v[104:107], v[48:51]
  buffer_load_dwordx4 v[104:107], v2, s[8:11], s3 offen offset:1024 sc1
  s_waitcnt vmcnt(27)
  v_mfma_f32_16x16x32_bf16 v[36:39], v[160:163], v[108:111], v[36:39]
  v_mfma_f32_16x16x32_bf16 v[40:43], v[164:167], v[108:111], v[40:43]
  v_mfma_f32_16x16x32_bf16 v[44:47], v[168:171], v[108:111], v[44:47]
  s_add_u32 s3, s64, 23072768
  v_mfma_f32_16x16x32_bf16 v[48:51], v[172:175], v[108:111], v[48:51]
  buffer_load_dwordx4 v[108:111], v2, s[8:11], s3 offen offset:2048 sc1
  s_waitcnt vmcnt(27)
  v_mfma_f32_16x16x32_bf16 v[36:39], v[176:179], v[112:115], v[36:39]
  v_mfma_f32_16x16x32_bf16 v[40:43], v[180:183], v[112:115], v[40:43]
  v_mfma_f32_16x16x32_bf16 v[44:47], v[184:187], v[112:115], v[44:47]
  s_add_u32 s3, s64, 23072768
  v_mfma_f32_16x16x32_bf16 v[48:51], v[188:191], v[112:115], v[48:51]
  buffer_load_dwordx4 v[112:115], v2, s[8:11], s3 offen offset:3072 sc1
  s_waitcnt vmcnt(27)
  v_mfma_f32_16x16x32_bf16 v[36:39], v[192:195], v[116:119], v[36:39]
  v_mfma_f32_16x16x32_bf16 v[40:43], v[196:199], v[116:119], v[40:43]
  v_mfma_f32_16x16x32_bf16 v[44:47], v[200:203], v[116:119], v[44:47]
  s_add_u32 s3, s64, 23076864
  v_mfma_f32_16x16x32_bf16 v[48:51], v[204:207], v[116:119], v[48:51]
  buffer_load_dwordx4 v[116:119], v2, s[8:11], s3 offen offset:0 sc1
  s_waitcnt vmcnt(27)
  v_mfma_f32_16x16x32_bf16 v[36:39], v[208:211], v[120:123], v[36:39]
  v_mfma_f32_16x16x32_bf16 v[40:43], v[212:215], v[120:123], v[40:43]
  v_mfma_f32_16x16x32_bf16 v[44:47], v[216:219], v[120:123], v[44:47]
  s_add_u32 s3, s64, 23076864
  v_mfma_f32_16x16x32_bf16 v[48:51], v[220:223], v[120:123], v[48:51]
  buffer_load_dwordx4 v[120:123], v2, s[8:11], s3 offen offset:1024 sc1
  s_waitcnt vmcnt(27)
  v_mfma_f32_16x16x32_bf16 v[36:39], v[224:227], v[124:127], v[36:39]
  v_mfma_f32_16x16x32_bf16 v[40:43], v[228:231], v[124:127], v[40:43]
  v_mfma_f32_16x16x32_bf16 v[44:47], v[232:235], v[124:127], v[44:47]
  s_add_u32 s3, s64, 23076864
  v_mfma_f32_16x16x32_bf16 v[48:51], v[236:239], v[124:127], v[48:51]
  buffer_load_dwordx4 v[124:127], v2, s[8:11], s3 offen offset:2048 sc1
  s_waitcnt vmcnt(27)
  v_mfma_f32_16x16x32_bf16 v[36:39], v[240:243], v[128:131], v[36:39]
  v_mfma_f32_16x16x32_bf16 v[40:43], v[244:247], v[128:131], v[40:43]
  v_mfma_f32_16x16x32_bf16 v[44:47], v[248:251], v[128:131], v[44:47]
  v_mfma_f32_16x16x32_bf16 v[48:51], v[252:255], v[128:131], v[48:51]
  buffer_load_dwordx4 a[56:59], v2, s[8:11], s49 offen offset:2048
  s_waitcnt vmcnt(27)
  v_mfma_f32_16x16x32_bf16 v[20:23], a[192:195], v[132:135], 0
  v_mfma_f32_16x16x32_bf16 v[24:27], a[196:199], v[132:135], 0
  v_mfma_f32_16x16x32_bf16 v[28:31], a[200:203], v[132:135], 0
  v_mfma_f32_16x16x32_bf16 v[32:35], a[204:207], v[132:135], 0
  buffer_load_dwordx4 a[60:63], v2, s[8:11], s49 offen offset:3072
  s_waitcnt vmcnt(11)
  v_mfma_f32_16x16x32_bf16 v[20:23], a[208:211], v[88:91], v[20:23]
  v_mfma_f32_16x16x32_bf16 v[24:27], a[212:215], v[88:91], v[24:27]
  v_mfma_f32_16x16x32_bf16 v[28:31], a[216:219], v[88:91], v[28:31]
  s_add_u32 s49, s41, 16384
  v_mfma_f32_16x16x32_bf16 v[32:35], a[220:223], v[88:91], v[32:35]
  buffer_load_dwordx4 a[64:67], v2, s[8:11], s49 offen offset:0
  s_waitcnt vmcnt(11)
  v_mfma_f32_16x16x32_bf16 v[20:23], a[224:227], v[92:95], v[20:23]
  v_mfma_f32_16x16x32_bf16 v[24:27], a[228:231], v[92:95], v[24:27]
  v_xor_b32 v137, 16384, v7
  v_xor_b32 v138, 24576, v7
  v_mfma_f32_16x16x32_bf16 v[28:31], a[232:235], v[92:95], v[28:31]
  ds_write_b128 v137, v[36:39] offset:4096
  ds_write_b128 v137, v[40:43] offset:5120
  v_mfma_f32_16x16x32_bf16 v[32:35], a[236:239], v[92:95], v[32:35]
  ds_write_b128 v138, v[44:47] offset:6144
  ds_write_b128 v138, v[48:51] offset:7168
  s_waitcnt vmcnt(10)
  v_mfma_f32_16x16x32_bf16 v[20:23], a[240:243], v[96:99], v[20:23]
  buffer_load_dwordx4 a[68:71], v2, s[8:11], s49 offen offset:1024
  v_mfma_f32_16x16x32_bf16 v[24:27], a[244:247], v[96:99], v[24:27]
  v_mfma_f32_16x16x32_bf16 v[28:31], a[248:251], v[96:99], v[28:31]
  v_mfma_f32_16x16x32_bf16 v[32:35], a[252:255], v[96:99], v[32:35]
  s_waitcnt vmcnt(10)
  v_mfma_f32_16x16x32_bf16 v[20:23], v[144:147], v[100:103], v[20:23]
  s_barrier
  s_add_u32 s34, s51, 8298496
  v_mfma_f32_16x16x32_bf16 v[24:27], v[148:151], v[100:103], v[24:27]
  s_cmp_eq_u32 s7, 1
  s_cbranch_scc1 IMP_5
  buffer_store_dword v18, v1, s[8:11], s34 offen
IMPB_5:
  v_mfma_f32_16x16x32_bf16 v[28:31], v[152:155], v[100:103], v[28:31]
  buffer_load_dwordx4 a[72:75], v2, s[8:11], s49 offen offset:2048
  v_mfma_f32_16x16x32_bf16 v[32:35], v[156:159], v[100:103], v[32:35]
  s_waitcnt vmcnt(11)
  v_mfma_f32_16x16x32_bf16 v[28:31], v[168:171], v[104:107], v[28:31]
  v_mfma_f32_16x16x32_bf16 v[32:35], v[172:175], v[104:107], v[32:35]
  s_waitcnt vmcnt(10)
  v_mfma_f32_16x16x32_bf16 v[28:31], v[184:187], v[108:111], v[28:31]
  v_mfma_f32_16x16x32_bf16 v[32:35], v[188:191], v[108:111], v[32:35]
  s_waitcnt vmcnt(9)
  v_mfma_f32_16x16x32_bf16 v[28:31], v[200:203], v[112:115], v[28:31]
  v_mfma_f32_16x16x32_bf16 v[32:35], v[204:207], v[112:115], v[32:35]
  s_waitcnt vmcnt(8)
  v_mfma_f32_16x16x32_bf16 v[28:31], v[216:219], v[116:119], v[28:31]
  v_mfma_f32_16x16x32_bf16 v[32:35], v[220:223], v[116:119], v[32:35]
  s_waitcnt vmcnt(7)
  v_mfma_f32_16x16x32_bf16 v[28:31], v[232:235], v[120:123], v[28:31]
  v_mfma_f32_16x16x32_bf16 v[32:35], v[236:239], v[120:123], v[32:35]
  s_waitcnt vmcnt(6)
  v_mfma_f32_16x16x32_bf16 v[28:31], v[248:251], v[124:127], v[28:31]
  v_mfma_f32_16x16x32_bf16 v[32:35], v[252:255], v[124:127], v[32:35]
  v_mfma_f32_16x16x32_bf16 v[20:23], v[160:163], v[104:107], v[20:23]
  v_mfma_f32_16x16x32_bf16 v[24:27], v[164:167], v[104:107], v[24:27]
  v_mfma_f32_16x16x32_bf16 v[20:23], v[176:179], v[108:111], v[20:23]
  v_mfma_f32_16x16x32_bf16 v[24:27], v[180:183], v[108:111], v[24:27]
  v_mfma_f32_16x16x32_bf16 v[20:23], v[192:195], v[112:115], v[20:23]
  v_mfma_f32_16x16x32_bf16 v[24:27], v[196:199], v[112:115], v[24:27]
  v_mfma_f32_16x16x32_bf16 v[20:23], v[208:211], v[116:119], v[20:23]
  v_mfma_f32_16x16x32_bf16 v[24:27], v[212:215], v[116:119], v[24:27]
  v_mfma_f32_16x16x32_bf16 v[20:23], v[224:227], v[120:123], v[20:23]
  v_mfma_f32_16x16x32_bf16 v[24:27], v[228:231], v[120:123], v[24:27]
  v_xor_b32 v136, 8192, v7
  ds_write_b128 v136, v[28:31] offset:2048
  v_mfma_f32_16x16x32_bf16 v[20:23], v[240:243], v[124:127], v[20:23]
  ds_write_b128 v136, v[32:35] offset:3072
  v_mfma_f32_16x16x32_bf16 v[24:27], v[244:247], v[124:127], v[24:27]
  s_waitcnt lgkmcnt(0)
  s_barrier
  ds_read_b128 v[28:31], v7 offset:2048
  ds_read_b128 v[32:35], v7 offset:3072
  ds_read_b128 v[36:39], v7 offset:4096
  ds_read_b128 v[40:43], v7 offset:5120
  ds_read_b128 v[44:47], v7 offset:6144
  ds_read_b128 v[48:51], v7 offset:7168
  v_lshlrev_b32 v52, 16, v140
  v_and_b32 v53, 0xffff0000, v140
  v_lshlrev_b32 v54, 16, v141
  v_and_b32 v55, 0xffff0000, v141
  v_lshlrev_b32 v56, 16, v142
  v_and_b32 v57, 0xffff0000, v142
  v_lshlrev_b32 v58, 16, v143
  v_and_b32 v59, 0xffff0000, v143
  v_pk_add_f32 v[20:21], v[20:21], v[52:53]
  v_pk_add_f32 v[22:23], v[22:23], v[54:55]
  v_pk_add_f32 v[24:25], v[24:25], v[56:57]
  v_pk_add_f32 v[26:27], v[26:27], v[58:59]
  s_waitcnt lgkmcnt(5)
  v_pk_add_f32 v[20:21], v[20:21], v[28:29]
  v_pk_add_f32 v[22:23], v[22:23], v[30:31]
  s_waitcnt lgkmcnt(4)
  v_pk_add_f32 v[24:25], v[24:25], v[32:33]
  v_pk_add_f32 v[26:27], v[26:27], v[34:35]
  s_waitcnt lgkmcnt(3)
  v_pk_add_f32 v[20:21], v[20:21], v[36:37]
  v_pk_add_f32 v[22:23], v[22:23], v[38:39]
  s_waitcnt lgkmcnt(2)
  v_pk_add_f32 v[24:25], v[24:25], v[40:41]
  v_pk_add_f32 v[26:27], v[26:27], v[42:43]
  s_waitcnt lgkmcnt(1)
  v_pk_add_f32 v[20:21], v[20:21], v[44:45]
  v_pk_add_f32 v[22:23], v[22:23], v[46:47]
  s_waitcnt lgkmcnt(0)
  v_pk_add_f32 v[24:25], v[24:25], v[48:49]
  v_pk_add_f32 v[26:27], v[26:27], v[50:51]
  v_cvt_pk_bf16_f32 v60, v20, v21
  v_cvt_pk_bf16_f32 v61, v22, v23
  v_cvt_pk_bf16_f32 v62, v24, v25
  v_cvt_pk_bf16_f32 v63, v26, v27
  s_add_u32 s58, s47, 12582912
  buffer_store_dwordx4 v[60:63], v2, s[8:11], s58 offen sc1
  v_pk_add_f32 v[52:53], v[20:21], v[22:23]
  v_pk_add_f32 v[54:55], v[24:25], v[26:27]
  v_pk_mul_f32 v[56:57], v[20:21], v[20:21]
  v_pk_add_f32 v[52:53], v[52:53], v[54:55]
  v_pk_fma_f32 v[56:57], v[22:23], v[22:23], v[56:57]
  v_pk_fma_f32 v[56:57], v[24:25], v[24:25], v[56:57]
  v_pk_fma_f32 v[56:57], v[26:27], v[26:27], v[56:57]
  v_add_f32 v52, v52, v53
  v_add_f32 v53, v56, v57
  s_nop 1
  v_permlane16_swap_b32 v52, v53
  v_add_f32 v52, v52, v53
  v_mov_b32 v53, v52
  s_nop 1
  v_permlane32_swap_b32 v52, v53
  v_add_f32 v52, v52, v53
  s_add_u32 s58, s57, 17301504
  v_lshrrev_b32 v54, 2, v2
  s_mov_b32 exec_hi, 0
  buffer_store_dword v52, v54, s[8:11], s58 offen sc1
  s_mov_b32 exec_hi, -1
  s_add_u32 s35, s54, 8298496
  buffer_load_dword v19, v9, s[8:11], s35 offen sc1
  s_waitcnt vmcnt(1)
  s_barrier
  s_add_u32 s34, s50, 8306688
  buffer_store_dword v18, v1, s[8:11], s34 offen sc1
  s_add_u32 s62, s55, 8306688
  buffer_load_dword v139, v0, s[8:11], s62 offen sc1
  s_waitcnt vmcnt(2)
  v_cmp_ne_u32 vcc, s61, v19
  s_nop 0
  s_and_b64 vcc, vcc, s[30:31]
  s_cbranch_vccnz SLOW_8
BACK_8:
  s_barrier
  s_add_u32 s32, s65, 26214400
  buffer_load_dwordx4 v[88:91], v2, s[8:11], s32 offen offset:0 sc1
  s_add_u32 s32, s65, 26214400
  buffer_load_dwordx4 v[92:95], v2, s[8:11], s32 offen offset:1024 sc1
  s_add_u32 s32, s65, 26214400
  buffer_load_dwordx4 v[96:99], v2, s[8:11], s32 offen offset:2048 sc1
  s_add_u32 s32, s65, 26214400
  buffer_load_dwordx4 v[100:103], v2, s[8:11], s32 offen offset:3072 sc1
  s_add_u32 s32, s47, 11534336
  buffer_load_dwordx4 v[140:143], v2, s[8:11], s32 offen sc1
  s_add_u32 s32, s65, 26218496
  buffer_load_dwordx4 v[104:107], v2, s[8:11], s32 offen offset:0 sc1
  s_add_u32 s32, s65, 26218496
  buffer_load_dwordx4 v[108:111], v2, s[8:11], s32 offen offset:1024 sc1
  s_add_u32 s32, s65, 26218496
  buffer_load_dwordx4 v[112:115], v2, s[8:11], s32 offen offset:2048 sc1
  s_add_u32 s32, s65, 26218496
  buffer_load_dwordx4 v[116:119], v2, s[8:11], s32 offen offset:3072 sc1
  s_add_u32 s32, s65, 26222592
  buffer_load_dwordx4 v[120:123], v2, s[8:11], s32 offen offset:0 sc1
  s_add_u32 s32, s65, 26222592
  buffer_load_dwordx4 v[124:127], v2, s[8:11], s32 offen offset:1024 sc1
  s_add_u32 s32, s65, 26222592
  buffer_load_dwordx4 v[128:131], v2, s[8:11], s32 offen offset:2048 sc1
  s_add_u32 s32, s64, 26214400
  buffer_load_dwordx4 v[132:135], v2, s[8:11], s32 offen offset:0 sc1
  s_waitcnt vmcnt(12)
  v_mfma_f32_16x16x32_bf16 v[36:39], a[192:195], v[88:91], 0
  buffer_load_dwordx4 a[76:79], v2, s[8:11], s49 offen offset:3072
  v_mfma_f32_16x16x32_bf16 v[40:43], a[196:199], v[88:91], 0
  v_mfma_f32_16x16x32_bf16 v[44:47], a[200:203], v[88:91], 0
  s_add_u32 s3, s64, 26214400
  v_mfma_f32_16x16x32_bf16 v[48:51], a[204:207], v[88:91], 0
  buffer_load_dwordx4 v[88:91], v2, s[8:11], s3 offen offset:1024 sc1
  s_waitcnt vmcnt(13)
  v_mfma_f32_16x16x32_bf16 v[36:39], a[208:211], v[92:95], v[36:39]
  v_mfma_f32_16x16x32_bf16 v[40:43], a[212:215], v[92:95], v[40:43]
  v_mfma_f32_16x16x32_bf16 v[44:47], a[216:219], v[92:95], v[44:47]
  s_add_u32 s3, s64, 26214400
  s_add_u32 s49, s41, 20480
  v_mfma_f32_16x16x32_bf16 v[48:51], a[220:223], v[92:95], v[48:51]
  buffer_load_dwordx4 v[92:95], v2, s[8:11], s3 offen offset:2048 sc1
  s_waitcnt vmcnt(13)
  v_mfma_f32_16x16x32_bf16 v[36:39], a[224:227], v[96:99], v[36:39]
  v_cmp_ne_u32 vcc, s61, v139
  s_nop 0
  s_and_b64 vcc, vcc, s[100:101]
  v_mfma_f32_16x16x32_bf16 v[40:43], a[228:231], v[96:99], v[40:43]
  s_cbranch_vccnz SLOW_9
BACK_9:
  s_barrier
  v_mfma_f32_16x16x32_bf16 v[44:47], a[232:235], v[96:99], v[44:47]
  s_add_u32 s3, s64, 26214400
  v_mfma_f32_16x16x32_bf16 v[48:51], a[236:239], v[96:99], v[48:51]
  buffer_load_dwordx4 v[96:99], v2, s[8:11], s3 offen offset:3072 sc1
  s_waitcnt vmcnt(13)
  v_mfma_f32_16x16x32_bf16 v[36:39], a[240:243], v[100:103], v[36:39]
  v_mfma_f32_16x16x32_bf16 v[40:43], a[244:247], v[100:103], v[40:43]
  v_mfma_f32_16x16x32_bf16 v[44:47], a[248:251], v[100:103], v[44:47]
  s_add_u32 s3, s64, 26218496
  v_mfma_f32_16x16x32_bf16 v[48:51], a[252:255], v[100:103], v[48:51]
  buffer_load_dwordx4 v[100:103], v2, s[8:11], s3 offen offset:0 sc1
  s_waitcnt vmcnt(12)
  v_mfma_f32_16x16x32_bf16 v[36:39], v[144:147], v[104:107], v[36:39]
  v_mfma_f32_16x16x32_bf16 v[40:43], v[148:151], v[104:107], v[40:43]
  v_mfma_f32_16x16x32_bf16 v[44:47], v[152:155], v[104:107], v[44:47]
  s_add_u32 s3, s64, 26218496
  v_mfma_f32_16x16x32_bf16 v[48:51], v[156:159], v[104:107], v[48:51]
  buffer_load_dwordx4 v[104:107], v2, s[8:11], s3 offen offset:1024 sc1
  s_waitcnt vmcnt(12)
  v_mfma_f32_16x16x32_bf16 v[36:39], v[160:163], v[108:111], v[36:39]
  v_mfma_f32_16x16x32_bf16 v[40:43], v[164:167], v[108:111], v[40:43]
  v_mfma_f32_16x16x32_bf16 v[44:47], v[168:171], v[108:111], v[44:47]
  s_add_u32 s3, s64, 26218496
  v_mfma_f32_16x16x32_bf16 v[48:51], v[172:175], v[108:111], v[48:51]
  buffer_load_dwordx4 v[108:111], v2, s[8:11], s3 offen offset:2048 sc1
  s_waitcnt vmcnt(12)
  v_mfma_f32_16x16x32_bf16 v[36:39], v[176:179], v[112:115], v[36:39]
  v_mfma_f32_16x16x32_bf16 v[40:43], v[180:183], v[112:115], v[40:43]
  v_mfma_f32_16x16x32_bf16 v[44:47], v[184:187], v[112:115], v[44:47]
  s_add_u32 s3, s64, 26218496
  v_mfma_f32_16x16x32_bf16 v[48:51], v[188:191], v[112:115], v[48:51]
  buffer_load_dwordx4 v[112:115], v2, s[8:11], s3 offen offset:3072 sc1
  s_waitcnt vmcnt(12)
  v_mfma_f32_16x16x32_bf16 v[36:39], v[192:195], v[116:119], v[36:39]
  v_mfma_f32_16x16x32_bf16 v[40:43], v[196:199], v[116:119], v[40:43]
  v_mfma_f32_16x16x32_bf16 v[44:47], v[200:203], v[116:119], v[44:47]
  s_add_u32 s3, s64, 26222592
  v_mfma_f32_16x16x32_bf16 v[48:51], v[204:207], v[116:119], v[48:51]
  buffer_load_dwordx4 v[116:119], v2, s[8:11], s3 offen offset:0 sc1
  s_waitcnt vmcnt(12)
  v_mfma_f32_16x16x32_bf16 v[36:39], v[208:211], v[120:123], v[36:39]
  v_mfma_f32_16x16x32_bf16 v[40:43], v[212:215], v[120:123], v[40:43]
  v_mfma_f32_16x16x32_bf16 v[44:47], v[216:219], v[120:123], v[44:47]
  s_add_u32 s3, s64, 26222592
  v_mfma_f32_16x16x32_bf16 v[48:51], v[220:223], v[120:123], v[48:51]
  buffer_load_dwordx4 v[120:123], v2, s[8:11], s3 offen offset:1024 sc1
  s_waitcnt vmcnt(12)
  v_mfma_f32_16x16x32_bf16 v[36:39], v[224:227], v[124:127], v[36:39]
  v_mfma_f32_16x16x32_bf16 v[40:43], v[228:231], v[124:127], v[40:43]
  v_mfma_f32_16x16x32_bf16 v[44:47], v[232:235], v[124:127], v[44:47]
  s_add_u32 s3, s64, 26222592
  v_mfma_f32_16x16x32_bf16 v[48:51], v[236:239], v[124:127], v[48:51]
  buffer_load_dwordx4 v[124:127], v2, s[8:11], s3 offen offset:2048 sc1
  s_waitcnt vmcnt(12)
  v_mfma_f32_16x16x32_bf16 v[36:39], v[240:243], v[128:131], v[36:39]
  v_mfma_f32_16x16x32_bf16 v[40:43], v[244:247], v[128:131], v[40:43]
  v_mfma_f32_16x16x32_bf16 v[44:47], v[248:251], v[128:131], v[44:47]
  v_mfma_f32_16x16x32_bf16 v[48:51], v[252:255], v[128:131], v[48:51]
  buffer_load_dwordx4 a[80:83], v2, s[8:11], s49 offen offset:0
  s_waitcnt vmcnt(12)
  v_mfma_f32_16x16x32_bf16 v[20:23], a[192:195], v[132:135], 0
  v_mfma_f32_16x16x32_bf16 v[24:27], a[196:199], v[132:135], 0
  v_mfma_f32_16x16x32_bf16 v[28:31], a[200:203], v[132:135], 0
  s_add_u32 m0, s27, 0
  s_add_u32 s32, s63, 12582912
  v_mfma_f32_16x16x32_bf16 v[32:35], a[204:207], v[132:135], 0
  buffer_load_dwordx4 v2, s[8:11], s32 offen sc1 lds
  s_waitcnt vmcnt(11)
  v_mfma_f32_16x16x32_bf16 v[20:23], a[208:211], v[88:91], v[20:23]
  v_mfma_f32_16x16x32_bf16 v[24:27], a[212:215], v[88:91], v[24:27]
  v_mfma_f32_16x16x32_bf16 v[28:31], a[216:219], v[88:91], v[28:31]
  s_add_u32 m0, s27, 16384
  s_add_u32 s32, s66, 12582912
  v_mfma_f32_16x16x32_bf16 v[32:35], a[220:223], v[88:91], v[32:35]
  buffer_load_dwordx4 v2, s[8:11], s32 offen sc1 lds
  s_waitcnt vmcnt(11)
  v_mfma_f32_16x16x32_bf16 v[20:23], a[224:227], v[92:95], v[20:23]
  v_mfma_f32_16x16x32_bf16 v[24:27], a[228:231], v[92:95], v[24:27]
  v_xor_b32 v137, 16384, v7
  v_xor_b32 v138, 24576, v7
  v_mfma_f32_16x16x32_bf16 v[28:31], a[232:235], v[92:95], v[28:31]
  ds_write_b128 v137, v[36:39] offset:36864
  ds_write_b128 v137, v[40:43] offset:37888
  v_mfma_f32_16x16x32_bf16 v[32:35], a[236:239], v[92:95], v[32:35]
  ds_write_b128 v138, v[44:47] offset:38912
  ds_write_b128 v138, v[48:51] offset:39936
  s_waitcnt vmcnt(10)
  v_mfma_f32_16x16x32_bf16 v[20:23], a[240:243], v[96:99], v[20:23]
  s_add_u32 m0, s27, 32768
  s_add_u32 s32, s66, 12599296
  v_mfma_f32_16x16x32_bf16 v[24:27], a[244:247], v[96:99], v[24:27]
  buffer_load_dwordx4 v2, s[8:11], s32 offen sc1 lds
  v_mfma_f32_16x16x32_bf16 v[28:31], a[248:251], v[96:99], v[28:31]
  v_mfma_f32_16x16x32_bf16 v[32:35], a[252:255], v[96:99], v[32:35]
  s_waitcnt vmcnt(10)
  v_mfma_f32_16x16x32_bf16 v[20:23], v[144:147], v[100:103], v[20:23]
  s_lshl_b32 s33, s16, 11
  s_add_u32 m0, s33, 131072
  s_add_u32 s32, s25, 17301504
  v_mfma_f32_16x16x32_bf16 v[24:27], v[148:151], v[100:103], v[24:27]
  buffer_load_dwordx4 v2, s[8:11], s32 offen offset:0 sc1 lds
  v_mfma_f32_16x16x32_bf16 v[28:31], v[152:155], v[100:103], v[28:31]
  v_mfma_f32_16x16x32_bf16 v[32:35], v[156:159], v[100:103], v[32:35]
  s_waitcnt vmcnt(10)
  v_mfma_f32_16x16x32_bf16 v[28:31], v[168:171], v[104:107], v[28:31]
  s_lshl_b32 s33, s16, 11
  s_add_u32 m0, s33, 131072
  s_add_u32 s32, s25, 17301504
  v_mfma_f32_16x16x32_bf16 v[32:35], v[172:175], v[104:107], v[32:35]
  buffer_load_dwordx4 v2, s[8:11], s32 offen offset:1024 sc1 lds
  s_waitcnt vmcnt(10)
  v_mfma_f32_16x16x32_bf16 v[28:31], v[184:187], v[108:111], v[28:31]
  v_mfma_f32_16x16x32_bf16 v[32:35], v[188:191], v[108:111], v[32:35]
  s_waitcnt vmcnt(9)
  v_mfma_f32_16x16x32_bf16 v[28:31], v[200:203], v[112:115], v[28:31]
  s_add_u32 m0, s27, 4096
  s_add_u32 s32, s63, 12587008
  v_mfma_f32_16x16x32_bf16 v[32:35], v[204:207], v[112:115], v[32:35]
  buffer_load_dwordx4 v2, s[8:11], s32 offen sc1 lds
  s_waitcnt vmcnt(9)
  v_mfma_f32_16x16x32_bf16 v[28:31], v[216:219], v[116:119], v[28:31]
  v_mfma_f32_16x16x32_bf16 v[32:35], v[220:223], v[116:119], v[32:35]
  s_waitcnt vmcnt(8)
  v_mfma_f32_16x16x32_bf16 v[28:31], v[232:235], v[120:123], v[28:31]
  s_add_u32 m0, s27, 20480
  s_add_u32 s32, s66, 12587008
  v_mfma_f32_16x16x32_bf16 v[32:35], v[236:239], v[120:123], v[32:35]
  buffer_load_dwordx4 v2, s[8:11], s32 offen sc1 lds
  s_waitcnt vmcnt(8)
  v_mfma_f32_16x16x32_bf16 v[28:31], v[248:251], v[124:127], v[28:31]
  v_mfma_f32_16x16x32_bf16 v[32:35], v[252:255], v[124:127], v[32:35]
  v_mfma_f32_16x16x32_bf16 v[20:23], v[160:163], v[104:107], v[20:23]
  s_add_u32 m0, s27, 36864
  s_add_u32 s32, s66, 12603392
  v_mfma_f32_16x16x32_bf16 v[24:27], v[164:167], v[104:107], v[24:27]
  buffer_load_dwordx4 v2, s[8:11], s32 offen sc1 lds
  v_mfma_f32_16x16x32_bf16 v[20:23], v[176:179], v[108:111], v[20:23]
  v_mfma_f32_16x16x32_bf16 v[24:27], v[180:183], v[108:111], v[24:27]
  v_mfma_f32_16x16x32_bf16 v[20:23], v[192:195], v[112:115], v[20:23]
  v_mfma_f32_16x16x32_bf16 v[24:27], v[196:199], v[112:115], v[24:27]
  buffer_load_dwordx4 a[84:87], v2, s[8:11], s49 offen offset:1024
  v_mfma_f32_16x16x32_bf16 v[20:23], v[208:211], v[116:119], v[20:23]
  v_mfma_f32_16x16x32_bf16 v[24:27], v[212:215], v[116:119], v[24:27]
  v_mfma_f32_16x16x32_bf16 v[20:23], v[224:227], v[120:123], v[20:23]
  v_mfma_f32_16x16x32_bf16 v[24:27], v[228:231], v[120:123], v[24:27]
  v_xor_b32 v136, 8192, v7
  ds_write_b128 v136, v[28:31] offset:34816
  v_mfma_f32_16x16x32_bf16 v[20:23], v[240:243], v[124:127], v[20:23]
  ds_write_b128 v136, v[32:35] offset:35840
  v_mfma_f32_16x16x32_bf16 v[24:27], v[244:247], v[124:127], v[24:27]
  buffer_load_dwordx4 a[88:91], v2, s[8:11], s49 offen offset:2048
  s_waitcnt lgkmcnt(0)
  s_barrier
  ds_read_b128 v[28:31], v7 offset:34816
  ds_read_b128 v[32:35], v7 offset:35840
  ds_read_b128 v[36:39], v7 offset:36864
  ds_read_b128 v[40:43], v7 offset:37888
  ds_read_b128 v[44:47], v7 offset:38912
  ds_read_b128 v[48:51], v7 offset:39936
  v_lshlrev_b32 v52, 16, v140
  v_and_b32 v53, 0xffff0000, v140
  v_lshlrev_b32 v54, 16, v141
  v_and_b32 v55, 0xffff0000, v141
  v_lshlrev_b32 v56, 16, v142
  buffer_load_dwordx4 a[92:95], v2, s[8:11], s49 offen offset:3072
  v_and_b32 v57, 0xffff0000, v142
  v_lshlrev_b32 v58, 16, v143
  v_and_b32 v59, 0xffff0000, v143
  v_pk_add_f32 v[20:21], v[20:21], v[52:53]
  v_pk_add_f32 v[22:23], v[22:23], v[54:55]
  s_add_u32 s49, s41, 24576
  buffer_load_dwordx4 a[96:99], v2, s[8:11], s49 offen offset:0
  v_pk_add_f32 v[24:25], v[24:25], v[56:57]
  v_pk_add_f32 v[26:27], v[26:27], v[58:59]
  s_waitcnt lgkmcnt(5)
  v_pk_add_f32 v[20:21], v[20:21], v[28:29]
  v_pk_add_f32 v[22:23], v[22:23], v[30:31]
  s_waitcnt lgkmcnt(4)
  v_pk_add_f32 v[24:25], v[24:25], v[32:33]
  buffer_load_dwordx4 a[100:103], v2, s[8:11], s49 offen offset:1024
  v_pk_add_f32 v[26:27], v[26:27], v[34:35]
  s_waitcnt lgkmcnt(3)
  v_pk_add_f32 v[20:21], v[20:21], v[36:37]
  v_pk_add_f32 v[22:23], v[22:23], v[38:39]
  s_waitcnt lgkmcnt(2)
  v_pk_add_f32 v[24:25], v[24:25], v[40:41]
  v_pk_add_f32 v[26:27], v[26:27], v[42:43]
  buffer_load_dwordx4 a[104:107], v2, s[8:11], s49 offen offset:2048
  s_waitcnt lgkmcnt(1)
  v_pk_add_f32 v[20:21], v[20:21], v[44:45]
  v_pk_add_f32 v[22:23], v[22:23], v[46:47]
  s_waitcnt lgkmcnt(0)
  v_pk_add_f32 v[24:25], v[24:25], v[48:49]
  v_pk_add_f32 v[26:27], v[26:27], v[50:51]
  v_cvt_pk_bf16_f32 v60, v20, v21
  buffer_load_dwordx4 a[108:111], v2, s[8:11], s49 offen offset:3072
  v_cvt_pk_bf16_f32 v61, v22, v23
  v_cvt_pk_bf16_f32 v62, v24, v25
  v_cvt_pk_bf16_f32 v63, v26, v27
  s_add_u32 s58, s47, 13631488
  buffer_store_dwordx4 v[60:63], v2, s[8:11], s58 offen sc1
  v_pk_add_f32 v[52:53], v[20:21], v[22:23]
  v_pk_add_f32 v[54:55], v[24:25], v[26:27]
  s_add_u32 s49, s41, 28672
  buffer_load_dwordx4 a[112:115], v2, s[8:11], s49 offen offset:0
  v_pk_mul_f32 v[56:57], v[20:21], v[20:21]
  v_pk_add_f32 v[52:53], v[52:53], v[54:55]
  v_pk_fma_f32 v[56:57], v[22:23], v[22:23], v[56:57]
  v_pk_fma_f32 v[56:57], v[24:25], v[24:25], v[56:57]
  v_pk_fma_f32 v[56:57], v[26:27], v[26:27], v[56:57]
  buffer_load_dwordx4 a[116:119], v2, s[8:11], s49 offen offset:1024
  v_add_f32 v52, v52, v53
  v_add_f32 v53, v56, v57
  s_nop 1
  v_permlane16_swap_b32 v52, v53
  v_add_f32 v52, v52, v53
  v_mov_b32 v53, v52
  buffer_load_dwordx4 a[120:123], v2, s[8:11], s49 offen offset:2048
  s_nop 0
  v_permlane32_swap_b32 v52, v53
  v_add_f32 v52, v52, v53
  s_add_u32 s58, s57, 17432576
  v_lshrrev_b32 v54, 2, v2
  s_mov_b32 exec_hi, 0
  buffer_store_dword v52, v54, s[8:11], s58 offen sc1
  s_mov_b32 exec_hi, -1
  s_waitcnt vmcnt(17)
  s_barrier
  ds_read_b128 v[68:71], v2 offset:0
  ds_read_b128 v[72:75], v2 offset:16384
  ds_read_b128 v[76:79], v2 offset:32768
  ds_read_b128 v[80:83], v2 offset:1024
  ds_read_b128 v[84:87], v2 offset:17408
  s_waitcnt lgkmcnt(4)
  v_mfma_f32_16x16x32_bf16 v[28:31], a[4:7], v[68:71], 0
  s_add_u32 m0, s27, 8192
  s_add_u32 s32, s63, 12591104
  v_mfma_f32_16x16x32_bf16 v[40:43], v[68:71], a[8:11], 0
  ds_read_b128 v[68:71], v2 offset:33792
  s_waitcnt lgkmcnt(4)
  v_mfma_f32_16x16x32_bf16 v[20:23], a[0:3], v[72:75], 0
  buffer_load_dwordx4 v2, s[8:11], s32 offen sc1 lds
  v_mfma_f32_16x16x32_bf16 v[32:35], a[4:7], v[72:75], 0
  v_mfma_f32_16x16x32_bf16 v[44:47], v[72:75], a[8:11], 0
  ds_read_b128 v[72:75], v2 offset:2048
  s_waitcnt lgkmcnt(4)
  v_mfma_f32_16x16x32_bf16 v[24:27], a[0:3], v[76:79], 0
  s_add_u32 m0, s27, 24576
  s_add_u32 s32, s66, 12591104
  v_mfma_f32_16x16x32_bf16 v[36:39], a[4:7], v[76:79], 0
  buffer_load_dwordx4 v2, s[8:11], s32 offen sc1 lds
  v_mfma_f32_16x16x32_bf16 v[48:51], v[76:79], a[8:11], 0
  ds_read_b128 v[76:79], v2 offset:18432
  s_waitcnt vmcnt(17)
  s_waitcnt lgkmcnt(4)
  v_mfma_f32_16x16x32_bf16 v[28:31], a[16:19], v[80:83], v[28:31]
  ds_read2_b32 v[88:89], v11 offset0:0 offset1:32
  ds_read2_b32 v[90:91], v11 offset0:64 offset1:96
  v_mfma_f32_16x16x32_bf16 v[40:43], v[80:83], a[20:23], v[40:43]
  ds_read_b128 v[80:83], v2 offset:34816
  s_waitcnt lgkmcnt(6)
  v_mfma_f32_16x16x32_bf16 v[20:23], a[12:15], v[84:87], v[20:23]
  s_add_u32 m0, s27, 40960
  s_add_u32 s32, s66, 12607488
  v_mfma_f32_16x16x32_bf16 v[32:35], a[16:19], v[84:87], v[32:35]
  buffer_load_dwordx4 v2, s[8:11], s32 offen sc1 lds
  v_mfma_f32_16x16x32_bf16 v[44:47], v[84:87], a[20:23], v[44:47]
  ds_read_b128 v[84:87], v2 offset:3072
  s_waitcnt lgkmcnt(6)
  v_mfma_f32_16x16x32_bf16 v[24:27], a[12:15], v[68:71], v[24:27]
  ds_read2_b32 v[92:93], v11 offset0:128 offset1:160
  ds_read2_b32 v[94:95], v11 offset0:192 offset1:224
  v_mfma_f32_16x16x32_bf16 v[36:39], a[16:19], v[68:71], v[36:39]
  s_add_u32 m0, s27, 12288
  s_add_u32 s32, s63, 12595200
  v_mfma_f32_16x16x32_bf16 v[48:51], v[68:71], a[20:23], v[48:51]
  ds_read_b128 v[68:71], v2 offset:19456
  s_waitcnt lgkmcnt(8)
  v_mfma_f32_16x16x32_bf16 v[28:31], a[28:31], v[72:75], v[28:31]
  buffer_load_dwordx4 v2, s[8:11], s32 offen sc1 lds
  v_mfma_f32_16x16x32_bf16 v[40:43], v[72:75], a[32:35], v[40:43]
  ds_read_b128 v[72:75], v2 offset:35840
  s_waitcnt lgkmcnt(8)
  v_mfma_f32_16x16x32_bf16 v[20:23], a[24:27], v[76:79], v[20:23]
  v_mfma_f32_16x16x32_bf16 v[32:35], a[28:31], v[76:79], v[32:35]
  s_add_u32 m0, s27, 28672
  s_add_u32 s32, s66, 12595200
  v_mfma_f32_16x16x32_bf16 v[44:47], v[76:79], a[32:35], v[44:47]
  s_waitcnt vmcnt(16)
  s_barrier
  ds_read_b128 v[76:79], v2 offset:4096
  s_waitcnt lgkmcnt(6)
  v_mfma_f32_16x16x32_bf16 v[24:27], a[24:27], v[80:83], v[24:27]
  buffer_load_dwordx4 v2, s[8:11], s32 offen sc1 lds
  v_mfma_f32_16x16x32_bf16 v[36:39], a[28:31], v[80:83], v[36:39]
  v_mfma_f32_16x16x32_bf16 v[48:51], v[80:83], a[32:35], v[48:51]
  ds_read_b128 v[80:83], v2 offset:20480
  s_waitcnt lgkmcnt(6)
  v_mfma_f32_16x16x32_bf16 v[28:31], a[40:43], v[84:87], v[28:31]
  s_add_u32 m0, s27, 45056
  s_add_u32 s32, s66, 12611584
  v_mfma_f32_16x16x32_bf16 v[40:43], v[84:87], a[44:47], v[40:43]
  ds_read_b128 v[84:87], v2 offset:36864
  s_waitcnt lgkmcnt(4)
  v_mfma_f32_16x16x32_bf16 v[20:23], a[36:39], v[68:71], v[20:23]
  buffer_load_dwordx4 v2, s[8:11], s32 offen sc1 lds
  v_mfma_f32_16x16x32_bf16 v[32:35], a[40:43], v[68:71], v[32:35]
  v_add_f32 v88, v88, v89
  v_add_f32 v90, v90, v91
  v_mfma_f32_16x16x32_bf16 v[44:47], v[68:71], a[44:47], v[44:47]
  ds_read_b128 v[68:71], v2 offset:5120
  s_waitcnt lgkmcnt(4)
  v_mfma_f32_16x16x32_bf16 v[24:27], a[36:39], v[72:75], v[24:27]
  v_add_f32 v92, v92, v93
  v_add_f32 v94, v94, v95
  v_mfma_f32_16x16x32_bf16 v[36:39], a[40:43], v[72:75], v[36:39]
  buffer_load_dwordx4 a[124:127], v2, s[8:11], s49 offen offset:3072
  v_mfma_f32_16x16x32_bf16 v[48:51], v[72:75], a[44:47], v[48:51]
  ds_read_b128 v[72:75], v2 offset:21504
  s_waitcnt lgkmcnt(4)
  v_mfma_f32_16x16x32_bf16 v[28:31], a[52:55], v[76:79], v[28:31]
  v_add_f32 v88, v88, v90
  v_add_f32 v92, v92, v94
  v_mfma_f32_16x16x32_bf16 v[40:43], v[76:79], a[56:59], v[40:43]
  ds_read_b128 v[76:79], v2 offset:37888
  s_waitcnt lgkmcnt(4)
  v_mfma_f32_16x16x32_bf16 v[20:23], a[48:51], v[80:83], v[20:23]
  s_add_u32 s49, s41, 32768
  v_add_f32 v88, v88, v92
  v_mfma_f32_16x16x32_bf16 v[32:35], a[52:55], v[80:83], v[32:35]
  buffer_load_dwordx4 a[128:131], v2, s[8:11], s49 offen offset:0
  v_mfma_f32_16x16x32_bf16 v[44:47], v[80:83], a[56:59], v[44:47]
  ds_read_b128 v[80:83], v2 offset:6144
  s_waitcnt lgkmcnt(4)
  v_mfma_f32_16x16x32_bf16 v[24:27], a[48:51], v[84:87], v[24:27]
  v_mov_b32 v89, v88
  v_mfma_f32_16x16x32_bf16 v[36:39], a[52:55], v[84:87], v[36:39]
  s_nop 0
  v_permlane32_swap_b32 v88, v89
  v_mfma_f32_16x16x32_bf16 v[48:51], v[84:87], a[56:59], v[48:51]
  ds_read_b128 v[84:87], v2 offset:22528
  s_waitcnt lgkmcnt(4)
  v_mfma_f32_16x16x32_bf16 v[28:31], a[64:67], v[68:71], v[28:31]
  buffer_load_dwordx4 a[132:135], v2, s[8:11], s49 offen offset:1024
  v_mfma_f32_16x16x32_bf16 v[40:43], v[68:71], a[68:71], v[40:43]
  ds_read_b128 v[68:71], v2 offset:38912
  s_waitcnt lgkmcnt(4)
  v_mfma_f32_16x16x32_bf16 v[20:23], a[60:63], v[72:75], v[20:23]
  v_add_f32 v88, v88, v89
  v_mov_b32 v89, v88
  v_mfma_f32_16x16x32_bf16 v[32:35], a[64:67], v[72:75], v[32:35]
  s_nop 0
  v_permlane16_swap_b32 v88, v89
  v_mfma_f32_16x16x32_bf16 v[44:47], v[72:75], a[68:71], v[44:47]
  ds_read_b128 v[72:75], v2 offset:7168
  s_waitcnt lgkmcnt(4)
  v_mfma_f32_16x16x32_bf16 v[24:27], a[60:63], v[76:79], v[24:27]
  buffer_load_dwordx4 a[136:139], v2, s[8:11], s49 offen offset:2048
  v_mfma_f32_16x16x32_bf16 v[36:39], a[64:67], v[76:79], v[36:39]
  v_mul_f32 v88, 0xbb000000, v88
  v_mul_f32 v90, v88, v88
  v_mfma_f32_16x16x32_bf16 v[48:51], v[76:79], a[68:71], v[48:51]
  ds_read_b128 v[76:79], v2 offset:23552
  s_waitcnt lgkmcnt(4)
  v_mfma_f32_16x16x32_bf16 v[28:31], a[76:79], v[80:83], v[28:31]
  s_waitcnt vmcnt(10)
  s_barrier
  s_add_u32 s34, s50, 8314880
  v_mfma_f32_16x16x32_bf16 v[40:43], v[80:83], a[80:83], v[40:43]
  ds_read_b128 v[80:83], v2 offset:39936
  s_waitcnt lgkmcnt(4)
  v_mfma_f32_16x16x32_bf16 v[20:23], a[72:75], v[84:87], v[20:23]
  buffer_store_dword v18, v1, s[8:11], s34 offen sc1
  v_mfma_f32_16x16x32_bf16 v[32:35], a[76:79], v[84:87], v[32:35]
  v_fma_f32 v89, v89, s96, -v90
  v_max_f32 v89, 0, v89
  v_mfma_f32_16x16x32_bf16 v[44:47], v[84:87], a[80:83], v[44:47]
  s_waitcnt vmcnt(8)
  s_barrier
  ds_read_b128 v[84:87], v2 offset:8192
  s_waitcnt lgkmcnt(4)
  v_mfma_f32_16x16x32_bf16 v[24:27], a[72:75], v[68:71], v[24:27]
  v_add_f32 v89, s97, v89
  v_mfma_f32_16x16x32_bf16 v[36:39], a[76:79], v[68:71], v[36:39]
  buffer_load_dwordx4 a[140:143], v2, s[8:11], s49 offen offset:3072
  v_mfma_f32_16x16x32_bf16 v[48:51], v[68:71], a[80:83], v[48:51]
  ds_read_b128 v[68:71], v2 offset:24576
  s_waitcnt lgkmcnt(4)
  v_mfma_f32_16x16x32_bf16 v[28:31], a[88:91], v[72:75], v[28:31]
  v_rsq_f32 v89, v89
  v_mfma_f32_16x16x32_bf16 v[40:43], v[72:75], a[92:95], v[40:43]
  ds_read_b128 v[72:75], v2 offset:40960
  s_waitcnt lgkmcnt(4)
  v_mfma_f32_16x16x32_bf16 v[20:23], a[84:87], v[76:79], v[20:23]
  s_add_u32 s49, s41, 36864
  v_cndmask_b32 v88, v88, v89, s[36:37]
  v_mfma_f32_16x16x32_bf16 v[32:35], a[88:91], v[76:79], v[32:35]
  buffer_load_dwordx4 a[144:147], v2, s[8:11], s49 offen offset:0
  v_mfma_f32_16x16x32_bf16 v[44:47], v[76:79], a[92:95], v[44:47]
  ds_read_b128 v[76:79], v2 offset:9216
  s_waitcnt lgkmcnt(4)
  v_mfma_f32_16x16x32_bf16 v[24:27], a[84:87], v[80:83], v[24:27]
  ds_write_b32 v12, v88 offset:0
  v_mfma_f32_16x16x32_bf16 v[36:39], a[88:91], v[80:83], v[36:39]
  v_mfma_f32_16x16x32_bf16 v[48:51], v[80:83], a[92:95], v[48:51]
  ds_read_b128 v[80:83], v2 offset:25600
  s_waitcnt lgkmcnt(5)
  v_mfma_f32_16x16x32_bf16 v[28:31], a[100:103], v[84:87], v[28:31]
  buffer_load_dwordx4 a[148:151], v2, s[8:11], s49 offen offset:1024
  v_mfma_f32_16x16x32_bf16 v[40:43], v[84:87], a[104:107], v[40:43]
  ds_read_b128 v[84:87], v2 offset:41984
  s_waitcnt lgkmcnt(5)
  v_mfma_f32_16x16x32_bf16 v[20:23], a[96:99], v[68:71], v[20:23]
  v_mfma_f32_16x16x32_bf16 v[32:35], a[100:103], v[68:71], v[32:35]
  v_mfma_f32_16x16x32_bf16 v[44:47], v[68:71], a[104:107], v[44:47]
  ds_read_b128 v[68:71], v2 offset:10240
  s_waitcnt lgkmcnt(5)
  v_mfma_f32_16x16x32_bf16 v[24:27], a[96:99], v[72:75], v[24:27]
  buffer_load_dwordx4 a[152:155], v2, s[8:11], s49 offen offset:2048
  v_mfma_f32_16x16x32_bf16 v[36:39], a[100:103], v[72:75], v[36:39]
  v_mfma_f32_16x16x32_bf16 v[48:51], v[72:75], a[104:107], v[48:51]
  ds_read_b128 v[72:75], v2 offset:26624
  s_waitcnt lgkmcnt(5)
  v_mfma_f32_16x16x32_bf16 v[28:31], a[112:115], v[76:79], v[28:31]
  v_mfma_f32_16x16x32_bf16 v[40:43], v[76:79], a[116:119], v[40:43]
  ds_read_b128 v[76:79], v2 offset:43008
  s_waitcnt lgkmcnt(4)
  v_mfma_f32_16x16x32_bf16 v[20:23], a[108:111], v[80:83], v[20:23]
  buffer_load_dwordx4 a[156:159], v2, s[8:11], s49 offen offset:3072
  v_mfma_f32_16x16x32_bf16 v[32:35], a[112:115], v[80:83], v[32:35]
  v_mfma_f32_16x16x32_bf16 v[44:47], v[80:83], a[116:119], v[44:47]
  ds_read_b128 v[80:83], v2 offset:11264
  s_waitcnt lgkmcnt(4)
  v_mfma_f32_16x16x32_bf16 v[24:27], a[108:111], v[84:87], v[24:27]
  s_add_u32 s49, s41, 40960
  v_mfma_f32_16x16x32_bf16 v[36:39], a[112:115], v[84:87], v[36:39]
  buffer_load_dwordx4 a[160:163], v2, s[8:11], s49 offen offset:0
  v_mfma_f32_16x16x32_bf16 v[48:51], v[84:87], a[116:119], v[48:51]
  ds_read_b128 v[84:87], v2 offset:27648
  s_waitcnt vmcnt(10) lgkmcnt(4)
  v_mfma_f32_16x16x32_bf16 v[28:31], a[124:127], v[68:71], v[28:31]
  s_waitcnt vmcnt(9)
  v_mfma_f32_16x16x32_bf16 v[40:43], v[68:71], a[128:131], v[40:43]
  ds_read_b128 v[68:71], v2 offset:44032
  s_waitcnt lgkmcnt(4)
  v_mfma_f32_16x16x32_bf16 v[20:23], a[120:123], v[72:75], v[20:23]
  buffer_load_dwordx4 a[164:167], v2, s[8:11], s49 offen offset:1024
  v_mfma_f32_16x16x32_bf16 v[32:35], a[124:127], v[72:75], v[32:35]
  v_mfma_f32_16x16x32_bf16 v[44:47], v[72:75], a[128:131], v[44:47]
  s_barrier
  ds_read_b128 v[72:75], v2 offset:12288
  s_waitcnt lgkmcnt(4)
  v_mfma_f32_16x16x32_bf16 v[24:27], a[120:123], v[76:79], v[24:27]
  v_mfma_f32_16x16x32_bf16 v[36:39], a[124:127], v[76:79], v[36:39]
  buffer_load_dwordx4 a[168:171], v2, s[8:11], s49 offen offset:2048
  v_mfma_f32_16x16x32_bf16 v[48:51], v[76:79], a[128:131], v[48:51]
  ds_read_b128 v[76:79], v2 offset:28672
  s_waitcnt vmcnt(9) lgkmcnt(4)
  v_mfma_f32_16x16x32_bf16 v[28:31], a[136:139], v[80:83], v[28:31]
  s_waitcnt vmcnt(7)
  v_mfma_f32_16x16x32_bf16 v[40:43], v[80:83], a[140:143], v[40:43]
  ds_read_b128 v[80:83], v2 offset:45056
  s_waitcnt lgkmcnt(4)
  v_mfma_f32_16x16x32_bf16 v[20:23], a[132:135], v[84:87], v[20:23]
  buffer_load_dwordx4 a[172:175], v2, s[8:11], s49 offen offset:3072
  v_mfma_f32_16x16x32_bf16 v[32:35], a[136:139], v[84:87], v[32:35]
  v_mfma_f32_16x16x32_bf16 v[44:47], v[84:87], a[140:143], v[44:47]
  ds_read_b128 v[84:87], v2 offset:13312
  s_waitcnt lgkmcnt(4)
  v_mfma_f32_16x16x32_bf16 v[24:27], a[132:135], v[68:71], v[24:27]
  s_add_u32 s49, s41, 45056
  v_mfma_f32_16x16x32_bf16 v[36:39], a[136:139], v[68:71], v[36:39]
  buffer_load_dwordx4 a[176:179], v2, s[8:11], s49 offen offset:0
  v_mfma_f32_16x16x32_bf16 v[48:51], v[68:71], a[140:143], v[48:51]
  ds_read_b128 v[68:71], v2 offset:29696
  s_waitcnt vmcnt(7) lgkmcnt(4)
  v_mfma_f32_16x16x32_bf16 v[28:31], a[148:151], v[72:75], v[28:31]
  s_add_u32 s35, s55, 8314880
  s_waitcnt vmcnt(6)
  v_mfma_f32_16x16x32_bf16 v[40:43], v[72:75], a[152:155], v[40:43]
  ds_read_b128 v[72:75], v2 offset:46080
  s_waitcnt lgkmcnt(4)
  v_mfma_f32_16x16x32_bf16 v[20:23], a[144:147], v[76:79], v[20:23]
  buffer_load_dword v19, v0, s[8:11], s35 offen sc1
  v_mfma_f32_16x16x32_bf16 v[32:35], a[148:151], v[76:79], v[32:35]
  v_mfma_f32_16x16x32_bf16 v[44:47], v[76:79], a[152:155], v[44:47]
  ds_read_b128 v[76:79], v2 offset:14336
  s_barrier
  s_waitcnt lgkmcnt(4)
  v_mfma_f32_16x16x32_bf16 v[24:27], a[144:147], v[80:83], v[24:27]
  v_mfma_f32_16x16x32_bf16 v[36:39], a[148:151], v[80:83], v[36:39]
  buffer_load_dwordx4 a[180:183], v2, s[8:11], s49 offen offset:1024
  v_mfma_f32_16x16x32_bf16 v[48:51], v[80:83], a[152:155], v[48:51]
  ds_read_b128 v[80:83], v2 offset:30720
  ds_read_b128 v[52:55], v14 offset:0
  s_waitcnt vmcnt(6) lgkmcnt(5)
  v_mfma_f32_16x16x32_bf16 v[28:31], a[160:163], v[84:87], v[28:31]
  s_waitcnt vmcnt(5)
  v_mfma_f32_16x16x32_bf16 v[40:43], v[84:87], a[164:167], v[40:43]
  ds_read_b128 v[84:87], v2 offset:47104
  ds_read_b128 v[56:59], v14 offset:256
  s_waitcnt lgkmcnt(6)
  v_mfma_f32_16x16x32_bf16 v[20:23], a[156:159], v[68:71], v[20:23]
  buffer_load_dwordx4 a[184:187], v2, s[8:11], s49 offen offset:2048
  v_mfma_f32_16x16x32_bf16 v[32:35], a[160:163], v[68:71], v[32:35]
  v_mfma_f32_16x16x32_bf16 v[44:47], v[68:71], a[164:167], v[44:47]
  ds_read_b128 v[68:71], v2 offset:15360
  ds_read_b128 v[60:63], v14 offset:64
  s_waitcnt lgkmcnt(7)
  v_mfma_f32_16x16x32_bf16 v[24:27], a[156:159], v[72:75], v[24:27]
  v_mfma_f32_16x16x32_bf16 v[36:39], a[160:163], v[72:75], v[36:39]
  buffer_load_dwordx4 a[188:191], v2, s[8:11], s49 offen offset:3072
  v_mfma_f32_16x16x32_bf16 v[48:51], v[72:75], a[164:167], v[48:51]
  ds_read_b128 v[72:75], v2 offset:31744
  ds_read_b128 v[64:67], v14 offset:320
  s_waitcnt vmcnt(5) lgkmcnt(8)
  v_mfma_f32_16x16x32_bf16 v[28:31], a[172:175], v[76:79], v[28:31]
  s_waitcnt vmcnt(4)
  v_mfma_f32_16x16x32_bf16 v[40:43], v[76:79], a[176:179], v[40:43]
  ds_read_b128 v[76:79], v2 offset:48128
  s_waitcnt lgkmcnt(8)
  v_mfma_f32_16x16x32_bf16 v[20:23], a[168:171], v[80:83], v[20:23]
  s_add_u32 s49, s42, 0
  v_mfma_f32_16x16x32_bf16 v[32:35], a[172:175], v[80:83], v[32:35]
  buffer_load_dwordx4 a[192:195], v2, s[8:11], s49 offen offset:0
  v_mfma_f32_16x16x32_bf16 v[44:47], v[80:83], a[176:179], v[44:47]
  ds_read_b128 v[80:83], v15 offset:64
  s_waitcnt lgkmcnt(7)
  v_mfma_f32_16x16x32_bf16 v[24:27], a[168:171], v[84:87], v[24:27]
  v_mfma_f32_16x16x32_bf16 v[36:39], a[172:175], v[84:87], v[36:39]
  v_mfma_f32_16x16x32_bf16 v[48:51], v[84:87], a[176:179], v[48:51]
  ds_read_b32 v84, v16
  s_waitcnt vmcnt(2) lgkmcnt(6)
  v_mfma_f32_16x16x32_bf16 v[28:31], a[184:187], v[68:71], v[28:31]
  buffer_load_dwordx4 a[196:199], v2, s[8:11], s49 offen offset:1024
  s_waitcnt vmcnt(2)
  v_mfma_f32_16x16x32_bf16 v[40:43], v[68:71], a[188:191], v[40:43]
  ds_read_b64 v[68:69], v13 offset:0
  ds_read_b64 v[70:71], v13 offset:128
  s_waitcnt lgkmcnt(6)
  v_mfma_f32_16x16x32_bf16 v[20:23], a[180:183], v[72:75], v[20:23]
  v_mfma_f32_16x16x32_bf16 v[32:35], a[184:187], v[72:75], v[32:35]
  v_mfma_f32_16x16x32_bf16 v[44:47], v[72:75], a[188:191], v[44:47]
  ds_read_b64 v[72:73], v13 offset:256
  s_waitcnt lgkmcnt(5)
  v_mfma_f32_16x16x32_bf16 v[24:27], a[180:183], v[76:79], v[24:27]
  buffer_load_dwordx4 a[200:203], v2, s[8:11], s49 offen offset:2048
  v_mfma_f32_16x16x32_bf16 v[36:39], a[184:187], v[76:79], v[36:39]
  v_mfma_f32_16x16x32_bf16 v[48:51], v[76:79], a[188:191], v[48:51]
  ds_read_b128 v[76:79], v15 offset:0
  v_cmp_ne_u32 vcc, s61, v19
  s_nop 0
  s_and_b64 vcc, vcc, s[100:101]
  s_cbranch_vccnz SLOW_10
BACK_10:
  s_barrier
  s_barrier
  s_waitcnt lgkmcnt(0)
  v_pk_fma_f32 v[20:21], v[70:71], v[76:77], v[20:21] op_sel_hi:[0,1,1]
  v_pk_fma_f32 v[22:23], v[70:71], v[78:79], v[22:23] op_sel_hi:[0,1,1]
  v_mul_f32 v86, s98, v71
  v_pk_mul_f32 v[20:21], v[20:21], v[86:87] op_sel_hi:[1,0]
  v_pk_mul_f32 v[22:23], v[22:23], v[86:87] op_sel_hi:[1,0]
  v_cvt_pk_bf16_f32 v20, v20, v21
  v_cvt_pk_bf16_f32 v21, v22, v23
  v_pk_fma_f32 v[24:25], v[72:73], v[76:77], v[24:25] op_sel_hi:[0,1,1]
  v_pk_fma_f32 v[26:27], v[72:73], v[78:79], v[26:27] op_sel_hi:[0,1,1]
  v_mul_f32 v86, s98, v73
  s_add_u32 m0, s27, 65536
  s_add_u32 s32, s63, 13631488
  buffer_load_dwordx4 v2, s[8:11], s32 offen sc1 lds
  v_pk_mul_f32 v[24:25], v[24:25], v[86:87] op_sel_hi:[1,0]
  v_pk_mul_f32 v[26:27], v[26:27], v[86:87] op_sel_hi:[1,0]
  v_cvt_pk_bf16_f32 v24, v24, v25
  v_cvt_pk_bf16_f32 v25, v26, v27
  v_pk_fma_f32 v[28:29], v[68:69], v[80:81], v[28:29] op_sel_hi:[0,1,1]
  v_pk_fma_f32 v[30:31], v[68:69], v[82:83], v[30:31] op_sel_hi:[0,1,1]
  v_pk_mul_f32 v[28:29], v[28:29], v[68:69] op_sel:[0,1] op_sel_hi:[1,1]
  v_pk_mul_f32 v[30:31], v[30:31], v[68:69] op_sel:[0,1] op_sel_hi:[1,1]
  v_cvt_pk_bf16_f32 v28, v28, v29
  v_cvt_pk_bf16_f32 v29, v30, v31
  s_add_u32 m0, s27, 81920
  s_add_u32 s32, s66, 13631488
  buffer_load_dwordx4 v2, s[8:11], s32 offen sc1 lds
  v_pk_fma_f32 v[32:33], v[70:71], v[80:81], v[32:33] op_sel_hi:[0,1,1]
  v_pk_fma_f32 v[34:35], v[70:71], v[82:83], v[34:35] op_sel_hi:[0,1,1]
  v_pk_mul_f32 v[32:33], v[32:33], v[70:71] op_sel:[0,1] op_sel_hi:[1,1]
  v_pk_mul_f32 v[34:35], v[34:35], v[70:71] op_sel:[0,1] op_sel_hi:[1,1]
  v_cvt_pk_bf16_f32 v32, v32, v33
  v_cvt_pk_bf16_f32 v33, v34, v35
  v_pk_fma_f32 v[36:37], v[72:73], v[80:81], v[36:37] op_sel_hi:[0,1,1]
  v_pk_fma_f32 v[38:39], v[72:73], v[82:83], v[38:39] op_sel_hi:[0,1,1]
  v_pk_mul_f32 v[36:37], v[36:37], v[72:73] op_sel:[0,1] op_sel_hi:[1,1]
  v_pk_mul_f32 v[38:39], v[38:39], v[72:73] op_sel:[0,1] op_sel_hi:[1,1]
  s_add_u32 m0, s27, 98304
  s_add_u32 s32, s66, 13647872
  buffer_load_dwordx4 v2, s[8:11], s32 offen sc1 lds
  v_cvt_pk_bf16_f32 v36, v36, v37
  v_cvt_pk_bf16_f32 v37, v38, v39
  v_add_u32 v138, 151552, v2
  ds_read_b128 v[68:71], v17
  ds_read_b128 v[72:75], v138 offset:1024
  ds_read_b128 v[76:79], v138 offset:0
  v_pk_fma_f32 v[40:41], v[52:53], v[84:85], v[40:41] op_sel_hi:[1,0,1]
  v_pk_fma_f32 v[42:43], v[54:55], v[84:85], v[42:43] op_sel_hi:[1,0,1]
  v_pk_mul_f32 v[40:41], v[40:41], v[56:57]
  v_pk_mul_f32 v[42:43], v[42:43], v[58:59]
  ds_read_b128 v[52:55], v14 offset:128
  ds_read_b128 v[56:59], v14 offset:384
  v_cvt_pk_bf16_f32 v40, v40, v41
  v_cvt_pk_bf16_f32 v41, v42, v43
  v_pk_fma_f32 v[44:45], v[60:61], v[84:85], v[44:45] op_sel_hi:[1,0,1]
  s_lshl_b32 s33, s16, 11
  s_add_u32 m0, s33, 139264
  s_add_u32 s32, s25, 17432576
  buffer_load_dwordx4 v2, s[8:11], s32 offen offset:0 sc1 lds
  v_pk_fma_f32 v[46:47], v[62:63], v[84:85], v[46:47] op_sel_hi:[1,0,1]
  v_pk_mul_f32 v[44:45], v[44:45], v[64:65]
  v_pk_mul_f32 v[46:47], v[46:47], v[66:67]
  v_cvt_pk_bf16_f32 v44, v44, v45
  v_cvt_pk_bf16_f32 v45, v46, v47
  s_waitcnt lgkmcnt(1)
  v_pk_fma_f32 v[48:49], v[52:53], v[84:85], v[48:49] op_sel_hi:[1,0,1]
  v_pk_fma_f32 v[50:51], v[54:55], v[84:85], v[50:51] op_sel_hi:[1,0,1]
  s_waitcnt lgkmcnt(0)
  v_pk_mul_f32 v[48:49], v[48:49], v[56:57]
  v_pk_mul_f32 v[50:51], v[50:51], v[58:59]
  v_cvt_pk_bf16_f32 v48, v48, v49
  s_lshl_b32 s33, s16, 11
  s_add_u32 m0, s33, 139264
  s_add_u32 s32, s25, 17432576
  buffer_load_dwordx4 v2, s[8:11], s32 offen offset:1024 sc1 lds
  v_cvt_pk_bf16_f32 v49, v50, v51
  v_mfma_f32_16x16x16_bf16 v[52:55], v[28:29], v[20:21], v[68:71]
  v_mfma_f32_16x16x16_bf16 v[56:59], v[32:33], v[20:21], v[76:79]
  v_mfma_f32_16x16x16_bf16 v[60:63], v[32:33], v[24:25], v[72:75]
  v_mfma_f32_16x16x16_bf16 v[64:67], v[36:37], v[24:25], v[76:79]
  s_nop 4
  v_max3_f32 v80, v52, v53, v54
  v_max3_f32 v81, v55, v56, v57
  v_max3_f32 v80, v80, v58, v59
  v_max_f32 v80, v80, v81
  v_max3_f32 v84, v60, v61, v62
  s_add_u32 m0, s27, 69632
  s_add_u32 s32, s63, 13635584
  buffer_load_dwordx4 v2, s[8:11], s32 offen sc1 lds
  v_max3_f32 v85, v63, v64, v65
  v_max3_f32 v84, v84, v66, v67
  v_max_f32 v84, v84, v85
  v_mov_b32 v81, v80
  v_mov_b32 v85, v84
  s_nop 0
  v_permlane16_swap_b32 v80, v81
  v_permlane16_swap_b32 v84, v85
  v_max_f32 v80, v80, v81
  v_max_f32 v84, v84, v85
  v_mov_b32 v81, v80
  s_add_u32 m0, s27, 86016
  s_add_u32 s32, s66, 13635584
  buffer_load_dwordx4 v2, s[8:11], s32 offen sc1 lds
  v_mov_b32 v85, v84
  v_permlane32_swap_b32 v80, v81
  s_nop 0
  v_permlane32_swap_b32 v84, v85
  v_max_f32 v80, v80, v81
  v_max_f32 v84, v84, v85
  v_pk_add_f32 v[52:53], v[52:53], v[80:81] op_sel_hi:[1,0] neg_lo:[0,1] neg_hi:[0,1]
  v_pk_add_f32 v[54:55], v[54:55], v[80:81] op_sel_hi:[1,0] neg_lo:[0,1] neg_hi:[0,1]
  v_pk_add_f32 v[56:57], v[56:57], v[80:81] op_sel_hi:[1,0] neg_lo:[0,1] neg_hi:[0,1]
  v_pk_add_f32 v[58:59], v[58:59], v[80:81] op_sel_hi:[1,0] neg_lo:[0,1] neg_hi:[0,1]
  v_pk_add_f32 v[60:61], v[60:61], v[84:85] op_sel_hi:[1,0] neg_lo:[0,1] neg_hi:[0,1]
  s_add_u32 m0, s27, 102400
  s_add_u32 s32, s66, 13651968
  buffer_load_dwordx4 v2, s[8:11], s32 offen sc1 lds
  v_pk_add_f32 v[62:63], v[62:63], v[84:85] op_sel_hi:[1,0] neg_lo:[0,1] neg_hi:[0,1]
  v_pk_add_f32 v[64:65], v[64:65], v[84:85] op_sel_hi:[1,0] neg_lo:[0,1] neg_hi:[0,1]
  v_pk_add_f32 v[66:67], v[66:67], v[84:85] op_sel_hi:[1,0] neg_lo:[0,1] neg_hi:[0,1]
  v_exp_f32 v52, v52
  v_exp_f32 v56, v56
  v_exp_f32 v53, v53
  v_exp_f32 v57, v57
  v_exp_f32 v54, v54
  v_exp_f32 v58, v58
  v_exp_f32 v55, v55
  buffer_load_dwordx4 a[204:207], v2, s[8:11], s49 offen offset:3072
  v_exp_f32 v59, v59
  v_exp_f32 v60, v60
  v_exp_f32 v64, v64
  v_exp_f32 v61, v61
  v_exp_f32 v65, v65
  v_exp_f32 v62, v62
  v_exp_f32 v66, v66
  v_exp_f32 v63, v63
  v_exp_f32 v67, v67
  v_mov_b32 v76, 0x3f803f80
  s_add_u32 s49, s42, 4096
  buffer_load_dwordx4 a[208:211], v2, s[8:11], s49 offen offset:0
  v_mov_b32 v77, 0x3f803f80
  v_cvt_pk_bf16_f32 v52, v52, v53
  v_cvt_pk_bf16_f32 v53, v54, v55
  v_cvt_pk_bf16_f32 v56, v56, v57
  v_cvt_pk_bf16_f32 v57, v58, v59
  v_cvt_pk_bf16_f32 v60, v60, v61
  v_cvt_pk_bf16_f32 v61, v62, v63
  v_cvt_pk_bf16_f32 v64, v64, v65
  v_cvt_pk_bf16_f32 v65, v66, v67
  v_mfma_f32_16x16x16_bf16 v[80:83], v[76:77], v[52:53], 0
  buffer_load_dwordx4 a[212:215], v2, s[8:11], s49 offen offset:1024
  v_mfma_f32_16x16x16_bf16 v[84:87], v[76:77], v[60:61], 0
  v_mfma_f32_16x16x16_bf16 v[20:23], v[40:41], v[52:53], 0
  v_mfma_f32_16x16x16_bf16 v[24:27], v[44:45], v[60:61], 0
  v_mfma_f32_16x16x16_bf16 v[80:83], v[76:77], v[56:57], v[80:83]
  v_mfma_f32_16x16x16_bf16 v[84:87], v[76:77], v[64:65], v[84:87]
  v_mfma_f32_16x16x16_bf16 v[20:23], v[44:45], v[56:57], v[20:23]
  v_mfma_f32_16x16x16_bf16 v[24:27], v[48:49], v[64:65], v[24:27]
  s_nop 4
  v_rcp_f32 v80, v80
  v_rcp_f32 v84, v84
  v_pk_mul_f32 v[20:21], v[20:21], v[80:81] op_sel_hi:[1,0]
  buffer_load_dwordx4 a[216:219], v2, s[8:11], s49 offen offset:2048
  v_pk_mul_f32 v[22:23], v[22:23], v[80:81] op_sel_hi:[1,0]
  v_pk_mul_f32 v[24:25], v[24:25], v[84:85] op_sel_hi:[1,0]
  v_pk_mul_f32 v[26:27], v[26:27], v[84:85] op_sel_hi:[1,0]
  v_cvt_pk_bf16_f32 v20, v20, v21
  v_cvt_pk_bf16_f32 v21, v22, v23
  v_cvt_pk_bf16_f32 v22, v24, v25
  v_cvt_pk_bf16_f32 v23, v26, v27
  s_nop 0
  v_permlane16_swap_b32 v20, v22
  v_permlane16_swap_b32 v21, v23
  s_add_u32 s58, s45, 20971520
  buffer_store_dwordx4 v[20:23], v4, s[8:11], s58 offen sc1
  buffer_load_dwordx4 a[220:223], v2, s[8:11], s49 offen offset:3072
  s_add_u32 s49, s42, 8192
  buffer_load_dwordx4 a[224:227], v2, s[8:11], s49 offen offset:0
  buffer_load_dwordx4 a[228:231], v2, s[8:11], s49 offen offset:1024
  buffer_load_dwordx4 a[232:235], v2, s[8:11], s49 offen offset:2048
  buffer_load_dwordx4 a[236:239], v2, s[8:11], s49 offen offset:3072
  s_add_u32 s49, s42, 12288
  buffer_load_dwordx4 a[240:243], v2, s[8:11], s49 offen offset:0
  buffer_load_dwordx4 a[244:247], v2, s[8:11], s49 offen offset:1024
  buffer_load_dwordx4 a[248:251], v2, s[8:11], s49 offen offset:2048
  buffer_load_dwordx4 a[252:255], v2, s[8:11], s49 offen offset:3072
  s_waitcnt vmcnt(19)
  s_barrier
  ds_read_b128 v[68:71], v3 offset:0
  ds_read_b128 v[72:75], v3 offset:16384
  ds_read_b128 v[76:79], v3 offset:32768
  ds_read_b128 v[80:83], v3 offset:1024
  ds_read_b128 v[84:87], v3 offset:17408
  s_waitcnt lgkmcnt(4)
  v_mfma_f32_16x16x32_bf16 v[28:31], a[4:7], v[68:71], 0
  s_add_u32 m0, s27, 73728
  s_add_u32 s32, s63, 13639680
  v_mfma_f32_16x16x32_bf16 v[40:43], v[68:71], a[8:11], 0
  ds_read_b128 v[68:71], v3 offset:33792
  s_waitcnt lgkmcnt(4)
  v_mfma_f32_16x16x32_bf16 v[20:23], a[0:3], v[72:75], 0
  buffer_load_dwordx4 v2, s[8:11], s32 offen sc1 lds
  v_mfma_f32_16x16x32_bf16 v[32:35], a[4:7], v[72:75], 0
  v_mfma_f32_16x16x32_bf16 v[44:47], v[72:75], a[8:11], 0
  ds_read_b128 v[72:75], v3 offset:2048
  s_waitcnt lgkmcnt(4)
  v_mfma_f32_16x16x32_bf16 v[24:27], a[0:3], v[76:79], 0
  s_add_u32 m0, s27, 90112
  s_add_u32 s32, s66, 13639680
  v_mfma_f32_16x16x32_bf16 v[36:39], a[4:7], v[76:79], 0
  buffer_load_dwordx4 v2, s[8:11], s32 offen sc1 lds
  v_mfma_f32_16x16x32_bf16 v[48:51], v[76:79], a[8:11], 0
  ds_read_b128 v[76:79], v3 offset:18432
  s_waitcnt lgkmcnt(4)
  v_mfma_f32_16x16x32_bf16 v[28:31], a[16:19], v[80:83], v[28:31]
  v_add_u32 v96, 8192, v11
  s_waitcnt vmcnt(19)
  v_mfma_f32_16x16x32_bf16 v[40:43], v[80:83], a[20:23], v[40:43]
  ds_read_b128 v[80:83], v3 offset:34816
  s_waitcnt lgkmcnt(4)
  v_mfma_f32_16x16x32_bf16 v[20:23], a[12:15], v[84:87], v[20:23]
  s_add_u32 m0, s27, 106496
  s_add_u32 s32, s66, 13656064
  v_mfma_f32_16x16x32_bf16 v[32:35], a[16:19], v[84:87], v[32:35]
  buffer_load_dwordx4 v2, s[8:11], s32 offen sc1 lds
  v_mfma_f32_16x16x32_bf16 v[44:47], v[84:87], a[20:23], v[44:47]
  ds_read_b128 v[84:87], v3 offset:3072
  s_waitcnt lgkmcnt(4)
  v_mfma_f32_16x16x32_bf16 v[24:27], a[12:15], v[68:71], v[24:27]
  ds_read2_b32 v[88:89], v96 offset0:0 offset1:32
  ds_read2_b32 v[90:91], v96 offset0:64 offset1:96
  v_mfma_f32_16x16x32_bf16 v[36:39], a[16:19], v[68:71], v[36:39]
  s_add_u32 m0, s27, 77824
  s_add_u32 s32, s63, 13643776
  v_mfma_f32_16x16x32_bf16 v[48:51], v[68:71], a[20:23], v[48:51]
  ds_read_b128 v[68:71], v3 offset:19456
  s_waitcnt lgkmcnt(6)
  v_mfma_f32_16x16x32_bf16 v[28:31], a[28:31], v[72:75], v[28:31]
  buffer_load_dwordx4 v2, s[8:11], s32 offen sc1 lds
  v_mfma_f32_16x16x32_bf16 v[40:43], v[72:75], a[32:35], v[40:43]
  ds_read_b128 v[72:75], v3 offset:35840
  s_waitcnt lgkmcnt(6)
  v_mfma_f32_16x16x32_bf16 v[20:23], a[24:27], v[76:79], v[20:23]
  ds_read2_b32 v[92:93], v96 offset0:128 offset1:160
  ds_read2_b32 v[94:95], v96 offset0:192 offset1:224
  v_mfma_f32_16x16x32_bf16 v[32:35], a[28:31], v[76:79], v[32:35]
  s_add_u32 m0, s27, 94208
  s_add_u32 s32, s66, 13643776
  v_mfma_f32_16x16x32_bf16 v[44:47], v[76:79], a[32:35], v[44:47]
  s_waitcnt vmcnt(18)
  s_barrier
  ds_read_b128 v[76:79], v3 offset:4096
  s_waitcnt lgkmcnt(8)
  v_mfma_f32_16x16x32_bf16 v[24:27], a[24:27], v[80:83], v[24:27]
  buffer_load_dwordx4 v2, s[8:11], s32 offen sc1 lds
  v_mfma_f32_16x16x32_bf16 v[36:39], a[28:31], v[80:83], v[36:39]
  v_mfma_f32_16x16x32_bf16 v[48:51], v[80:83], a[32:35], v[48:51]
  ds_read_b128 v[80:83], v3 offset:20480
  s_waitcnt lgkmcnt(8)
  v_mfma_f32_16x16x32_bf16 v[28:31], a[40:43], v[84:87], v[28:31]
  s_add_u32 m0, s27, 110592
  s_add_u32 s32, s66, 13660160
  v_mfma_f32_16x16x32_bf16 v[40:43], v[84:87], a[44:47], v[40:43]
  ds_read_b128 v[84:87], v3 offset:36864
  s_waitcnt lgkmcnt(6)
  v_mfma_f32_16x16x32_bf16 v[20:23], a[36:39], v[68:71], v[20:23]
  buffer_load_dwordx4 v2, s[8:11], s32 offen sc1 lds
  v_mfma_f32_16x16x32_bf16 v[32:35], a[40:43], v[68:71], v[32:35]
  v_mfma_f32_16x16x32_bf16 v[44:47], v[68:71], a[44:47], v[44:47]
  ds_read_b128 v[68:71], v3 offset:5120
  s_waitcnt lgkmcnt(6)
  v_mfma_f32_16x16x32_bf16 v[24:27], a[36:39], v[72:75], v[24:27]
  s_add_u32 s49, s43, 0
  v_add_f32 v88, v88, v89
  v_mfma_f32_16x16x32_bf16 v[36:39], a[40:43], v[72:75], v[36:39]
  buffer_load_dwordx4 a[0:3], v2, s[8:11], s49 offen offset:0
  v_mfma_f32_16x16x32_bf16 v[48:51], v[72:75], a[44:47], v[48:51]
  ds_read_b128 v[72:75], v3 offset:21504
  s_waitcnt lgkmcnt(4)
  v_mfma_f32_16x16x32_bf16 v[28:31], a[52:55], v[76:79], v[28:31]
  v_add_f32 v90, v90, v91
  v_add_f32 v92, v92, v93
  v_mfma_f32_16x16x32_bf16 v[40:43], v[76:79], a[56:59], v[40:43]
  ds_read_b128 v[76:79], v3 offset:37888
  s_waitcnt lgkmcnt(4)
  v_mfma_f32_16x16x32_bf16 v[20:23], a[48:51], v[80:83], v[20:23]
  buffer_load_dwordx4 a[4:7], v2, s[8:11], s49 offen offset:1024
  v_mfma_f32_16x16x32_bf16 v[32:35], a[52:55], v[80:83], v[32:35]
  v_add_f32 v94, v94, v95
  v_add_f32 v88, v88, v90
  v_mfma_f32_16x16x32_bf16 v[44:47], v[80:83], a[56:59], v[44:47]
  ds_read_b128 v[80:83], v3 offset:6144
  s_waitcnt lgkmcnt(4)
  v_mfma_f32_16x16x32_bf16 v[24:27], a[48:51], v[84:87], v[24:27]
  v_add_f32 v92, v92, v94
  v_add_f32 v88, v88, v92
  v_mfma_f32_16x16x32_bf16 v[36:39], a[52:55], v[84:87], v[36:39]
  buffer_load_dwordx4 a[8:11], v2, s[8:11], s49 offen offset:2048
  v_mfma_f32_16x16x32_bf16 v[48:51], v[84:87], a[56:59], v[48:51]
  ds_read_b128 v[84:87], v3 offset:22528
  s_waitcnt lgkmcnt(4)
  v_mfma_f32_16x16x32_bf16 v[28:31], a[64:67], v[68:71], v[28:31]
  v_mov_b32 v89, v88
  v_mfma_f32_16x16x32_bf16 v[40:43], v[68:71], a[68:71], v[40:43]
  ds_read_b128 v[68:71], v3 offset:38912
  s_waitcnt lgkmcnt(4)
  v_mfma_f32_16x16x32_bf16 v[20:23], a[60:63], v[72:75], v[20:23]
  buffer_load_dwordx4 a[12:15], v2, s[8:11], s49 offen offset:3072
  v_mfma_f32_16x16x32_bf16 v[32:35], a[64:67], v[72:75], v[32:35]
  v_permlane32_swap_b32 v88, v89
  v_mfma_f32_16x16x32_bf16 v[44:47], v[72:75], a[68:71], v[44:47]
  ds_read_b128 v[72:75], v3 offset:7168
  s_waitcnt vmcnt(19)
  s_waitcnt lgkmcnt(4)
  v_mfma_f32_16x16x32_bf16 v[24:27], a[60:63], v[76:79], v[24:27]
  s_barrier
  s_add_u32 s34, s50, 8323072
  s_cmp_eq_u32 s7, 1
  v_mfma_f32_16x16x32_bf16 v[36:39], a[64:67], v[76:79], v[36:39]
  s_cbranch_scc1 IMP_6
  buffer_store_dword v18, v1, s[8:11], s34 offen
IMPB_6:
  s_add_u32 s49, s43, 4096
  v_mfma_f32_16x16x32_bf16 v[48:51], v[76:79], a[68:71], v[48:51]
  ds_read_b128 v[76:79], v3 offset:23552
  s_waitcnt lgkmcnt(4)
  v_mfma_f32_16x16x32_bf16 v[28:31], a[76:79], v[80:83], v[28:31]
  buffer_load_dwordx4 a[16:19], v2, s[8:11], s49 offen offset:0
  v_mfma_f32_16x16x32_bf16 v[40:43], v[80:83], a[80:83], v[40:43]
  ds_read_b128 v[80:83], v3 offset:39936
  s_waitcnt lgkmcnt(4)
  v_mfma_f32_16x16x32_bf16 v[20:23], a[72:75], v[84:87], v[20:23]
  v_add_f32 v88, v88, v89
  v_mov_b32 v89, v88
  v_mfma_f32_16x16x32_bf16 v[32:35], a[76:79], v[84:87], v[32:35]
  s_nop 0
  v_permlane16_swap_b32 v88, v89
  v_mfma_f32_16x16x32_bf16 v[44:47], v[84:87], a[80:83], v[44:47]
  s_waitcnt vmcnt(9)
  s_barrier
  ds_read_b128 v[84:87], v3 offset:8192
  s_waitcnt lgkmcnt(4)
  v_mfma_f32_16x16x32_bf16 v[24:27], a[72:75], v[68:71], v[24:27]
  buffer_load_dwordx4 a[20:23], v2, s[8:11], s49 offen offset:1024
  v_mfma_f32_16x16x32_bf16 v[36:39], a[76:79], v[68:71], v[36:39]
  v_mul_f32 v88, 0xbb000000, v88
  v_mul_f32 v90, v88, v88
  v_mfma_f32_16x16x32_bf16 v[48:51], v[68:71], a[80:83], v[48:51]
  ds_read_b128 v[68:71], v3 offset:24576
  s_waitcnt lgkmcnt(4)
  v_mfma_f32_16x16x32_bf16 v[28:31], a[88:91], v[72:75], v[28:31]
  v_fma_f32 v89, v89, s96, -v90
  v_max_f32 v89, 0, v89
  v_mfma_f32_16x16x32_bf16 v[40:43], v[72:75], a[92:95], v[40:43]
  ds_read_b128 v[72:75], v3 offset:40960
  s_waitcnt lgkmcnt(4)
  v_mfma_f32_16x16x32_bf16 v[20:23], a[84:87], v[76:79], v[20:23]
  buffer_load_dwordx4 a[24:27], v2, s[8:11], s49 offen offset:2048
  v_mfma_f32_16x16x32_bf16 v[32:35], a[88:91], v[76:79], v[32:35]
  v_add_f32 v89, s97, v89
  v_mfma_f32_16x16x32_bf16 v[44:47], v[76:79], a[92:95], v[44:47]
  ds_read_b128 v[76:79], v3 offset:9216
  s_waitcnt lgkmcnt(4)
  v_mfma_f32_16x16x32_bf16 v[24:27], a[84:87], v[80:83], v[24:27]
  v_rsq_f32 v89, v89
  v_mfma_f32_16x16x32_bf16 v[36:39], a[88:91], v[80:83], v[36:39]
  buffer_load_dwordx4 a[28:31], v2, s[8:11], s49 offen offset:3072
  v_mfma_f32_16x16x32_bf16 v[48:51], v[80:83], a[92:95], v[48:51]
  ds_read_b128 v[80:83], v3 offset:25600
  s_waitcnt lgkmcnt(4)
  v_mfma_f32_16x16x32_bf16 v[28:31], a[100:103], v[84:87], v[28:31]
  v_cndmask_b32 v88, v88, v89, s[36:37]
  ds_write_b32 v12, v88 offset:1024
  v_mfma_f32_16x16x32_bf16 v[40:43], v[84:87], a[104:107], v[40:43]
  ds_read_b128 v[84:87], v3 offset:41984
  s_waitcnt lgkmcnt(5)
  v_mfma_f32_16x16x32_bf16 v[20:23], a[96:99], v[68:71], v[20:23]
  s_add_u32 s49, s43, 8192
  v_mfma_f32_16x16x32_bf16 v[32:35], a[100:103], v[68:71], v[32:35]
  buffer_load_dwordx4 a[32:35], v2, s[8:11], s49 offen offset:0
  v_mfma_f32_16x16x32_bf16 v[44:47], v[68:71], a[104:107], v[44:47]
  ds_read_b128 v[68:71], v3 offset:10240
  s_waitcnt lgkmcnt(5)
  v_mfma_f32_16x16x32_bf16 v[24:27], a[96:99], v[72:75], v[24:27]
  v_mfma_f32_16x16x32_bf16 v[36:39], a[100:103], v[72:75], v[36:39]
  v_mfma_f32_16x16x32_bf16 v[48:51], v[72:75], a[104:107], v[48:51]
  ds_read_b128 v[72:75], v3 offset:26624
  s_waitcnt lgkmcnt(5)
  v_mfma_f32_16x16x32_bf16 v[28:31], a[112:115], v[76:79], v[28:31]
  buffer_load_dwordx4 a[36:39], v2, s[8:11], s49 offen offset:1024
  v_mfma_f32_16x16x32_bf16 v[40:43], v[76:79], a[116:119], v[40:43]
  ds_read_b128 v[76:79], v3 offset:43008
  s_waitcnt lgkmcnt(5)
  v_mfma_f32_16x16x32_bf16 v[20:23], a[108:111], v[80:83], v[20:23]
  v_mfma_f32_16x16x32_bf16 v[32:35], a[112:115], v[80:83], v[32:35]
  v_mfma_f32_16x16x32_bf16 v[44:47], v[80:83], a[116:119], v[44:47]
  ds_read_b128 v[80:83], v3 offset:11264
  s_waitcnt lgkmcnt(4)
  v_mfma_f32_16x16x32_bf16 v[24:27], a[108:111], v[84:87], v[24:27]
  buffer_load_dwordx4 a[40:43], v2, s[8:11], s49 offen offset:2048
  v_mfma_f32_16x16x32_bf16 v[36:39], a[112:115], v[84:87], v[36:39]
  v_mfma_f32_16x16x32_bf16 v[48:51], v[84:87], a[116:119], v[48:51]
  ds_read_b128 v[84:87], v3 offset:27648
  s_waitcnt lgkmcnt(4)
  v_mfma_f32_16x16x32_bf16 v[28:31], a[124:127], v[68:71], v[28:31]
  v_mfma_f32_16x16x32_bf16 v[40:43], v[68:71], a[128:131], v[40:43]
  ds_read_b128 v[68:71], v3 offset:44032
  s_waitcnt lgkmcnt(4)
  v_mfma_f32_16x16x32_bf16 v[20:23], a[120:123], v[72:75], v[20:23]
  buffer_load_dwordx4 a[44:47], v2, s[8:11], s49 offen offset:3072
  v_mfma_f32_16x16x32_bf16 v[32:35], a[124:127], v[72:75], v[32:35]
  v_mfma_f32_16x16x32_bf16 v[44:47], v[72:75], a[128:131], v[44:47]
  s_waitcnt vmcnt(13)
  s_barrier
  ds_read_b128 v[72:75], v3 offset:12288
  s_waitcnt lgkmcnt(4)
  v_mfma_f32_16x16x32_bf16 v[24:27], a[120:123], v[76:79], v[24:27]
  s_add_u32 s49, s43, 12288
  v_mfma_f32_16x16x32_bf16 v[36:39], a[124:127], v[76:79], v[36:39]
  buffer_load_dwordx4 a[48:51], v2, s[8:11], s49 offen offset:0
  v_mfma_f32_16x16x32_bf16 v[48:51], v[76:79], a[128:131], v[48:51]
  ds_read_b128 v[76:79], v3 offset:28672
  s_waitcnt lgkmcnt(4)
  v_mfma_f32_16x16x32_bf16 v[28:31], a[136:139], v[80:83], v[28:31]
  v_mfma_f32_16x16x32_bf16 v[40:43], v[80:83], a[140:143], v[40:43]
  ds_read_b128 v[80:83], v3 offset:45056
  s_waitcnt lgkmcnt(4)
  v_mfma_f32_16x16x32_bf16 v[20:23], a[132:135], v[84:87], v[20:23]
  buffer_load_dwordx4 a[52:55], v2, s[8:11], s49 offen offset:1024
  v_mfma_f32_16x16x32_bf16 v[32:35], a[136:139], v[84:87], v[32:35]
  v_mfma_f32_16x16x32_bf16 v[44:47], v[84:87], a[140:143], v[44:47]
  ds_read_b128 v[84:87], v3 offset:13312
  s_waitcnt lgkmcnt(4)
  v_mfma_f32_16x16x32_bf16 v[24:27], a[132:135], v[68:71], v[24:27]
  v_mfma_f32_16x16x32_bf16 v[36:39], a[136:139], v[68:71], v[36:39]
  buffer_load_dwordx4 a[56:59], v2, s[8:11], s49 offen offset:2048
  v_mfma_f32_16x16x32_bf16 v[48:51], v[68:71], a[140:143], v[48:51]
  ds_read_b128 v[68:71], v3 offset:29696
  s_waitcnt lgkmcnt(4)
  v_mfma_f32_16x16x32_bf16 v[28:31], a[148:151], v[72:75], v[28:31]
  s_add_u32 s35, s52, 8323072
  v_mfma_f32_16x16x32_bf16 v[40:43], v[72:75], a[152:155], v[40:43]
  ds_read_b128 v[72:75], v3 offset:46080
  s_waitcnt lgkmcnt(4)
  v_mfma_f32_16x16x32_bf16 v[20:23], a[144:147], v[76:79], v[20:23]
  buffer_load_dword v19, v9, s[8:11], s35 offen sc1
  v_mfma_f32_16x16x32_bf16 v[32:35], a[148:151], v[76:79], v[32:35]
  v_mfma_f32_16x16x32_bf16 v[44:47], v[76:79], a[152:155], v[44:47]
  ds_read_b128 v[76:79], v3 offset:14336
  s_barrier
  s_waitcnt lgkmcnt(4)
  v_mfma_f32_16x16x32_bf16 v[24:27], a[144:147], v[80:83], v[24:27]
  v_mfma_f32_16x16x32_bf16 v[36:39], a[148:151], v[80:83], v[36:39]
  buffer_load_dwordx4 a[60:63], v2, s[8:11], s49 offen offset:3072
  v_mfma_f32_16x16x32_bf16 v[48:51], v[80:83], a[152:155], v[48:51]
  ds_read_b128 v[80:83], v3 offset:30720
  ds_read_b128 v[52:55], v14 offset:1024
  s_waitcnt lgkmcnt(5)
  v_mfma_f32_16x16x32_bf16 v[28:31], a[160:163], v[84:87], v[28:31]
  v_mfma_f32_16x16x32_bf16 v[40:43], v[84:87], a[164:167], v[40:43]
  ds_read_b128 v[84:87], v3 offset:47104
  ds_read_b128 v[56:59], v14 offset:1280
  s_waitcnt lgkmcnt(6)
  v_mfma_f32_16x16x32_bf16 v[20:23], a[156:159], v[68:71], v[20:23]
  s_add_u32 s49, s43, 16384
  v_mfma_f32_16x16x32_bf16 v[32:35], a[160:163], v[68:71], v[32:35]
  buffer_load_dwordx4 a[64:67], v2, s[8:11], s49 offen offset:0
  v_mfma_f32_16x16x32_bf16 v[44:47], v[68:71], a[164:167], v[44:47]
  ds_read_b128 v[68:71], v3 offset:15360
  ds_read_b128 v[60:63], v14 offset:1088
  s_waitcnt lgkmcnt(7)
  v_mfma_f32_16x16x32_bf16 v[24:27], a[156:159], v[72:75], v[24:27]
  v_mfma_f32_16x16x32_bf16 v[36:39], a[160:163], v[72:75], v[36:39]
  v_mfma_f32_16x16x32_bf16 v[48:51], v[72:75], a[164:167], v[48:51]
  ds_read_b128 v[72:75], v3 offset:31744
  ds_read_b128 v[64:67], v14 offset:1344
  s_waitcnt lgkmcnt(8)
  v_mfma_f32_16x16x32_bf16 v[28:31], a[172:175], v[76:79], v[28:31]
  buffer_load_dwordx4 a[68:71], v2, s[8:11], s49 offen offset:1024
  v_mfma_f32_16x16x32_bf16 v[40:43], v[76:79], a[176:179], v[40:43]
  ds_read_b128 v[76:79], v3 offset:48128
  s_waitcnt lgkmcnt(8)
  v_mfma_f32_16x16x32_bf16 v[20:23], a[168:171], v[80:83], v[20:23]
  v_mfma_f32_16x16x32_bf16 v[32:35], a[172:175], v[80:83], v[32:35]
  v_mfma_f32_16x16x32_bf16 v[44:47], v[80:83], a[176:179], v[44:47]
  ds_read_b128 v[80:83], v15 offset:64
  s_waitcnt lgkmcnt(7)
  v_mfma_f32_16x16x32_bf16 v[24:27], a[168:171], v[84:87], v[24:27]
  buffer_load_dwordx4 a[72:75], v2, s[8:11], s49 offen offset:2048
  v_mfma_f32_16x16x32_bf16 v[36:39], a[172:175], v[84:87], v[36:39]
  v_mfma_f32_16x16x32_bf16 v[48:51], v[84:87], a[176:179], v[48:51]
  ds_read_b32 v84, v16
  s_waitcnt lgkmcnt(6)
  v_mfma_f32_16x16x32_bf16 v[28:31], a[184:187], v[68:71], v[28:31]
  v_mfma_f32_16x16x32_bf16 v[40:43], v[68:71], a[188:191], v[40:43]
  ds_read_b64 v[68:69], v13 offset:1024
  ds_read_b64 v[70:71], v13 offset:1152
  s_waitcnt lgkmcnt(6)
  v_mfma_f32_16x16x32_bf16 v[20:23], a[180:183], v[72:75], v[20:23]
  buffer_load_dwordx4 a[76:79], v2, s[8:11], s49 offen offset:3072
  v_mfma_f32_16x16x32_bf16 v[32:35], a[184:187], v[72:75], v[32:35]
  v_mfma_f32_16x16x32_bf16 v[44:47], v[72:75], a[188:191], v[44:47]
  ds_read_b64 v[72:73], v13 offset:1280
  s_waitcnt lgkmcnt(5)
  v_mfma_f32_16x16x32_bf16 v[24:27], a[180:183], v[76:79], v[24:27]
  s_add_u32 s49, s43, 20480
  v_mfma_f32_16x16x32_bf16 v[36:39], a[184:187], v[76:79], v[36:39]
  buffer_load_dwordx4 a[80:83], v2, s[8:11], s49 offen offset:0
  v_mfma_f32_16x16x32_bf16 v[48:51], v[76:79], a[188:191], v[48:51]
  ds_read_b128 v[76:79], v15 offset:0
  s_waitcnt vmcnt(6)
  v_cmp_ne_u32 vcc, s61, v19
  s_nop 0
  s_and_b64 vcc, vcc, s[28:29]
  s_cbranch_vccnz SLOW_11
BACK_11:
  s_barrier
  s_barrier
  s_waitcnt lgkmcnt(0)
  v_pk_fma_f32 v[20:21], v[70:71], v[76:77], v[20:21] op_sel_hi:[0,1,1]
  v_pk_fma_f32 v[22:23], v[70:71], v[78:79], v[22:23] op_sel_hi:[0,1,1]
  v_mul_f32 v86, s98, v71
  v_pk_mul_f32 v[20:21], v[20:21], v[86:87] op_sel_hi:[1,0]
  v_pk_mul_f32 v[22:23], v[22:23], v[86:87] op_sel_hi:[1,0]
  v_cvt_pk_bf16_f32 v20, v20, v21
  v_cvt_pk_bf16_f32 v21, v22, v23
  v_pk_fma_f32 v[24:25], v[72:73], v[76:77], v[24:25] op_sel_hi:[0,1,1]
  v_pk_fma_f32 v[26:27], v[72:73], v[78:79], v[26:27] op_sel_hi:[0,1,1]
  v_mul_f32 v86, s98, v73
  s_add_u32 s32, s60, 20971520
  buffer_load_dwordx4 v[88:91], v2, s[8:11], s32 offen offset:0 sc1
  v_pk_mul_f32 v[24:25], v[24:25], v[86:87] op_sel_hi:[1,0]
  v_pk_mul_f32 v[26:27], v[26:27], v[86:87] op_sel_hi:[1,0]
  v_cvt_pk_bf16_f32 v24, v24, v25
  v_cvt_pk_bf16_f32 v25, v26, v27
  v_pk_fma_f32 v[28:29], v[68:69], v[80:81], v[28:29] op_sel_hi:[0,1,1]
  v_pk_fma_f32 v[30:31], v[68:69], v[82:83], v[30:31] op_sel_hi:[0,1,1]
  v_pk_mul_f32 v[28:29], v[28:29], v[68:69] op_sel:[0,1] op_sel_hi:[1,1]
  v_pk_mul_f32 v[30:31], v[30:31], v[68:69] op_sel:[0,1] op_sel_hi:[1,1]
  v_cvt_pk_bf16_f32 v28, v28, v29
  v_cvt_pk_bf16_f32 v29, v30, v31
  s_add_u32 s32, s60, 20971520
  buffer_load_dwordx4 v[92:95], v2, s[8:11], s32 offen offset:1024 sc1
  v_pk_fma_f32 v[32:33], v[70:71], v[80:81], v[32:33] op_sel_hi:[0,1,1]
  v_pk_fma_f32 v[34:35], v[70:71], v[82:83], v[34:35] op_sel_hi:[0,1,1]
  v_pk_mul_f32 v[32:33], v[32:33], v[70:71] op_sel:[0,1] op_sel_hi:[1,1]
  v_pk_mul_f32 v[34:35], v[34:35], v[70:71] op_sel:[0,1] op_sel_hi:[1,1]
  v_cvt_pk_bf16_f32 v32, v32, v33
  v_cvt_pk_bf16_f32 v33, v34, v35
  v_pk_fma_f32 v[36:37], v[72:73], v[80:81], v[36:37] op_sel_hi:[0,1,1]
  v_pk_fma_f32 v[38:39], v[72:73], v[82:83], v[38:39] op_sel_hi:[0,1,1]
  v_pk_mul_f32 v[36:37], v[36:37], v[72:73] op_sel:[0,1] op_sel_hi:[1,1]
  v_pk_mul_f32 v[38:39], v[38:39], v[72:73] op_sel:[0,1] op_sel_hi:[1,1]
  s_add_u32 s32, s60, 20971520
  buffer_load_dwordx4 v[96:99], v2, s[8:11], s32 offen offset:2048 sc1
  v_cvt_pk_bf16_f32 v36, v36, v37
  v_cvt_pk_bf16_f32 v37, v38, v39
  v_add_u32 v138, 151552, v2
  ds_read_b128 v[68:71], v17
  ds_read_b128 v[72:75], v138 offset:1024
  ds_read_b128 v[76:79], v138 offset:0
  v_pk_fma_f32 v[40:41], v[52:53], v[84:85], v[40:41] op_sel_hi:[1,0,1]
  v_pk_fma_f32 v[42:43], v[54:55], v[84:85], v[42:43] op_sel_hi:[1,0,1]
  v_pk_mul_f32 v[40:41], v[40:41], v[56:57]
  v_pk_mul_f32 v[42:43], v[42:43], v[58:59]
  ds_read_b128 v[52:55], v14 offset:1152
  ds_read_b128 v[56:59], v14 offset:1408
  v_cvt_pk_bf16_f32 v40, v40, v41
  v_cvt_pk_bf16_f32 v41, v42, v43
  v_pk_fma_f32 v[44:45], v[60:61], v[84:85], v[44:45] op_sel_hi:[1,0,1]
  s_add_u32 s32, s60, 20971520
  buffer_load_dwordx4 v[100:103], v2, s[8:11], s32 offen offset:3072 sc1
  v_pk_fma_f32 v[46:47], v[62:63], v[84:85], v[46:47] op_sel_hi:[1,0,1]
  v_pk_mul_f32 v[44:45], v[44:45], v[64:65]
  v_pk_mul_f32 v[46:47], v[46:47], v[66:67]
  v_cvt_pk_bf16_f32 v44, v44, v45
  v_cvt_pk_bf16_f32 v45, v46, v47
  s_waitcnt lgkmcnt(1)
  v_pk_fma_f32 v[48:49], v[52:53], v[84:85], v[48:49] op_sel_hi:[1,0,1]
  v_pk_fma_f32 v[50:51], v[54:55], v[84:85], v[50:51] op_sel_hi:[1,0,1]
  s_waitcnt lgkmcnt(0)
  v_pk_mul_f32 v[48:49], v[48:49], v[56:57]
  v_pk_mul_f32 v[50:51], v[50:51], v[58:59]
  v_cvt_pk_bf16_f32 v48, v48, v49
  s_add_u32 s32, s47, 12582912
  buffer_load_dwordx4 v[140:143], v2, s[8:11], s32 offen sc1
  v_cvt_pk_bf16_f32 v49, v50, v51
  v_mfma_f32_16x16x16_bf16 v[52:55], v[28:29], v[20:21], v[68:71]
  v_mfma_f32_16x16x16_bf16 v[56:59], v[32:33], v[20:21], v[76:79]
  v_mfma_f32_16x16x16_bf16 v[60:63], v[32:33], v[24:25], v[72:75]
  v_mfma_f32_16x16x16_bf16 v[64:67], v[36:37], v[24:25], v[76:79]
  s_nop 4
  v_max3_f32 v80, v52, v53, v54
  v_max3_f32 v81, v55, v56, v57
  v_max3_f32 v80, v80, v58, v59
  v_max_f32 v80, v80, v81
  v_max3_f32 v84, v60, v61, v62
  s_add_u32 s32, s46, 20971520
  buffer_load_dwordx4 v[104:107], v2, s[8:11], s32 offen offset:0 sc1
  v_max3_f32 v85, v63, v64, v65
  v_max3_f32 v84, v84, v66, v67
  v_max_f32 v84, v84, v85
  v_mov_b32 v81, v80
  v_mov_b32 v85, v84
  s_nop 0
  v_permlane16_swap_b32 v80, v81
  v_permlane16_swap_b32 v84, v85
  v_max_f32 v80, v80, v81
  v_max_f32 v84, v84, v85
  v_mov_b32 v81, v80
  s_add_u32 s32, s46, 20971520
  buffer_load_dwordx4 v[108:111], v2, s[8:11], s32 offen offset:1024 sc1
  v_mov_b32 v85, v84
  v_permlane32_swap_b32 v80, v81
  s_nop 0
  v_permlane32_swap_b32 v84, v85
  v_max_f32 v80, v80, v81
  v_max_f32 v84, v84, v85
  v_pk_add_f32 v[52:53], v[52:53], v[80:81] op_sel_hi:[1,0] neg_lo:[0,1] neg_hi:[0,1]
  v_pk_add_f32 v[54:55], v[54:55], v[80:81] op_sel_hi:[1,0] neg_lo:[0,1] neg_hi:[0,1]
  v_pk_add_f32 v[56:57], v[56:57], v[80:81] op_sel_hi:[1,0] neg_lo:[0,1] neg_hi:[0,1]
  v_pk_add_f32 v[58:59], v[58:59], v[80:81] op_sel_hi:[1,0] neg_lo:[0,1] neg_hi:[0,1]
  v_pk_add_f32 v[60:61], v[60:61], v[84:85] op_sel_hi:[1,0] neg_lo:[0,1] neg_hi:[0,1]
  s_add_u32 s32, s46, 20971520
  buffer_load_dwordx4 v[112:115], v2, s[8:11], s32 offen offset:2048 sc1
  v_pk_add_f32 v[62:63], v[62:63], v[84:85] op_sel_hi:[1,0] neg_lo:[0,1] neg_hi:[0,1]
  v_pk_add_f32 v[64:65], v[64:65], v[84:85] op_sel_hi:[1,0] neg_lo:[0,1] neg_hi:[0,1]
  v_pk_add_f32 v[66:67], v[66:67], v[84:85] op_sel_hi:[1,0] neg_lo:[0,1] neg_hi:[0,1]
  v_exp_f32 v52, v52
  v_exp_f32 v56, v56
  v_exp_f32 v53, v53
  v_exp_f32 v57, v57
  v_exp_f32 v54, v54
  v_exp_f32 v58, v58
  v_exp_f32 v55, v55
  s_add_u32 s32, s46, 20971520
  buffer_load_dwordx4 v[116:119], v2, s[8:11], s32 offen offset:3072 sc1
  v_exp_f32 v59, v59
  v_exp_f32 v60, v60
  v_exp_f32 v64, v64
  v_exp_f32 v61, v61
  v_exp_f32 v65, v65
  v_exp_f32 v62, v62
  v_exp_f32 v66, v66
  v_exp_f32 v63, v63
  v_exp_f32 v67, v67
  v_mov_b32 v76, 0x3f803f80
  buffer_load_dwordx4 a[84:87], v2, s[8:11], s49 offen offset:1024
  v_mov_b32 v77, 0x3f803f80
  v_cvt_pk_bf16_f32 v52, v52, v53
  v_cvt_pk_bf16_f32 v53, v54, v55
  v_cvt_pk_bf16_f32 v56, v56, v57
  v_cvt_pk_bf16_f32 v57, v58, v59
  v_cvt_pk_bf16_f32 v60, v60, v61
  v_cvt_pk_bf16_f32 v61, v62, v63
  v_cvt_pk_bf16_f32 v64, v64, v65
  v_cvt_pk_bf16_f32 v65, v66, v67
  v_mfma_f32_16x16x16_bf16 v[80:83], v[76:77], v[52:53], 0
  buffer_load_dwordx4 a[88:91], v2, s[8:11], s49 offen offset:2048
  v_mfma_f32_16x16x16_bf16 v[84:87], v[76:77], v[60:61], 0
  v_mfma_f32_16x16x16_bf16 v[20:23], v[40:41], v[52:53], 0
  v_mfma_f32_16x16x16_bf16 v[24:27], v[44:45], v[60:61], 0
  v_mfma_f32_16x16x16_bf16 v[80:83], v[76:77], v[56:57], v[80:83]
  v_mfma_f32_16x16x16_bf16 v[84:87], v[76:77], v[64:65], v[84:87]
  v_mfma_f32_16x16x16_bf16 v[20:23], v[44:45], v[56:57], v[20:23]
  v_mfma_f32_16x16x16_bf16 v[24:27], v[48:49], v[64:65], v[24:27]
  s_nop 4
  v_rcp_f32 v80, v80
  v_rcp_f32 v84, v84
  v_pk_mul_f32 v[20:21], v[20:21], v[80:81] op_sel_hi:[1,0]
  buffer_load_dwordx4 a[92:95], v2, s[8:11], s49 offen offset:3072
  v_pk_mul_f32 v[22:23], v[22:23], v[80:81] op_sel_hi:[1,0]
  v_pk_mul_f32 v[24:25], v[24:25], v[84:85] op_sel_hi:[1,0]
  v_pk_mul_f32 v[26:27], v[26:27], v[84:85] op_sel_hi:[1,0]
  v_cvt_pk_bf16_f32 v20, v20, v21
  v_cvt_pk_bf16_f32 v21, v22, v23
  v_cvt_pk_bf16_f32 v22, v24, v25
  v_cvt_pk_bf16_f32 v23, v26, v27
  s_nop 0
  v_permlane16_swap_b32 v20, v22
  v_permlane16_swap_b32 v21, v23
  s_add_u32 s58, s45, 22020096
  buffer_store_dwordx4 v[20:23], v4, s[8:11], s58 offen sc1
  s_waitcnt vmcnt(12)
  v_mfma_f32_16x16x32_bf16 v[36:39], a[192:195], v[88:91], 0
  s_add_u32 s49, s43, 24576
  v_mfma_f32_16x16x32_bf16 v[40:43], a[196:199], v[88:91], 0
  buffer_load_dwordx4 a[96:99], v2, s[8:11], s49 offen offset:0
  v_mfma_f32_16x16x32_bf16 v[44:47], a[200:203], v[88:91], 0
  v_mfma_f32_16x16x32_bf16 v[48:51], a[204:207], v[88:91], 0
  s_waitcnt vmcnt(12)
  v_mfma_f32_16x16x32_bf16 v[36:39], a[208:211], v[92:95], v[36:39]
  v_mfma_f32_16x16x32_bf16 v[40:43], a[212:215], v[92:95], v[40:43]
  buffer_load_dwordx4 a[100:103], v2, s[8:11], s49 offen offset:1024
  v_mfma_f32_16x16x32_bf16 v[44:47], a[216:219], v[92:95], v[44:47]
  v_mfma_f32_16x16x32_bf16 v[48:51], a[220:223], v[92:95], v[48:51]
  s_waitcnt vmcnt(12)
  v_mfma_f32_16x16x32_bf16 v[36:39], a[224:227], v[96:99], v[36:39]
  v_mfma_f32_16x16x32_bf16 v[40:43], a[228:231], v[96:99], v[40:43]
  buffer_load_dwordx4 a[104:107], v2, s[8:11], s49 offen offset:2048
  v_mfma_f32_16x16x32_bf16 v[44:47], a[232:235], v[96:99], v[44:47]
  v_mfma_f32_16x16x32_bf16 v[48:51], a[236:239], v[96:99], v[48:51]
  s_waitcnt vmcnt(12)
  v_mfma_f32_16x16x32_bf16 v[36:39], a[240:243], v[100:103], v[36:39]
  v_mfma_f32_16x16x32_bf16 v[40:43], a[244:247], v[100:103], v[40:43]
  buffer_load_dwordx4 a[108:111], v2, s[8:11], s49 offen offset:3072
  v_mfma_f32_16x16x32_bf16 v[44:47], a[248:251], v[100:103], v[44:47]
  v_mfma_f32_16x16x32_bf16 v[48:51], a[252:255], v[100:103], v[48:51]
  s_waitcnt vmcnt(11)
  v_mfma_f32_16x16x32_bf16 v[28:31], a[200:203], v[104:107], 0
  s_add_u32 s49, s43, 28672
  v_mfma_f32_16x16x32_bf16 v[32:35], a[204:207], v[104:107], 0
  buffer_load_dwordx4 a[112:115], v2, s[8:11], s49 offen offset:0
  s_waitcnt vmcnt(11)
  v_mfma_f32_16x16x32_bf16 v[28:31], a[216:219], v[108:111], v[28:31]
  v_mfma_f32_16x16x32_bf16 v[32:35], a[220:223], v[108:111], v[32:35]
  s_waitcnt vmcnt(10)
  v_mfma_f32_16x16x32_bf16 v[28:31], a[232:235], v[112:115], v[28:31]
  v_mfma_f32_16x16x32_bf16 v[32:35], a[236:239], v[112:115], v[32:35]
  buffer_load_dwordx4 a[116:119], v2, s[8:11], s49 offen offset:1024
  s_waitcnt vmcnt(10)
  v_mfma_f32_16x16x32_bf16 v[28:31], a[248:251], v[116:119], v[28:31]
  v_mfma_f32_16x16x32_bf16 v[32:35], a[252:255], v[116:119], v[32:35]
  v_mfma_f32_16x16x32_bf16 v[20:23], a[192:195], v[104:107], 0
  v_mfma_f32_16x16x32_bf16 v[24:27], a[196:199], v[104:107], 0
  v_xor_b32 v137, 16384, v7
  v_xor_b32 v138, 24576, v7
  v_mfma_f32_16x16x32_bf16 v[20:23], a[208:211], v[108:111], v[20:23]
  ds_write_b128 v137, v[36:39] offset:4096
  ds_write_b128 v137, v[40:43] offset:5120
  v_mfma_f32_16x16x32_bf16 v[24:27], a[212:215], v[108:111], v[24:27]
  ds_write_b128 v138, v[44:47] offset:6144
  ds_write_b128 v138, v[48:51] offset:7168
  v_mfma_f32_16x16x32_bf16 v[20:23], a[224:227], v[112:115], v[20:23]
  buffer_load_dwordx4 a[120:123], v2, s[8:11], s49 offen offset:2048
  v_mfma_f32_16x16x32_bf16 v[24:27], a[228:231], v[112:115], v[24:27]
  v_mfma_f32_16x16x32_bf16 v[20:23], a[240:243], v[116:119], v[20:23]
  v_mfma_f32_16x16x32_bf16 v[24:27], a[244:247], v[116:119], v[24:27]
  buffer_load_dwordx4 a[124:127], v2, s[8:11], s49 offen offset:3072
  v_xor_b32 v136, 8192, v7
  ds_write_b128 v136, v[28:31] offset:2048
  ds_write_b128 v136, v[32:35] offset:3072
  s_waitcnt lgkmcnt(0)
  s_barrier
  ds_read_b128 v[28:31], v7 offset:2048
  ds_read_b128 v[32:35], v7 offset:3072
  ds_read_b128 v[36:39], v7 offset:4096
  ds_read_b128 v[40:43], v7 offset:5120
  ds_read_b128 v[44:47], v7 offset:6144
  ds_read_b128 v[48:51], v7 offset:7168
  v_lshlrev_b32 v52, 16, v140
  v_and_b32 v53, 0xffff0000, v140
  v_lshlrev_b32 v54, 16, v141
  v_and_b32 v55, 0xffff0000, v141
  v_lshlrev_b32 v56, 16, v142
  v_and_b32 v57, 0xffff0000, v142
  v_lshlrev_b32 v58, 16, v143
  v_and_b32 v59, 0xffff0000, v143
  v_pk_add_f32 v[20:21], v[20:21], v[52:53]
  v_pk_add_f32 v[22:23], v[22:23], v[54:55]
  v_pk_add_f32 v[24:25], v[24:25], v[56:57]
  v_pk_add_f32 v[26:27], v[26:27], v[58:59]
  s_waitcnt lgkmcnt(5)
  v_pk_add_f32 v[20:21], v[20:21], v[28:29]
  v_pk_add_f32 v[22:23], v[22:23], v[30:31]
  s_waitcnt lgkmcnt(4)
  v_pk_add_f32 v[24:25], v[24:25], v[32:33]
  v_pk_add_f32 v[26:27], v[26:27], v[34:35]
  s_waitcnt lgkmcnt(3)
  v_pk_add_f32 v[20:21], v[20:21], v[36:37]
  v_pk_add_f32 v[22:23], v[22:23], v[38:39]
  s_waitcnt lgkmcnt(2)
  v_pk_add_f32 v[24:25], v[24:25], v[40:41]
  v_pk_add_f32 v[26:27], v[26:27], v[42:43]
  s_waitcnt lgkmcnt(1)
  v_pk_add_f32 v[20:21], v[20:21], v[44:45]
  v_pk_add_f32 v[22:23], v[22:23], v[46:47]
  s_waitcnt lgkmcnt(0)
  v_pk_add_f32 v[24:25], v[24:25], v[48:49]
  v_pk_add_f32 v[26:27], v[26:27], v[50:51]
  v_cvt_pk_bf16_f32 v60, v20, v21
  v_cvt_pk_bf16_f32 v61, v22, v23
  v_cvt_pk_bf16_f32 v62, v24, v25
  v_cvt_pk_bf16_f32 v63, v26, v27
  s_add_u32 s58, s47, 14680064
  buffer_store_dwordx4 v[60:63], v2, s[8:11], s58 offen sc1
  s_waitcnt vmcnt(9)
  s_barrier
  s_add_u32 s34, s50, 8331264
  s_cmp_eq_u32 s7, 1
  s_cbranch_scc1 IMP_7
  buffer_store_dword v18, v1, s[8:11], s34 offen
IMPB_7:
  v_pk_add_f32 v[52:53], v[20:21], v[22:23]
  v_pk_add_f32 v[54:55], v[24:25], v[26:27]
  v_pk_mul_f32 v[56:57], v[20:21], v[20:21]
  v_pk_add_f32 v[52:53], v[52:53], v[54:55]
  v_pk_fma_f32 v[56:57], v[22:23], v[22:23], v[56:57]
  v_pk_fma_f32 v[56:57], v[24:25], v[24:25], v[56:57]
  v_pk_fma_f32 v[56:57], v[26:27], v[26:27], v[56:57]
  v_add_f32 v52, v52, v53
  v_add_f32 v53, v56, v57
  s_nop 1
  v_permlane16_swap_b32 v52, v53
  v_add_f32 v52, v52, v53
  v_mov_b32 v53, v52
  s_nop 1
  v_permlane32_swap_b32 v52, v53
  v_add_f32 v52, v52, v53
  s_add_u32 s58, s57, 17563648
  v_lshrrev_b32 v54, 2, v2
  s_mov_b32 exec_hi, 0
  buffer_store_dword v52, v54, s[8:11], s58 offen sc1
  s_mov_b32 exec_hi, -1
  s_add_u32 s35, s52, 8331264
  buffer_load_dword v19, v9, s[8:11], s35 offen sc1
  s_waitcnt vmcnt(1)
  s_barrier
  s_add_u32 s34, s50, 8339456
  s_cmp_eq_u32 s7, 1
  s_cbranch_scc1 IMP_8
  buffer_store_dword v18, v1, s[8:11], s34 offen
IMPB_8:
  s_add_u32 s62, s53, 8339456
  buffer_load_dword v139, v8, s[8:11], s62 offen sc1
  s_waitcnt vmcnt(2)
  v_cmp_ne_u32 vcc, s61, v19
  s_nop 0
  s_and_b64 vcc, vcc, s[28:29]
  s_cbranch_vccnz SLOW_12
BACK_12:
  s_barrier
  s_add_u32 s32, s60, 22020096
  buffer_load_dwordx4 v[88:91], v2, s[8:11], s32 offen offset:0 sc1
  s_add_u32 s32, s60, 22020096
  buffer_load_dwordx4 v[92:95], v2, s[8:11], s32 offen offset:1024 sc1
  s_add_u32 s32, s60, 22020096
  buffer_load_dwordx4 v[96:99], v2, s[8:11], s32 offen offset:2048 sc1
  s_add_u32 s32, s60, 22020096
  buffer_load_dwordx4 v[100:103], v2, s[8:11], s32 offen offset:3072 sc1
  s_add_u32 s32, s47, 13631488
  buffer_load_dwordx4 v[140:143], v2, s[8:11], s32 offen sc1
  s_add_u32 s32, s46, 22020096
  buffer_load_dwordx4 v[104:107], v2, s[8:11], s32 offen offset:0 sc1
  s_add_u32 s32, s46, 22020096
  buffer_load_dwordx4 v[108:111], v2, s[8:11], s32 offen offset:1024 sc1
  s_add_u32 s32, s46, 22020096
  buffer_load_dwordx4 v[112:115], v2, s[8:11], s32 offen offset:2048 sc1
  s_add_u32 s32, s46, 22020096
  buffer_load_dwordx4 v[116:119], v2, s[8:11], s32 offen offset:3072 sc1
  s_waitcnt vmcnt(8)
  v_mfma_f32_16x16x32_bf16 v[36:39], a[192:195], v[88:91], 0
  v_cmp_ne_u32 vcc, s61, v139
  s_nop 0
  s_and_b64 vcc, vcc, s[100:101]
  v_mfma_f32_16x16x32_bf16 v[40:43], a[196:199], v[88:91], 0
  s_cbranch_vccnz SLOW_13
BACK_13:
  s_barrier
  s_add_u32 s49, s43, 32768
  v_mfma_f32_16x16x32_bf16 v[44:47], a[200:203], v[88:91], 0
  buffer_load_dwordx4 a[128:131], v2, s[8:11], s49 offen offset:0
  v_mfma_f32_16x16x32_bf16 v[48:51], a[204:207], v[88:91], 0
  s_waitcnt vmcnt(8)
  v_mfma_f32_16x16x32_bf16 v[36:39], a[208:211], v[92:95], v[36:39]
  v_mfma_f32_16x16x32_bf16 v[40:43], a[212:215], v[92:95], v[40:43]
  s_add_u32 m0, s27, 0
  s_add_u32 s32, s67, 14680064
  v_mfma_f32_16x16x32_bf16 v[44:47], a[216:219], v[92:95], v[44:47]
  buffer_load_dwordx4 v2, s[8:11], s32 offen sc1 lds
  v_mfma_f32_16x16x32_bf16 v[48:51], a[220:223], v[92:95], v[48:51]
  s_waitcnt vmcnt(8)
  v_mfma_f32_16x16x32_bf16 v[36:39], a[224:227], v[96:99], v[36:39]
  v_mfma_f32_16x16x32_bf16 v[40:43], a[228:231], v[96:99], v[40:43]
  s_add_u32 m0, s27, 16384
  s_add_u32 s32, s67, 14696448
  v_mfma_f32_16x16x32_bf16 v[44:47], a[232:235], v[96:99], v[44:47]
  buffer_load_dwordx4 v2, s[8:11], s32 offen sc1 lds
  v_mfma_f32_16x16x32_bf16 v[48:51], a[236:239], v[96:99], v[48:51]
  s_waitcnt vmcnt(8)
  v_mfma_f32_16x16x32_bf16 v[36:39], a[240:243], v[100:103], v[36:39]
  v_mfma_f32_16x16x32_bf16 v[40:43], a[244:247], v[100:103], v[40:43]
  s_add_u32 m0, s27, 32768
  s_add_u32 s32, s67, 14712832
  v_mfma_f32_16x16x32_bf16 v[44:47], a[248:251], v[100:103], v[44:47]
  buffer_load_dwordx4 v2, s[8:11], s32 offen sc1 lds
  v_mfma_f32_16x16x32_bf16 v[48:51], a[252:255], v[100:103], v[48:51]
  s_waitcnt vmcnt(7)
  v_mfma_f32_16x16x32_bf16 v[28:31], a[200:203], v[104:107], 0
  v_mfma_f32_16x16x32_bf16 v[32:35], a[204:207], v[104:107], 0
  s_add_u32 m0, s27, 49152
  s_add_u32 s32, s67, 14729216
  s_waitcnt vmcnt(6)
  v_mfma_f32_16x16x32_bf16 v[28:31], a[216:219], v[108:111], v[28:31]
  buffer_load_dwordx4 v2, s[8:11], s32 offen sc1 lds
  v_mfma_f32_16x16x32_bf16 v[32:35], a[220:223], v[108:111], v[32:35]
  s_waitcnt vmcnt(6)
  v_mfma_f32_16x16x32_bf16 v[28:31], a[232:235], v[112:115], v[28:31]
  v_mfma_f32_16x16x32_bf16 v[32:35], a[236:239], v[112:115], v[32:35]
  s_lshl_b32 s33, s16, 11
  s_add_u32 m0, s33, 131072
  s_add_u32 s32, s26, 17563648
  s_waitcnt vmcnt(5)
  v_mfma_f32_16x16x32_bf16 v[28:31], a[248:251], v[116:119], v[28:31]
  buffer_load_dwordx4 v2, s[8:11], s32 offen offset:0 sc1 lds
  v_mfma_f32_16x16x32_bf16 v[32:35], a[252:255], v[116:119], v[32:35]
  v_mfma_f32_16x16x32_bf16 v[20:23], a[192:195], v[104:107], 0
  v_mfma_f32_16x16x32_bf16 v[24:27], a[196:199], v[104:107], 0
  v_xor_b32 v137, 16384, v7
  v_xor_b32 v138, 24576, v7
  v_mfma_f32_16x16x32_bf16 v[20:23], a[208:211], v[108:111], v[20:23]
  ds_write_b128 v137, v[36:39] offset:36864
  ds_write_b128 v137, v[40:43] offset:37888
  v_mfma_f32_16x16x32_bf16 v[24:27], a[212:215], v[108:111], v[24:27]
  ds_write_b128 v138, v[44:47] offset:38912
  ds_write_b128 v138, v[48:51] offset:39936
  v_mfma_f32_16x16x32_bf16 v[20:23], a[224:227], v[112:115], v[20:23]
  s_lshl_b32 s33, s16, 11
  s_add_u32 m0, s33, 131072
  s_add_u32 s32, s26, 17563648
  v_mfma_f32_16x16x32_bf16 v[24:27], a[228:231], v[112:115], v[24:27]
  buffer_load_dwordx4 v2, s[8:11], s32 offen offset:1024 sc1 lds
  v_mfma_f32_16x16x32_bf16 v[20:23], a[240:243], v[116:119], v[20:23]
  v_mfma_f32_16x16x32_bf16 v[24:27], a[244:247], v[116:119], v[24:27]
  v_xor_b32 v136, 8192, v7
  ds_write_b128 v136, v[28:31] offset:34816
  ds_write_b128 v136, v[32:35] offset:35840
  s_waitcnt lgkmcnt(0)
  s_barrier
  ds_read_b128 v[28:31], v7 offset:34816
  ds_read_b128 v[32:35], v7 offset:35840
  ds_read_b128 v[36:39], v7 offset:36864
  ds_read_b128 v[40:43], v7 offset:37888
  ds_read_b128 v[44:47], v7 offset:38912
  ds_read_b128 v[48:51], v7 offset:39936
  v_lshlrev_b32 v52, 16, v140
  v_and_b32 v53, 0xffff0000, v140
  v_lshlrev_b32 v54, 16, v141
  v_and_b32 v55, 0xffff0000, v141
  s_add_u32 m0, s27, 4096
  s_add_u32 s32, s67, 14684160
  buffer_load_dwordx4 v2, s[8:11], s32 offen sc1 lds
  v_lshlrev_b32 v56, 16, v142
  v_and_b32 v57, 0xffff0000, v142
  v_lshlrev_b32 v58, 16, v143
  v_and_b32 v59, 0xffff0000, v143
  v_pk_add_f32 v[20:21], v[20:21], v[52:53]
  s_add_u32 m0, s27, 20480
  s_add_u32 s32, s67, 14700544
  buffer_load_dwordx4 v2, s[8:11], s32 offen sc1 lds
  v_pk_add_f32 v[22:23], v[22:23], v[54:55]
  v_pk_add_f32 v[24:25], v[24:25], v[56:57]
  v_pk_add_f32 v[26:27], v[26:27], v[58:59]
  s_waitcnt lgkmcnt(5)
  v_pk_add_f32 v[20:21], v[20:21], v[28:29]
  v_pk_add_f32 v[22:23], v[22:23], v[30:31]
  s_add_u32 m0, s27, 36864
  s_add_u32 s32, s67, 14716928
  buffer_load_dwordx4 v2, s[8:11], s32 offen sc1 lds
  s_waitcnt lgkmcnt(4)
  v_pk_add_f32 v[24:25], v[24:25], v[32:33]
  v_pk_add_f32 v[26:27], v[26:27], v[34:35]
  s_waitcnt lgkmcnt(3)
  v_pk_add_f32 v[20:21], v[20:21], v[36:37]
  v_pk_add_f32 v[22:23], v[22:23], v[38:39]
  s_waitcnt lgkmcnt(2)
  v_pk_add_f32 v[24:25], v[24:25], v[40:41]
  s_add_u32 m0, s27, 53248
  s_add_u32 s32, s67, 14733312
  buffer_load_dwordx4 v2, s[8:11], s32 offen sc1 lds
  v_pk_add_f32 v[26:27], v[26:27], v[42:43]
  s_waitcnt lgkmcnt(1)
  v_pk_add_f32 v[20:21], v[20:21], v[44:45]
  v_pk_add_f32 v[22:23], v[22:23], v[46:47]
  s_waitcnt lgkmcnt(0)
  v_pk_add_f32 v[24:25], v[24:25], v[48:49]
  v_pk_add_f32 v[26:27], v[26:27], v[50:51]
  buffer_load_dwordx4 a[132:135], v2, s[8:11], s49 offen offset:1024
  v_cvt_pk_bf16_f32 v60, v20, v21
  v_cvt_pk_bf16_f32 v61, v22, v23
  v_cvt_pk_bf16_f32 v62, v24, v25
  v_cvt_pk_bf16_f32 v63, v26, v27
  s_add_u32 s58, s47, 15728640
  buffer_store_dwordx4 v[60:63], v2, s[8:11], s58 offen sc1
  v_pk_add_f32 v[52:53], v[20:21], v[22:23]
  buffer_load_dwordx4 a[136:139], v2, s[8:11], s49 offen offset:2048
  v_pk_add_f32 v[54:55], v[24:25], v[26:27]
  v_pk_mul_f32 v[56:57], v[20:21], v[20:21]
  v_pk_add_f32 v[52:53], v[52:53], v[54:55]
  v_pk_fma_f32 v[56:57], v[22:23], v[22:23], v[56:57]
  v_pk_fma_f32 v[56:57], v[24:25], v[24:25], v[56:57]
  buffer_load_dwordx4 a[140:143], v2, s[8:11], s49 offen offset:3072
  v_pk_fma_f32 v[56:57], v[26:27], v[26:27], v[56:57]
  v_add_f32 v52, v52, v53
  v_add_f32 v53, v56, v57
  s_nop 1
  v_permlane16_swap_b32 v52, v53
  v_add_f32 v52, v52, v53
  s_add_u32 s49, s43, 36864
  buffer_load_dwordx4 a[144:147], v2, s[8:11], s49 offen offset:0
  v_mov_b32 v53, v52
  s_nop 1
  v_permlane32_swap_b32 v52, v53
  v_add_f32 v52, v52, v53
  s_add_u32 s58, s57, 17694720
  v_lshrrev_b32 v54, 2, v2
  s_mov_b32 exec_hi, 0
  buffer_store_dword v52, v54, s[8:11], s58 offen sc1
  s_mov_b32 exec_hi, -1
  s_waitcnt vmcnt(12)
  s_barrier
  ds_read_b128 v[68:71], v2 offset:0
  ds_read_b128 v[72:75], v2 offset:16384
  ds_read_b128 v[76:79], v2 offset:32768
  ds_read_b128 v[80:83], v2 offset:49152
  ds_read_b128 v[84:87], v2 offset:1024
  s_waitcnt lgkmcnt(4)
  v_mfma_f32_16x16x32_bf16 v[20:23], a[0:3], v[68:71], 0
  s_add_u32 m0, s27, 8192
  s_add_u32 s32, s67, 14688256
  v_mfma_f32_16x16x32_bf16 v[24:27], a[4:7], v[68:71], 0
  buffer_load_dwordx4 v2, s[8:11], s32 offen sc1 lds
  v_mfma_f32_16x16x32_bf16 v[28:31], a[8:11], v[68:71], 0
  ds_read_b128 v[68:71], v2 offset:17408
  s_waitcnt lgkmcnt(4)
  v_mfma_f32_16x16x32_bf16 v[32:35], a[0:3], v[72:75], 0
  v_mfma_f32_16x16x32_bf16 v[36:39], a[4:7], v[72:75], 0
  s_add_u32 m0, s27, 24576
  s_add_u32 s32, s67, 14704640
  v_mfma_f32_16x16x32_bf16 v[40:43], a[8:11], v[72:75], 0
  ds_read_b128 v[72:75], v2 offset:33792
  s_waitcnt lgkmcnt(4)
  v_mfma_f32_16x16x32_bf16 v[44:47], a[0:3], v[76:79], 0
  buffer_load_dwordx4 v2, s[8:11], s32 offen sc1 lds
  v_mfma_f32_16x16x32_bf16 v[48:51], a[4:7], v[76:79], 0
  s_waitcnt vmcnt(12)
  ds_read2_b32 v[88:89], v11 offset0:0 offset1:32
  v_mfma_f32_16x16x32_bf16 v[52:55], a[8:11], v[76:79], 0
  ds_read_b128 v[76:79], v2 offset:50176
  s_waitcnt lgkmcnt(5)
  v_mfma_f32_16x16x32_bf16 v[56:59], a[0:3], v[80:83], 0
  s_add_u32 m0, s27, 40960
  s_add_u32 s32, s67, 14721024
  v_mfma_f32_16x16x32_bf16 v[60:63], a[4:7], v[80:83], 0
  buffer_load_dwordx4 v2, s[8:11], s32 offen sc1 lds
  v_mfma_f32_16x16x32_bf16 v[64:67], a[8:11], v[80:83], 0
  ds_read_b128 v[80:83], v2 offset:2048
  s_waitcnt lgkmcnt(5)
  v_mfma_f32_16x16x32_bf16 v[20:23], a[12:15], v[84:87], v[20:23]
  ds_read2_b32 v[90:91], v11 offset0:64 offset1:96
  ds_read2_b32 v[92:93], v11 offset0:128 offset1:160
  v_mfma_f32_16x16x32_bf16 v[24:27], a[16:19], v[84:87], v[24:27]
  s_add_u32 m0, s27, 57344
  s_add_u32 s32, s67, 14737408
  v_mfma_f32_16x16x32_bf16 v[28:31], a[20:23], v[84:87], v[28:31]
  ds_read_b128 v[84:87], v2 offset:18432
  s_waitcnt lgkmcnt(7)
  v_mfma_f32_16x16x32_bf16 v[32:35], a[12:15], v[68:71], v[32:35]
  buffer_load_dwordx4 v2, s[8:11], s32 offen sc1 lds
  v_mfma_f32_16x16x32_bf16 v[36:39], a[16:19], v[68:71], v[36:39]
  ds_read2_b32 v[94:95], v11 offset0:192 offset1:224
  v_mfma_f32_16x16x32_bf16 v[40:43], a[20:23], v[68:71], v[40:43]
  ds_read_b128 v[68:71], v2 offset:34816
  s_waitcnt lgkmcnt(8)
  v_mfma_f32_16x16x32_bf16 v[44:47], a[12:15], v[72:75], v[44:47]
  s_add_u32 m0, s27, 12288
  s_add_u32 s32, s67, 14692352
  v_mfma_f32_16x16x32_bf16 v[48:51], a[16:19], v[72:75], v[48:51]
  buffer_load_dwordx4 v2, s[8:11], s32 offen sc1 lds
  v_mfma_f32_16x16x32_bf16 v[52:55], a[20:23], v[72:75], v[52:55]
  ds_read_b128 v[72:75], v2 offset:51200
  s_waitcnt lgkmcnt(7)
  v_mfma_f32_16x16x32_bf16 v[56:59], a[12:15], v[76:79], v[56:59]
  v_mfma_f32_16x16x32_bf16 v[60:63], a[16:19], v[76:79], v[60:63]
  s_add_u32 m0, s27, 28672
  s_add_u32 s32, s67, 14708736
  v_mfma_f32_16x16x32_bf16 v[64:67], a[20:23], v[76:79], v[64:67]
  ds_read_b128 v[76:79], v2 offset:3072
  s_waitcnt lgkmcnt(7)
  v_mfma_f32_16x16x32_bf16 v[20:23], a[24:27], v[80:83], v[20:23]
  buffer_load_dwordx4 v2, s[8:11], s32 offen sc1 lds
  v_mfma_f32_16x16x32_bf16 v[24:27], a[28:31], v[80:83], v[24:27]
  v_mfma_f32_16x16x32_bf16 v[28:31], a[32:35], v[80:83], v[28:31]
  ds_read_b128 v[80:83], v2 offset:19456
  s_waitcnt lgkmcnt(5)
  v_mfma_f32_16x16x32_bf16 v[32:35], a[24:27], v[84:87], v[32:35]
  s_add_u32 m0, s27, 45056
  s_add_u32 s32, s67, 14725120
  v_mfma_f32_16x16x32_bf16 v[36:39], a[28:31], v[84:87], v[36:39]
  buffer_load_dwordx4 v2, s[8:11], s32 offen sc1 lds
  v_mfma_f32_16x16x32_bf16 v[40:43], a[32:35], v[84:87], v[40:43]
  ds_read_b128 v[84:87], v2 offset:35840
  s_waitcnt lgkmcnt(4)
  v_mfma_f32_16x16x32_bf16 v[44:47], a[24:27], v[68:71], v[44:47]
  v_add_f32 v88, v88, v89
  v_add_f32 v90, v90, v91
  v_mfma_f32_16x16x32_bf16 v[48:51], a[28:31], v[68:71], v[48:51]
  s_add_u32 m0, s27, 61440
  s_add_u32 s32, s67, 14741504
  v_mfma_f32_16x16x32_bf16 v[52:55], a[32:35], v[68:71], v[52:55]
  ds_read_b128 v[68:71], v2 offset:52224
  s_waitcnt lgkmcnt(4)
  v_mfma_f32_16x16x32_bf16 v[56:59], a[24:27], v[72:75], v[56:59]
  buffer_load_dwordx4 v2, s[8:11], s32 offen sc1 lds
  v_mfma_f32_16x16x32_bf16 v[60:63], a[28:31], v[72:75], v[60:63]
  v_add_f32 v92, v92, v93
  v_add_f32 v94, v94, v95
  v_mfma_f32_16x16x32_bf16 v[64:67], a[32:35], v[72:75], v[64:67]
  s_waitcnt vmcnt(14)
  s_barrier
  ds_read_b128 v[72:75], v2 offset:4096
  s_waitcnt lgkmcnt(4)
  v_mfma_f32_16x16x32_bf16 v[20:23], a[36:39], v[76:79], v[20:23]
  v_add_f32 v88, v88, v90
  v_add_f32 v92, v92, v94
  v_mfma_f32_16x16x32_bf16 v[24:27], a[40:43], v[76:79], v[24:27]
  buffer_load_dwordx4 a[148:151], v2, s[8:11], s49 offen offset:1024
  v_mfma_f32_16x16x32_bf16 v[28:31], a[44:47], v[76:79], v[28:31]
  ds_read_b128 v[76:79], v2 offset:20480
  s_waitcnt lgkmcnt(4)
  v_mfma_f32_16x16x32_bf16 v[32:35], a[36:39], v[80:83], v[32:35]
  v_add_f32 v88, v88, v92
  v_mov_b32 v89, v88
  v_mfma_f32_16x16x32_bf16 v[36:39], a[40:43], v[80:83], v[36:39]
  s_nop 0
  v_permlane32_swap_b32 v88, v89
  v_mfma_f32_16x16x32_bf16 v[40:43], a[44:47], v[80:83], v[40:43]
  ds_read_b128 v[80:83], v2 offset:36864
  s_waitcnt lgkmcnt(4)
  v_mfma_f32_16x16x32_bf16 v[44:47], a[36:39], v[84:87], v[44:47]
  buffer_load_dwordx4 a[152:155], v2, s[8:11], s49 offen offset:2048
  v_mfma_f32_16x16x32_bf16 v[48:51], a[40:43], v[84:87], v[48:51]
  v_add_f32 v88, v88, v89
  v_mov_b32 v89, v88
  v_mfma_f32_16x16x32_bf16 v[52:55], a[44:47], v[84:87], v[52:55]
  ds_read_b128 v[84:87], v2 offset:53248
  s_waitcnt lgkmcnt(4)
  v_mfma_f32_16x16x32_bf16 v[56:59], a[36:39], v[68:71], v[56:59]
  v_permlane16_swap_b32 v88, v89
  v_mfma_f32_16x16x32_bf16 v[60:63], a[40:43], v[68:71], v[60:63]
  buffer_load_dwordx4 a[156:159], v2, s[8:11], s49 offen offset:3072
  v_mfma_f32_16x16x32_bf16 v[64:67], a[44:47], v[68:71], v[64:67]
  ds_read_b128 v[68:71], v2 offset:5120
  s_waitcnt lgkmcnt(4)
  v_mfma_f32_16x16x32_bf16 v[20:23], a[48:51], v[72:75], v[20:23]
  s_waitcnt vmcnt(11)
  s_barrier
  s_add_u32 s34, s50, 8347648
  v_mfma_f32_16x16x32_bf16 v[24:27], a[52:55], v[72:75], v[24:27]
  s_cmp_eq_u32 s7, 1
  s_cbranch_scc1 IMP_9
  buffer_store_dword v18, v1, s[8:11], s34 offen
IMPB_9:
  s_add_u32 s49, s43, 40960
  v_mfma_f32_16x16x32_bf16 v[28:31], a[56:59], v[72:75], v[28:31]
  ds_read_b128 v[72:75], v2 offset:21504
  s_waitcnt lgkmcnt(4)
  v_mfma_f32_16x16x32_bf16 v[32:35], a[48:51], v[76:79], v[32:35]
  buffer_load_dwordx4 a[160:163], v2, s[8:11], s49 offen offset:0
  v_mfma_f32_16x16x32_bf16 v[36:39], a[52:55], v[76:79], v[36:39]
  v_mul_f32 v88, 0xbb000000, v88
  v_mul_f32 v90, v88, v88
  v_mfma_f32_16x16x32_bf16 v[40:43], a[56:59], v[76:79], v[40:43]
  ds_read_b128 v[76:79], v2 offset:37888
  s_waitcnt lgkmcnt(4)
  v_mfma_f32_16x16x32_bf16 v[44:47], a[48:51], v[80:83], v[44:47]
  v_fma_f32 v89, v89, s96, -v90
  v_max_f32 v89, 0, v89
  v_mfma_f32_16x16x32_bf16 v[48:51], a[52:55], v[80:83], v[48:51]
  buffer_load_dwordx4 a[164:167], v2, s[8:11], s49 offen offset:1024
  v_mfma_f32_16x16x32_bf16 v[52:55], a[56:59], v[80:83], v[52:55]
  ds_read_b128 v[80:83], v2 offset:54272
  s_waitcnt lgkmcnt(4)
  v_mfma_f32_16x16x32_bf16 v[56:59], a[48:51], v[84:87], v[56:59]
  v_add_f32 v89, s97, v89
  v_mfma_f32_16x16x32_bf16 v[60:63], a[52:55], v[84:87], v[60:63]
  v_rsq_f32 v89, v89
  v_mfma_f32_16x16x32_bf16 v[64:67], a[56:59], v[84:87], v[64:67]
  ds_read_b128 v[84:87], v2 offset:6144
  s_waitcnt lgkmcnt(4)
  v_mfma_f32_16x16x32_bf16 v[20:23], a[60:63], v[68:71], v[20:23]
  buffer_load_dwordx4 a[168:171], v2, s[8:11], s49 offen offset:2048
  v_mfma_f32_16x16x32_bf16 v[24:27], a[64:67], v[68:71], v[24:27]
  v_cndmask_b32 v88, v88, v89, s[36:37]
  ds_write_b32 v12, v88 offset:0
  v_mfma_f32_16x16x32_bf16 v[28:31], a[68:71], v[68:71], v[28:31]
  ds_read_b128 v[68:71], v2 offset:22528
  s_waitcnt lgkmcnt(5)
  v_mfma_f32_16x16x32_bf16 v[32:35], a[60:63], v[72:75], v[32:35]
  v_mfma_f32_16x16x32_bf16 v[36:39], a[64:67], v[72:75], v[36:39]
  buffer_load_dwordx4 a[172:175], v2, s[8:11], s49 offen offset:3072
  v_mfma_f32_16x16x32_bf16 v[40:43], a[68:71], v[72:75], v[40:43]
  ds_read_b128 v[72:75], v2 offset:38912
  s_waitcnt lgkmcnt(5)
  v_mfma_f32_16x16x32_bf16 v[44:47], a[60:63], v[76:79], v[44:47]
  v_mfma_f32_16x16x32_bf16 v[48:51], a[64:67], v[76:79], v[48:51]
  s_add_u32 s49, s43, 45056
  v_mfma_f32_16x16x32_bf16 v[52:55], a[68:71], v[76:79], v[52:55]
  ds_read_b128 v[76:79], v2 offset:55296
  s_waitcnt lgkmcnt(5)
  v_mfma_f32_16x16x32_bf16 v[56:59], a[60:63], v[80:83], v[56:59]
  buffer_load_dwordx4 a[176:179], v2, s[8:11], s49 offen offset:0
  v_mfma_f32_16x16x32_bf16 v[60:63], a[64:67], v[80:83], v[60:63]
  v_mfma_f32_16x16x32_bf16 v[64:67], a[68:71], v[80:83], v[64:67]
  ds_read_b128 v[80:83], v2 offset:7168
  s_waitcnt lgkmcnt(5)
  v_mfma_f32_16x16x32_bf16 v[20:23], a[72:75], v[84:87], v[20:23]
  v_mfma_f32_16x16x32_bf16 v[24:27], a[76:79], v[84:87], v[24:27]
  buffer_load_dwordx4 a[180:183], v2, s[8:11], s49 offen offset:1024
  v_mfma_f32_16x16x32_bf16 v[28:31], a[80:83], v[84:87], v[28:31]
  ds_read_b128 v[84:87], v2 offset:23552
  s_waitcnt lgkmcnt(4)
  v_mfma_f32_16x16x32_bf16 v[32:35], a[72:75], v[68:71], v[32:35]
  v_mfma_f32_16x16x32_bf16 v[36:39], a[76:79], v[68:71], v[36:39]
  v_mfma_f32_16x16x32_bf16 v[40:43], a[80:83], v[68:71], v[40:43]
  ds_read_b128 v[68:71], v2 offset:39936
  s_waitcnt lgkmcnt(4)
  v_mfma_f32_16x16x32_bf16 v[44:47], a[72:75], v[72:75], v[44:47]
  buffer_load_dwordx4 a[184:187], v2, s[8:11], s49 offen offset:2048
  v_mfma_f32_16x16x32_bf16 v[48:51], a[76:79], v[72:75], v[48:51]
  v_mfma_f32_16x16x32_bf16 v[52:55], a[80:83], v[72:75], v[52:55]
  ds_read_b128 v[72:75], v2 offset:56320
  s_waitcnt lgkmcnt(4)
  v_mfma_f32_16x16x32_bf16 v[56:59], a[72:75], v[76:79], v[56:59]
  v_mfma_f32_16x16x32_bf16 v[60:63], a[76:79], v[76:79], v[60:63]
  buffer_load_dwordx4 a[188:191], v2, s[8:11], s49 offen offset:3072
  v_mfma_f32_16x16x32_bf16 v[64:67], a[80:83], v[76:79], v[64:67]
  s_waitcnt vmcnt(16)
  s_barrier
  ds_read_b128 v[76:79], v2 offset:8192
  s_waitcnt lgkmcnt(4)
  v_mfma_f32_16x16x32_bf16 v[20:23], a[84:87], v[80:83], v[20:23]
  v_mfma_f32_16x16x32_bf16 v[24:27], a[88:91], v[80:83], v[24:27]
  s_add_u32 s49, s44, 0
  v_mfma_f32_16x16x32_bf16 v[28:31], a[92:95], v[80:83], v[28:31]
  ds_read_b128 v[80:83], v2 offset:24576
  s_waitcnt lgkmcnt(4)
  v_mfma_f32_16x16x32_bf16 v[32:35], a[84:87], v[84:87], v[32:35]
  buffer_load_dwordx4 a[192:195], v2, s[8:11], s49 offen offset:0
  v_mfma_f32_16x16x32_bf16 v[36:39], a[88:91], v[84:87], v[36:39]
  v_mfma_f32_16x16x32_bf16 v[40:43], a[92:95], v[84:87], v[40:43]
  ds_read_b128 v[84:87], v2 offset:40960
  s_waitcnt lgkmcnt(4)
  v_mfma_f32_16x16x32_bf16 v[44:47], a[84:87], v[68:71], v[44:47]
  v_mfma_f32_16x16x32_bf16 v[48:51], a[88:91], v[68:71], v[48:51]
  buffer_load_dwordx4 a[196:199], v2, s[8:11], s49 offen offset:1024
  v_mfma_f32_16x16x32_bf16 v[52:55], a[92:95], v[68:71], v[52:55]
  ds_read_b128 v[68:71], v2 offset:57344
  s_waitcnt lgkmcnt(4)
  v_mfma_f32_16x16x32_bf16 v[56:59], a[84:87], v[72:75], v[56:59]
  v_mfma_f32_16x16x32_bf16 v[60:63], a[88:91], v[72:75], v[60:63]
  v_mfma_f32_16x16x32_bf16 v[64:67], a[92:95], v[72:75], v[64:67]
  ds_read_b128 v[72:75], v2 offset:9216
  s_waitcnt lgkmcnt(4)
  v_mfma_f32_16x16x32_bf16 v[20:23], a[96:99], v[76:79], v[20:23]
  buffer_load_dwordx4 a[200:203], v2, s[8:11], s49 offen offset:2048
  v_mfma_f32_16x16x32_bf16 v[24:27], a[100:103], v[76:79], v[24:27]
  v_mfma_f32_16x16x32_bf16 v[28:31], a[104:107], v[76:79], v[28:31]
  ds_read_b128 v[76:79], v2 offset:25600
  s_waitcnt lgkmcnt(4)
  v_mfma_f32_16x16x32_bf16 v[32:35], a[96:99], v[80:83], v[32:35]
  v_mfma_f32_16x16x32_bf16 v[36:39], a[100:103], v[80:83], v[36:39]
  buffer_load_dwordx4 a[204:207], v2, s[8:11], s49 offen offset:3072
  v_mfma_f32_16x16x32_bf16 v[40:43], a[104:107], v[80:83], v[40:43]
  ds_read_b128 v[80:83], v2 offset:41984
  s_waitcnt lgkmcnt(4)
  v_mfma_f32_16x16x32_bf16 v[44:47], a[96:99], v[84:87], v[44:47]
  v_mfma_f32_16x16x32_bf16 v[48:51], a[100:103], v[84:87], v[48:51]
  s_add_u32 s49, s44, 4096
  v_mfma_f32_16x16x32_bf16 v[52:55], a[104:107], v[84:87], v[52:55]
  ds_read_b128 v[84:87], v2 offset:58368
  s_waitcnt lgkmcnt(4)
  v_mfma_f32_16x16x32_bf16 v[56:59], a[96:99], v[68:71], v[56:59]
  buffer_load_dwordx4 a[208:211], v2, s[8:11], s49 offen offset:0
  v_mfma_f32_16x16x32_bf16 v[60:63], a[100:103], v[68:71], v[60:63]
  v_mfma_f32_16x16x32_bf16 v[64:67], a[104:107], v[68:71], v[64:67]
  ds_read_b128 v[68:71], v2 offset:10240
  s_waitcnt lgkmcnt(4)
  v_mfma_f32_16x16x32_bf16 v[20:23], a[108:111], v[72:75], v[20:23]
  s_add_u32 s35, s53, 8347648
  v_mfma_f32_16x16x32_bf16 v[24:27], a[112:115], v[72:75], v[24:27]
  buffer_load_dword v19, v8, s[8:11], s35 offen sc1
  v_mfma_f32_16x16x32_bf16 v[28:31], a[116:119], v[72:75], v[28:31]
  ds_read_b128 v[72:75], v2 offset:26624
  s_waitcnt lgkmcnt(4)
  v_mfma_f32_16x16x32_bf16 v[32:35], a[108:111], v[76:79], v[32:35]
  v_mfma_f32_16x16x32_bf16 v[36:39], a[112:115], v[76:79], v[36:39]
  v_mfma_f32_16x16x32_bf16 v[40:43], a[116:119], v[76:79], v[40:43]
  ds_read_b128 v[76:79], v2 offset:43008
  s_waitcnt lgkmcnt(4)
  v_mfma_f32_16x16x32_bf16 v[44:47], a[108:111], v[80:83], v[44:47]
  buffer_load_dwordx4 a[212:215], v2, s[8:11], s49 offen offset:1024
  v_mfma_f32_16x16x32_bf16 v[48:51], a[112:115], v[80:83], v[48:51]
  v_mfma_f32_16x16x32_bf16 v[52:55], a[116:119], v[80:83], v[52:55]
  ds_read_b128 v[80:83], v2 offset:59392
  s_waitcnt lgkmcnt(4)
  v_mfma_f32_16x16x32_bf16 v[56:59], a[108:111], v[84:87], v[56:59]
  v_mfma_f32_16x16x32_bf16 v[60:63], a[112:115], v[84:87], v[60:63]
  buffer_load_dwordx4 a[216:219], v2, s[8:11], s49 offen offset:2048
  v_mfma_f32_16x16x32_bf16 v[64:67], a[116:119], v[84:87], v[64:67]
  ds_read_b128 v[84:87], v2 offset:11264
  s_waitcnt lgkmcnt(4)
  v_mfma_f32_16x16x32_bf16 v[20:23], a[120:123], v[68:71], v[20:23]
  v_mfma_f32_16x16x32_bf16 v[24:27], a[124:127], v[68:71], v[24:27]
  v_mfma_f32_16x16x32_bf16 v[28:31], a[128:131], v[68:71], v[28:31]
  ds_read_b128 v[68:71], v2 offset:27648
  s_waitcnt lgkmcnt(4)
  v_mfma_f32_16x16x32_bf16 v[32:35], a[120:123], v[72:75], v[32:35]
  buffer_load_dwordx4 a[220:223], v2, s[8:11], s49 offen offset:3072
  v_mfma_f32_16x16x32_bf16 v[36:39], a[124:127], v[72:75], v[36:39]
  v_mfma_f32_16x16x32_bf16 v[40:43], a[128:131], v[72:75], v[40:43]
  ds_read_b128 v[72:75], v2 offset:44032
  s_waitcnt lgkmcnt(4)
  v_mfma_f32_16x16x32_bf16 v[44:47], a[120:123], v[76:79], v[44:47]
  s_add_u32 s49, s44, 8192
  v_mfma_f32_16x16x32_bf16 v[48:51], a[124:127], v[76:79], v[48:51]
  buffer_load_dwordx4 a[224:227], v2, s[8:11], s49 offen offset:0
  v_mfma_f32_16x16x32_bf16 v[52:55], a[128:131], v[76:79], v[52:55]
  ds_read_b128 v[76:79], v2 offset:60416
  s_waitcnt lgkmcnt(4)
  v_mfma_f32_16x16x32_bf16 v[56:59], a[120:123], v[80:83], v[56:59]
  v_mfma_f32_16x16x32_bf16 v[60:63], a[124:127], v[80:83], v[60:63]
  v_mfma_f32_16x16x32_bf16 v[64:67], a[128:131], v[80:83], v[64:67]
  s_waitcnt vmcnt(22)
  s_barrier
  ds_read_b128 v[80:83], v2 offset:12288
  s_waitcnt lgkmcnt(4)
  v_mfma_f32_16x16x32_bf16 v[20:23], a[132:135], v[84:87], v[20:23]
  buffer_load_dwordx4 a[228:231], v2, s[8:11], s49 offen offset:1024
  v_mfma_f32_16x16x32_bf16 v[24:27], a[136:139], v[84:87], v[24:27]
  v_mfma_f32_16x16x32_bf16 v[28:31], a[140:143], v[84:87], v[28:31]
  ds_read_b128 v[84:87], v2 offset:28672
  s_waitcnt lgkmcnt(4)
  v_mfma_f32_16x16x32_bf16 v[32:35], a[132:135], v[68:71], v[32:35]
  v_mfma_f32_16x16x32_bf16 v[36:39], a[136:139], v[68:71], v[36:39]
  buffer_load_dwordx4 a[232:235], v2, s[8:11], s49 offen offset:2048
  v_mfma_f32_16x16x32_bf16 v[40:43], a[140:143], v[68:71], v[40:43]
  ds_read_b128 v[68:71], v2 offset:45056
  s_waitcnt lgkmcnt(4)
  v_mfma_f32_16x16x32_bf16 v[44:47], a[132:135], v[72:75], v[44:47]
  v_mfma_f32_16x16x32_bf16 v[48:51], a[136:139], v[72:75], v[48:51]
  v_mfma_f32_16x16x32_bf16 v[52:55], a[140:143], v[72:75], v[52:55]
  ds_read_b128 v[72:75], v2 offset:61440
  s_waitcnt lgkmcnt(4)
  v_mfma_f32_16x16x32_bf16 v[56:59], a[132:135], v[76:79], v[56:59]
  buffer_load_dwordx4 a[236:239], v2, s[8:11], s49 offen offset:3072
  v_mfma_f32_16x16x32_bf16 v[60:63], a[136:139], v[76:79], v[60:63]
  v_mfma_f32_16x16x32_bf16 v[64:67], a[140:143], v[76:79], v[64:67]
  ds_read_b128 v[76:79], v2 offset:13312
  s_waitcnt lgkmcnt(4)
  v_mfma_f32_16x16x32_bf16 v[20:23], a[144:147], v[80:83], v[20:23]
  s_add_u32 s49, s44, 12288
  s_waitcnt vmcnt(24)
  v_mfma_f32_16x16x32_bf16 v[24:27], a[148:151], v[80:83], v[24:27]
  buffer_load_dwordx4 a[240:243], v2, s[8:11], s49 offen offset:0
  s_waitcnt vmcnt(24)
  v_mfma_f32_16x16x32_bf16 v[28:31], a[152:155], v[80:83], v[28:31]
  ds_read_b128 v[80:83], v2 offset:29696
  s_waitcnt lgkmcnt(4)
  v_mfma_f32_16x16x32_bf16 v[32:35], a[144:147], v[84:87], v[32:35]
  v_mfma_f32_16x16x32_bf16 v[36:39], a[148:151], v[84:87], v[36:39]
  v_mfma_f32_16x16x32_bf16 v[40:43], a[152:155], v[84:87], v[40:43]
  ds_read_b128 v[84:87], v2 offset:46080
  s_waitcnt lgkmcnt(4)
  v_mfma_f32_16x16x32_bf16 v[44:47], a[144:147], v[68:71], v[44:47]
  s_waitcnt vmcnt(8)
  v_cmp_ne_u32 vcc, s61, v19
  s_nop 0
  s_and_b64 vcc, vcc, s[100:101]
  v_mfma_f32_16x16x32_bf16 v[48:51], a[148:151], v[68:71], v[48:51]
  s_cbranch_vccnz SLOW_14
BACK_14:
  s_barrier
  v_mfma_f32_16x16x32_bf16 v[52:55], a[152:155], v[68:71], v[52:55]
  ds_read_b128 v[68:71], v2 offset:62464
  s_waitcnt lgkmcnt(4)
  v_mfma_f32_16x16x32_bf16 v[56:59], a[144:147], v[72:75], v[56:59]
  buffer_load_dwordx4 a[244:247], v2, s[8:11], s49 offen offset:1024
  v_mfma_f32_16x16x32_bf16 v[60:63], a[148:151], v[72:75], v[60:63]
  v_mfma_f32_16x16x32_bf16 v[64:67], a[152:155], v[72:75], v[64:67]
  ds_read_b128 v[72:75], v2 offset:14336
  s_waitcnt lgkmcnt(4)
  v_mfma_f32_16x16x32_bf16 v[20:23], a[156:159], v[76:79], v[20:23]
  s_add_u32 m0, s27, 65536
  s_add_u32 s32, s67, 15728640
  v_mfma_f32_16x16x32_bf16 v[24:27], a[160:163], v[76:79], v[24:27]
  buffer_load_dwordx4 v2, s[8:11], s32 offen sc1 lds
  v_mfma_f32_16x16x32_bf16 v[28:31], a[164:167], v[76:79], v[28:31]
  ds_read_b128 v[76:79], v2 offset:30720
  s_waitcnt lgkmcnt(4)
  v_mfma_f32_16x16x32_bf16 v[32:35], a[156:159], v[80:83], v[32:35]
  v_mfma_f32_16x16x32_bf16 v[36:39], a[160:163], v[80:83], v[36:39]
  s_add_u32 m0, s27, 81920
  s_add_u32 s32, s67, 15745024
  v_mfma_f32_16x16x32_bf16 v[40:43], a[164:167], v[80:83], v[40:43]
  ds_read_b128 v[80:83], v2 offset:47104
  s_waitcnt lgkmcnt(4)
  v_mfma_f32_16x16x32_bf16 v[44:47], a[156:159], v[84:87], v[44:47]
  buffer_load_dwordx4 v2, s[8:11], s32 offen sc1 lds
  v_mfma_f32_16x16x32_bf16 v[48:51], a[160:163], v[84:87], v[48:51]
  v_mfma_f32_16x16x32_bf16 v[52:55], a[164:167], v[84:87], v[52:55]
  ds_read_b128 v[84:87], v2 offset:63488
  s_waitcnt lgkmcnt(4)
  v_mfma_f32_16x16x32_bf16 v[56:59], a[156:159], v[68:71], v[56:59]
  s_add_u32 m0, s27, 98304
  s_add_u32 s32, s67, 15761408
  v_mfma_f32_16x16x32_bf16 v[60:63], a[160:163], v[68:71], v[60:63]
  buffer_load_dwordx4 v2, s[8:11], s32 offen sc1 lds
  v_mfma_f32_16x16x32_bf16 v[64:67], a[164:167], v[68:71], v[64:67]
  ds_read_b128 v[68:71], v2 offset:15360
  s_waitcnt lgkmcnt(4)
  v_mfma_f32_16x16x32_bf16 v[20:23], a[168:171], v[72:75], v[20:23]
  v_mfma_f32_16x16x32_bf16 v[24:27], a[172:175], v[72:75], v[24:27]
  s_add_u32 m0, s27, 114688
  s_add_u32 s32, s67, 15777792
  v_mfma_f32_16x16x32_bf16 v[28:31], a[176:179], v[72:75], v[28:31]
  ds_read_b128 v[72:75], v2 offset:31744
  s_waitcnt lgkmcnt(4)
  v_mfma_f32_16x16x32_bf16 v[32:35], a[168:171], v[76:79], v[32:35]
  buffer_load_dwordx4 v2, s[8:11], s32 offen sc1 lds
  v_mfma_f32_16x16x32_bf16 v[36:39], a[172:175], v[76:79], v[36:39]
  v_mfma_f32_16x16x32_bf16 v[40:43], a[176:179], v[76:79], v[40:43]
  ds_read_b128 v[76:79], v2 offset:48128
  s_waitcnt lgkmcnt(4)
  v_mfma_f32_16x16x32_bf16 v[44:47], a[168:171], v[80:83], v[44:47]
  s_lshl_b32 s33, s16, 11
  s_add_u32 m0, s33, 139264
  s_add_u32 s32, s26, 17694720
  v_mfma_f32_16x16x32_bf16 v[48:51], a[172:175], v[80:83], v[48:51]
  buffer_load_dwordx4 v2, s[8:11], s32 offen offset:0 sc1 lds
  v_mfma_f32_16x16x32_bf16 v[52:55], a[176:179], v[80:83], v[52:55]
  ds_read_b128 v[80:83], v2 offset:64512
  s_barrier
  s_waitcnt lgkmcnt(4)
  v_mfma_f32_16x16x32_bf16 v[56:59], a[168:171], v[84:87], v[56:59]
  v_mfma_f32_16x16x32_bf16 v[60:63], a[172:175], v[84:87], v[60:63]
  s_lshl_b32 s33, s16, 11
  s_add_u32 m0, s33, 139264
  s_add_u32 s32, s26, 17694720
  v_mfma_f32_16x16x32_bf16 v[64:67], a[176:179], v[84:87], v[64:67]
  buffer_load_dwordx4 v2, s[8:11], s32 offen offset:1024 sc1 lds
  s_waitcnt lgkmcnt(3)
  v_mfma_f32_16x16x32_bf16 v[20:23], a[180:183], v[68:71], v[20:23]
  v_mfma_f32_16x16x32_bf16 v[24:27], a[184:187], v[68:71], v[24:27]
  v_mfma_f32_16x16x32_bf16 v[28:31], a[188:191], v[68:71], v[28:31]
  ds_read_b128 v[68:71], v15 offset:768
  s_waitcnt lgkmcnt(3)
  v_mfma_f32_16x16x32_bf16 v[32:35], a[180:183], v[72:75], v[32:35]
  s_add_u32 m0, s27, 69632
  s_add_u32 s32, s67, 15732736
  v_mfma_f32_16x16x32_bf16 v[36:39], a[184:187], v[72:75], v[36:39]
  buffer_load_dwordx4 v2, s[8:11], s32 offen sc1 lds
  v_mfma_f32_16x16x32_bf16 v[40:43], a[188:191], v[72:75], v[40:43]
  ds_read_b128 v[72:75], v15 offset:832
  s_waitcnt lgkmcnt(3)
  v_mfma_f32_16x16x32_bf16 v[44:47], a[180:183], v[76:79], v[44:47]
  v_mfma_f32_16x16x32_bf16 v[48:51], a[184:187], v[76:79], v[48:51]
  s_add_u32 m0, s27, 86016
  s_add_u32 s32, s67, 15749120
  v_mfma_f32_16x16x32_bf16 v[52:55], a[188:191], v[76:79], v[52:55]
  ds_read_b128 v[76:79], v15 offset:896
  s_waitcnt lgkmcnt(3)
  v_mfma_f32_16x16x32_bf16 v[56:59], a[180:183], v[80:83], v[56:59]
  buffer_load_dwordx4 v2, s[8:11], s32 offen sc1 lds
  v_mfma_f32_16x16x32_bf16 v[60:63], a[184:187], v[80:83], v[60:63]
  v_mfma_f32_16x16x32_bf16 v[64:67], a[188:191], v[80:83], v[64:67]
  ds_read_b64 v[80:81], v13 offset:0
  s_barrier
  ds_read_b64 v[82:83], v13 offset:128
  s_waitcnt lgkmcnt(1)
  v_pk_fma_f32 v[28:29], v[80:81], v[76:77], v[28:29] op_sel_hi:[0,1,1]
  v_pk_fma_f32 v[30:31], v[80:81], v[78:79], v[30:31] op_sel_hi:[0,1,1]
  v_pk_fma_f32 v[20:21], v[80:81], v[68:69], v[20:21] op_sel_hi:[0,1,1]
  v_pk_fma_f32 v[22:23], v[80:81], v[70:71], v[22:23] op_sel_hi:[0,1,1]
  v_pk_fma_f32 v[24:25], v[80:81], v[72:73], v[24:25] op_sel_hi:[0,1,1]
  v_pk_fma_f32 v[26:27], v[80:81], v[74:75], v[26:27] op_sel_hi:[0,1,1]
  v_mul_f32 v84, s99, v81
  v_permlane16_swap_b32 v28, v30
  v_permlane16_swap_b32 v29, v31
  v_pk_mul_f32 v[20:21], v[20:21], v[84:85] op_sel_hi:[1,0]
  v_pk_mul_f32 v[22:23], v[22:23], v[84:85] op_sel_hi:[1,0]
  v_pk_mul_f32 v[28:29], v[28:29], v[84:85] op_sel_hi:[1,0]
  s_add_u32 m0, s27, 102400
  s_add_u32 s32, s67, 15765504
  buffer_load_dwordx4 v2, s[8:11], s32 offen sc1 lds
  v_exp_f32 v20, v20
  v_exp_f32 v21, v21
  v_exp_f32 v22, v22
  v_exp_f32 v23, v23
  v_exp_f32 v28, v28
  v_exp_f32 v29, v29
  v_pk_mul_f32 v[24:25], v[24:25], v[80:81] op_sel:[0,1] op_sel_hi:[1,1]
  v_pk_mul_f32 v[26:27], v[26:27], v[80:81] op_sel:[0,1] op_sel_hi:[1,1]
  v_pk_mul_f32 v[30:31], v[30:31], v[80:81] op_sel:[0,1] op_sel_hi:[1,1]
  v_pk_add_f32 v[20:21], v[20:21], s[38:39]
  v_pk_add_f32 v[22:23], v[22:23], s[38:39]
  v_pk_add_f32 v[28:29], v[28:29], s[38:39]
  s_add_u32 m0, s27, 118784
  s_add_u32 s32, s67, 15781888
  buffer_load_dwordx4 v2, s[8:11], s32 offen sc1 lds
  v_rcp_f32 v20, v20
  v_rcp_f32 v21, v21
  v_rcp_f32 v22, v22
  v_rcp_f32 v23, v23
  v_rcp_f32 v28, v28
  v_rcp_f32 v29, v29
  v_pk_mul_f32 v[24:25], v[24:25], v[20:21]
  v_pk_mul_f32 v[26:27], v[26:27], v[22:23]
  v_pk_mul_f32 v[30:31], v[30:31], v[28:29]
  v_cvt_pk_bf16_f32 v20, v24, v25
  v_cvt_pk_bf16_f32 v21, v26, v27
  v_cvt_pk_bf16_f32 v136, v30, v31
  buffer_load_dwordx4 a[248:251], v2, s[8:11], s49 offen offset:2048
  ds_read_b64 v[80:81], v13 offset:256
  s_waitcnt lgkmcnt(1)
  v_pk_fma_f32 v[40:41], v[82:83], v[76:77], v[40:41] op_sel_hi:[0,1,1]
  v_pk_fma_f32 v[42:43], v[82:83], v[78:79], v[42:43] op_sel_hi:[0,1,1]
  v_pk_fma_f32 v[32:33], v[82:83], v[68:69], v[32:33] op_sel_hi:[0,1,1]
  v_pk_fma_f32 v[34:35], v[82:83], v[70:71], v[34:35] op_sel_hi:[0,1,1]
  v_pk_fma_f32 v[36:37], v[82:83], v[72:73], v[36:37] op_sel_hi:[0,1,1]
  v_pk_fma_f32 v[38:39], v[82:83], v[74:75], v[38:39] op_sel_hi:[0,1,1]
  v_mul_f32 v84, s99, v83
  v_permlane16_swap_b32 v40, v42
  v_permlane16_swap_b32 v41, v43
  v_pk_mul_f32 v[32:33], v[32:33], v[84:85] op_sel_hi:[1,0]
  v_pk_mul_f32 v[34:35], v[34:35], v[84:85] op_sel_hi:[1,0]
  v_pk_mul_f32 v[40:41], v[40:41], v[84:85] op_sel_hi:[1,0]
  buffer_load_dwordx4 a[252:255], v2, s[8:11], s49 offen offset:3072
  v_exp_f32 v32, v32
  v_exp_f32 v33, v33
  v_exp_f32 v34, v34
  v_exp_f32 v35, v35
  v_exp_f32 v40, v40
  v_exp_f32 v41, v41
  v_pk_mul_f32 v[36:37], v[36:37], v[82:83] op_sel:[0,1] op_sel_hi:[1,1]
  v_pk_mul_f32 v[38:39], v[38:39], v[82:83] op_sel:[0,1] op_sel_hi:[1,1]
  v_pk_mul_f32 v[42:43], v[42:43], v[82:83] op_sel:[0,1] op_sel_hi:[1,1]
  v_pk_add_f32 v[32:33], v[32:33], s[38:39]
  v_pk_add_f32 v[34:35], v[34:35], s[38:39]
  v_pk_add_f32 v[40:41], v[40:41], s[38:39]
  v_rcp_f32 v32, v32
  v_rcp_f32 v33, v33
  v_rcp_f32 v34, v34
  v_rcp_f32 v35, v35
  v_rcp_f32 v40, v40
  v_rcp_f32 v41, v41
  v_pk_mul_f32 v[36:37], v[36:37], v[32:33]
  v_pk_mul_f32 v[38:39], v[38:39], v[34:35]
  v_pk_mul_f32 v[42:43], v[42:43], v[40:41]
  v_cvt_pk_bf16_f32 v22, v36, v37
  v_cvt_pk_bf16_f32 v23, v38, v39
  v_cvt_pk_bf16_f32 v137, v42, v43
  ds_read_b64 v[82:83], v13 offset:384
  s_waitcnt lgkmcnt(1)
  v_pk_fma_f32 v[52:53], v[80:81], v[76:77], v[52:53] op_sel_hi:[0,1,1]
  v_pk_fma_f32 v[54:55], v[80:81], v[78:79], v[54:55] op_sel_hi:[0,1,1]
  v_pk_fma_f32 v[44:45], v[80:81], v[68:69], v[44:45] op_sel_hi:[0,1,1]
  v_pk_fma_f32 v[46:47], v[80:81], v[70:71], v[46:47] op_sel_hi:[0,1,1]
  v_pk_fma_f32 v[48:49], v[80:81], v[72:73], v[48:49] op_sel_hi:[0,1,1]
  v_pk_fma_f32 v[50:51], v[80:81], v[74:75], v[50:51] op_sel_hi:[0,1,1]
  v_mul_f32 v84, s99, v81
  v_permlane16_swap_b32 v52, v54
  v_permlane16_swap_b32 v53, v55
  v_pk_mul_f32 v[44:45], v[44:45], v[84:85] op_sel_hi:[1,0]
  v_pk_mul_f32 v[46:47], v[46:47], v[84:85] op_sel_hi:[1,0]
  v_pk_mul_f32 v[52:53], v[52:53], v[84:85] op_sel_hi:[1,0]
  v_exp_f32 v44, v44
  v_exp_f32 v45, v45
  v_exp_f32 v46, v46
  v_exp_f32 v47, v47
  v_exp_f32 v52, v52
  v_exp_f32 v53, v53
  v_pk_mul_f32 v[48:49], v[48:49], v[80:81] op_sel:[0,1] op_sel_hi:[1,1]
  v_pk_mul_f32 v[50:51], v[50:51], v[80:81] op_sel:[0,1] op_sel_hi:[1,1]
  v_pk_mul_f32 v[54:55], v[54:55], v[80:81] op_sel:[0,1] op_sel_hi:[1,1]
  v_pk_add_f32 v[44:45], v[44:45], s[38:39]
  v_pk_add_f32 v[46:47], v[46:47], s[38:39]
  v_pk_add_f32 v[52:53], v[52:53], s[38:39]
  v_rcp_f32 v44, v44
  v_rcp_f32 v45, v45
  v_rcp_f32 v46, v46
  v_rcp_f32 v47, v47
  v_rcp_f32 v52, v52
  v_rcp_f32 v53, v53
  v_pk_mul_f32 v[48:49], v[48:49], v[44:45]
  v_pk_mul_f32 v[50:51], v[50:51], v[46:47]
  v_pk_mul_f32 v[54:55], v[54:55], v[52:53]
  v_cvt_pk_bf16_f32 v44, v48, v49
  v_cvt_pk_bf16_f32 v45, v50, v51
  v_cvt_pk_bf16_f32 v138, v54, v55
  s_waitcnt lgkmcnt(0)
  v_pk_fma_f32 v[64:65], v[82:83], v[76:77], v[64:65] op_sel_hi:[0,1,1]
  v_pk_fma_f32 v[66:67], v[82:83], v[78:79], v[66:67] op_sel_hi:[0,1,1]
  v_pk_fma_f32 v[56:57], v[82:83], v[68:69], v[56:57] op_sel_hi:[0,1,1]
  v_pk_fma_f32 v[58:59], v[82:83], v[70:71], v[58:59] op_sel_hi:[0,1,1]
  v_pk_fma_f32 v[60:61], v[82:83], v[72:73], v[60:61] op_sel_hi:[0,1,1]
  v_pk_fma_f32 v[62:63], v[82:83], v[74:75], v[62:63] op_sel_hi:[0,1,1]
  v_mul_f32 v84, s99, v83
  v_permlane16_swap_b32 v64, v66
  v_permlane16_swap_b32 v65, v67
  v_pk_mul_f32 v[56:57], v[56:57], v[84:85] op_sel_hi:[1,0]
  v_pk_mul_f32 v[58:59], v[58:59], v[84:85] op_sel_hi:[1,0]
  v_pk_mul_f32 v[64:65], v[64:65], v[84:85] op_sel_hi:[1,0]
  v_exp_f32 v56, v56
  v_exp_f32 v57, v57
  v_exp_f32 v58, v58
  v_exp_f32 v59, v59
  v_exp_f32 v64, v64
  v_exp_f32 v65, v65
  v_pk_mul_f32 v[60:61], v[60:61], v[82:83] op_sel:[0,1] op_sel_hi:[1,1]
  v_pk_mul_f32 v[62:63], v[62:63], v[82:83] op_sel:[0,1] op_sel_hi:[1,1]
  v_pk_mul_f32 v[66:67], v[66:67], v[82:83] op_sel:[0,1] op_sel_hi:[1,1]
  v_pk_add_f32 v[56:57], v[56:57], s[38:39]
  v_pk_add_f32 v[58:59], v[58:59], s[38:39]
  v_pk_add_f32 v[64:65], v[64:65], s[38:39]
  v_rcp_f32 v56, v56
  v_rcp_f32 v57, v57
  v_rcp_f32 v58, v58
  v_rcp_f32 v59, v59
  v_rcp_f32 v64, v64
  v_rcp_f32 v65, v65
  v_pk_mul_f32 v[60:61], v[60:61], v[56:57]
  v_pk_mul_f32 v[62:63], v[62:63], v[58:59]
  v_pk_mul_f32 v[66:67], v[66:67], v[64:65]
  v_cvt_pk_bf16_f32 v46, v60, v61
  v_cvt_pk_bf16_f32 v47, v62, v63
  v_cvt_pk_bf16_f32 v139, v66, v67
  s_add_u32 s58, s48, 29360128
  v_permlane16_swap_b32 v20, v22
  v_permlane16_swap_b32 v21, v23
  buffer_store_dwordx4 v[20:23], v5, s[8:11], s58 offen sc1
  v_permlane16_swap_b32 v44, v46
  v_permlane16_swap_b32 v45, v47
  s_add_u32 s59, s58, 98304
  buffer_store_dwordx4 v[44:47], v5, s[8:11], s59 offen sc1
  v_permlane16_swap_b32 v136, v137
  v_permlane16_swap_b32 v138, v139
  s_nop 1
  v_permlane32_swap_b32 v136, v138
  v_permlane32_swap_b32 v137, v139
  buffer_store_dwordx4 v[136:139], v6, s[8:11], s58 offen sc1
  s_waitcnt vmcnt(11)
  s_barrier
  ds_read_b128 v[68:71], v3 offset:0
  ds_read_b128 v[72:75], v3 offset:16384
  ds_read_b128 v[76:79], v3 offset:32768
  ds_read_b128 v[80:83], v3 offset:49152
  ds_read_b128 v[84:87], v3 offset:1024
  s_waitcnt lgkmcnt(4)
  v_mfma_f32_16x16x32_bf16 v[20:23], a[0:3], v[68:71], 0
  s_add_u32 m0, s27, 73728
  s_add_u32 s32, s67, 15736832
  v_mfma_f32_16x16x32_bf16 v[24:27], a[4:7], v[68:71], 0
  buffer_load_dwordx4 v2, s[8:11], s32 offen sc1 lds
  v_mfma_f32_16x16x32_bf16 v[28:31], a[8:11], v[68:71], 0
  ds_read_b128 v[68:71], v3 offset:17408
  s_waitcnt lgkmcnt(4)
  v_mfma_f32_16x16x32_bf16 v[32:35], a[0:3], v[72:75], 0
  v_mfma_f32_16x16x32_bf16 v[36:39], a[4:7], v[72:75], 0
  s_add_u32 m0, s27, 90112
  s_add_u32 s32, s67, 15753216
  v_mfma_f32_16x16x32_bf16 v[40:43], a[8:11], v[72:75], 0
  ds_read_b128 v[72:75], v3 offset:33792
  s_waitcnt lgkmcnt(4)
  v_mfma_f32_16x16x32_bf16 v[44:47], a[0:3], v[76:79], 0
  buffer_load_dwordx4 v2, s[8:11], s32 offen sc1 lds
  v_mfma_f32_16x16x32_bf16 v[48:51], a[4:7], v[76:79], 0
  v_add_u32 v96, 8192, v11
  s_waitcnt vmcnt(11)
  v_mfma_f32_16x16x32_bf16 v[52:55], a[8:11], v[76:79], 0
  ds_read_b128 v[76:79], v3 offset:50176
  s_waitcnt lgkmcnt(4)
  v_mfma_f32_16x16x32_bf16 v[56:59], a[0:3], v[80:83], 0
  s_add_u32 m0, s27, 106496
  s_add_u32 s32, s67, 15769600
  v_mfma_f32_16x16x32_bf16 v[60:63], a[4:7], v[80:83], 0
  buffer_load_dwordx4 v2, s[8:11], s32 offen sc1 lds
  v_mfma_f32_16x16x32_bf16 v[64:67], a[8:11], v[80:83], 0
  ds_read_b128 v[80:83], v3 offset:2048
  s_waitcnt lgkmcnt(4)
  v_mfma_f32_16x16x32_bf16 v[20:23], a[12:15], v[84:87], v[20:23]
  ds_read2_b32 v[88:89], v96 offset0:0 offset1:32
  ds_read2_b32 v[90:91], v96 offset0:64 offset1:96
  v_mfma_f32_16x16x32_bf16 v[24:27], a[16:19], v[84:87], v[24:27]
  s_add_u32 m0, s27, 122880
  s_add_u32 s32, s67, 15785984
  v_mfma_f32_16x16x32_bf16 v[28:31], a[20:23], v[84:87], v[28:31]
  ds_read_b128 v[84:87], v3 offset:18432
  s_waitcnt lgkmcnt(6)
  v_mfma_f32_16x16x32_bf16 v[32:35], a[12:15], v[68:71], v[32:35]
  buffer_load_dwordx4 v2, s[8:11], s32 offen sc1 lds
  v_mfma_f32_16x16x32_bf16 v[36:39], a[16:19], v[68:71], v[36:39]
  ds_read2_b32 v[92:93], v96 offset0:128 offset1:160
  ds_read2_b32 v[94:95], v96 offset0:192 offset1:224
  v_mfma_f32_16x16x32_bf16 v[40:43], a[20:23], v[68:71], v[40:43]
  ds_read_b128 v[68:71], v3 offset:34816
  s_waitcnt lgkmcnt(8)
  v_mfma_f32_16x16x32_bf16 v[44:47], a[12:15], v[72:75], v[44:47]
  s_add_u32 m0, s27, 77824
  s_add_u32 s32, s67, 15740928
  v_mfma_f32_16x16x32_bf16 v[48:51], a[16:19], v[72:75], v[48:51]
  buffer_load_dwordx4 v2, s[8:11], s32 offen sc1 lds
  v_mfma_f32_16x16x32_bf16 v[52:55], a[20:23], v[72:75], v[52:55]
  ds_read_b128 v[72:75], v3 offset:51200
  s_waitcnt lgkmcnt(8)
  v_mfma_f32_16x16x32_bf16 v[56:59], a[12:15], v[76:79], v[56:59]
  v_mfma_f32_16x16x32_bf16 v[60:63], a[16:19], v[76:79], v[60:63]
  s_add_u32 m0, s27, 94208
  s_add_u32 s32, s67, 15757312
  v_mfma_f32_16x16x32_bf16 v[64:67], a[20:23], v[76:79], v[64:67]
  ds_read_b128 v[76:79], v3 offset:3072
  s_waitcnt lgkmcnt(8)
  v_mfma_f32_16x16x32_bf16 v[20:23], a[24:27], v[80:83], v[20:23]
  buffer_load_dwordx4 v2, s[8:11], s32 offen sc1 lds
  v_mfma_f32_16x16x32_bf16 v[24:27], a[28:31], v[80:83], v[24:27]
  v_mfma_f32_16x16x32_bf16 v[28:31], a[32:35], v[80:83], v[28:31]
  ds_read_b128 v[80:83], v3 offset:19456
  s_waitcnt lgkmcnt(6)
  v_mfma_f32_16x16x32_bf16 v[32:35], a[24:27], v[84:87], v[32:35]
  s_add_u32 m0, s27, 110592
  s_add_u32 s32, s67, 15773696
  v_mfma_f32_16x16x32_bf16 v[36:39], a[28:31], v[84:87], v[36:39]
  buffer_load_dwordx4 v2, s[8:11], s32 offen sc1 lds
  v_mfma_f32_16x16x32_bf16 v[40:43], a[32:35], v[84:87], v[40:43]
  ds_read_b128 v[84:87], v3 offset:35840
  s_waitcnt lgkmcnt(4)
  v_mfma_f32_16x16x32_bf16 v[44:47], a[24:27], v[68:71], v[44:47]
  v_add_f32 v88, v88, v89
  v_add_f32 v90, v90, v91
  v_mfma_f32_16x16x32_bf16 v[48:51], a[28:31], v[68:71], v[48:51]
  s_add_u32 m0, s27, 126976
  s_add_u32 s32, s67, 15790080
  v_mfma_f32_16x16x32_bf16 v[52:55], a[32:35], v[68:71], v[52:55]
  ds_read_b128 v[68:71], v3 offset:52224
  s_waitcnt lgkmcnt(4)
  v_mfma_f32_16x16x32_bf16 v[56:59], a[24:27], v[72:75], v[56:59]
  buffer_load_dwordx4 v2, s[8:11], s32 offen sc1 lds
  v_mfma_f32_16x16x32_bf16 v[60:63], a[28:31], v[72:75], v[60:63]
  v_add_f32 v92, v92, v93
  v_add_f32 v94, v94, v95
  v_mfma_f32_16x16x32_bf16 v[64:67], a[32:35], v[72:75], v[64:67]
  s_waitcnt vmcnt(13)
  s_barrier
  ds_read_b128 v[72:75], v3 offset:4096
  s_waitcnt lgkmcnt(4)
  v_mfma_f32_16x16x32_bf16 v[20:23], a[36:39], v[76:79], v[20:23]
  v_add_f32 v88, v88, v90
  v_add_f32 v92, v92, v94
  v_mfma_f32_16x16x32_bf16 v[24:27], a[40:43], v[76:79], v[24:27]
  v_add_f32 v88, v88, v92
  v_mov_b32 v89, v88
  v_mfma_f32_16x16x32_bf16 v[28:31], a[44:47], v[76:79], v[28:31]
  ds_read_b128 v[76:79], v3 offset:20480
  s_waitcnt lgkmcnt(4)
  v_mfma_f32_16x16x32_bf16 v[32:35], a[36:39], v[80:83], v[32:35]
  v_permlane32_swap_b32 v88, v89
  v_mfma_f32_16x16x32_bf16 v[36:39], a[40:43], v[80:83], v[36:39]
  v_add_f32 v88, v88, v89
  v_mov_b32 v89, v88
  v_mfma_f32_16x16x32_bf16 v[40:43], a[44:47], v[80:83], v[40:43]
  ds_read_b128 v[80:83], v3 offset:36864
  s_waitcnt lgkmcnt(4)
  v_mfma_f32_16x16x32_bf16 v[44:47], a[36:39], v[84:87], v[44:47]
  v_permlane16_swap_b32 v88, v89
  v_mfma_f32_16x16x32_bf16 v[48:51], a[40:43], v[84:87], v[48:51]
  v_mul_f32 v88, 0xbb000000, v88
  v_mul_f32 v90, v88, v88
  v_mfma_f32_16x16x32_bf16 v[52:55], a[44:47], v[84:87], v[52:55]
  ds_read_b128 v[84:87], v3 offset:53248
  s_waitcnt lgkmcnt(4)
  v_mfma_f32_16x16x32_bf16 v[56:59], a[36:39], v[68:71], v[56:59]
  v_fma_f32 v89, v89, s96, -v90
  v_max_f32 v89, 0, v89
  v_mfma_f32_16x16x32_bf16 v[60:63], a[40:43], v[68:71], v[60:63]
  v_add_f32 v89, s97, v89
  v_mfma_f32_16x16x32_bf16 v[64:67], a[44:47], v[68:71], v[64:67]
  ds_read_b128 v[68:71], v3 offset:5120
  s_waitcnt lgkmcnt(4)
  v_mfma_f32_16x16x32_bf16 v[20:23], a[48:51], v[72:75], v[20:23]
  v_rsq_f32 v89, v89
  v_mfma_f32_16x16x32_bf16 v[24:27], a[52:55], v[72:75], v[24:27]
  v_cndmask_b32 v88, v88, v89, s[36:37]
  ds_write_b32 v12, v88 offset:1024
  v_mfma_f32_16x16x32_bf16 v[28:31], a[56:59], v[72:75], v[28:31]
  ds_read_b128 v[72:75], v3 offset:21504
  s_waitcnt lgkmcnt(5)
  v_mfma_f32_16x16x32_bf16 v[32:35], a[48:51], v[76:79], v[32:35]
  v_mfma_f32_16x16x32_bf16 v[36:39], a[52:55], v[76:79], v[36:39]
  v_mfma_f32_16x16x32_bf16 v[40:43], a[56:59], v[76:79], v[40:43]
  ds_read_b128 v[76:79], v3 offset:37888
  s_waitcnt lgkmcnt(5)
  v_mfma_f32_16x16x32_bf16 v[44:47], a[48:51], v[80:83], v[44:47]
  v_mfma_f32_16x16x32_bf16 v[48:51], a[52:55], v[80:83], v[48:51]
  v_mfma_f32_16x16x32_bf16 v[52:55], a[56:59], v[80:83], v[52:55]
  ds_read_b128 v[80:83], v3 offset:54272
  s_waitcnt lgkmcnt(5)
  v_mfma_f32_16x16x32_bf16 v[56:59], a[48:51], v[84:87], v[56:59]
  v_mfma_f32_16x16x32_bf16 v[60:63], a[52:55], v[84:87], v[60:63]
  v_mfma_f32_16x16x32_bf16 v[64:67], a[56:59], v[84:87], v[64:67]
  ds_read_b128 v[84:87], v3 offset:6144
  s_waitcnt lgkmcnt(5)
  v_mfma_f32_16x16x32_bf16 v[20:23], a[60:63], v[68:71], v[20:23]
  v_mfma_f32_16x16x32_bf16 v[24:27], a[64:67], v[68:71], v[24:27]
  v_mfma_f32_16x16x32_bf16 v[28:31], a[68:71], v[68:71], v[28:31]
  ds_read_b128 v[68:71], v3 offset:22528
  s_waitcnt lgkmcnt(4)
  v_mfma_f32_16x16x32_bf16 v[32:35], a[60:63], v[72:75], v[32:35]
  v_mfma_f32_16x16x32_bf16 v[36:39], a[64:67], v[72:75], v[36:39]
  s_waitcnt vmcnt(8)
  s_barrier
  s_add_u32 s34, s51, 8355840
  v_mfma_f32_16x16x32_bf16 v[40:43], a[68:71], v[72:75], v[40:43]
  ds_read_b128 v[72:75], v3 offset:38912
  s_waitcnt lgkmcnt(4)
  v_mfma_f32_16x16x32_bf16 v[44:47], a[60:63], v[76:79], v[44:47]
  s_cmp_eq_u32 s7, 1
  s_cbranch_scc1 IMP_10
  buffer_store_dword v18, v1, s[8:11], s34 offen
IMPB_10:
  v_mfma_f32_16x16x32_bf16 v[48:51], a[64:67], v[76:79], v[48:51]
  v_mfma_f32_16x16x32_bf16 v[52:55], a[68:71], v[76:79], v[52:55]
  ds_read_b128 v[76:79], v3 offset:55296
  s_waitcnt lgkmcnt(4)
  v_mfma_f32_16x16x32_bf16 v[56:59], a[60:63], v[80:83], v[56:59]
  v_mfma_f32_16x16x32_bf16 v[60:63], a[64:67], v[80:83], v[60:63]
  v_mfma_f32_16x16x32_bf16 v[64:67], a[68:71], v[80:83], v[64:67]
  ds_read_b128 v[80:83], v3 offset:7168
  s_waitcnt lgkmcnt(4)
  v_mfma_f32_16x16x32_bf16 v[20:23], a[72:75], v[84:87], v[20:23]
  v_mfma_f32_16x16x32_bf16 v[24:27], a[76:79], v[84:87], v[24:27]
  v_mfma_f32_16x16x32_bf16 v[28:31], a[80:83], v[84:87], v[28:31]
  ds_read_b128 v[84:87], v3 offset:23552
  s_waitcnt lgkmcnt(4)
  v_mfma_f32_16x16x32_bf16 v[32:35], a[72:75], v[68:71], v[32:35]
  v_mfma_f32_16x16x32_bf16 v[36:39], a[76:79], v[68:71], v[36:39]
  v_mfma_f32_16x16x32_bf16 v[40:43], a[80:83], v[68:71], v[40:43]
  ds_read_b128 v[68:71], v3 offset:39936
  s_waitcnt lgkmcnt(4)
  v_mfma_f32_16x16x32_bf16 v[44:47], a[72:75], v[72:75], v[44:47]
  v_mfma_f32_16x16x32_bf16 v[48:51], a[76:79], v[72:75], v[48:51]
  v_mfma_f32_16x16x32_bf16 v[52:55], a[80:83], v[72:75], v[52:55]
  ds_read_b128 v[72:75], v3 offset:56320
  s_waitcnt lgkmcnt(4)
  v_mfma_f32_16x16x32_bf16 v[56:59], a[72:75], v[76:79], v[56:59]
  v_mfma_f32_16x16x32_bf16 v[60:63], a[76:79], v[76:79], v[60:63]
  v_mfma_f32_16x16x32_bf16 v[64:67], a[80:83], v[76:79], v[64:67]
  s_waitcnt vmcnt(5)
  s_barrier
  ds_read_b128 v[76:79], v3 offset:8192
  s_waitcnt lgkmcnt(4)
  v_mfma_f32_16x16x32_bf16 v[20:23], a[84:87], v[80:83], v[20:23]
  v_mfma_f32_16x16x32_bf16 v[24:27], a[88:91], v[80:83], v[24:27]
  v_mfma_f32_16x16x32_bf16 v[28:31], a[92:95], v[80:83], v[28:31]
  ds_read_b128 v[80:83], v3 offset:24576
  s_waitcnt lgkmcnt(4)
  v_mfma_f32_16x16x32_bf16 v[32:35], a[84:87], v[84:87], v[32:35]
  v_mfma_f32_16x16x32_bf16 v[36:39], a[88:91], v[84:87], v[36:39]
  v_mfma_f32_16x16x32_bf16 v[40:43], a[92:95], v[84:87], v[40:43]
  ds_read_b128 v[84:87], v3 offset:40960
  s_waitcnt lgkmcnt(4)
  v_mfma_f32_16x16x32_bf16 v[44:47], a[84:87], v[68:71], v[44:47]
  v_mfma_f32_16x16x32_bf16 v[48:51], a[88:91], v[68:71], v[48:51]
  v_mfma_f32_16x16x32_bf16 v[52:55], a[92:95], v[68:71], v[52:55]
  ds_read_b128 v[68:71], v3 offset:57344
  s_waitcnt lgkmcnt(4)
  v_mfma_f32_16x16x32_bf16 v[56:59], a[84:87], v[72:75], v[56:59]
  v_mfma_f32_16x16x32_bf16 v[60:63], a[88:91], v[72:75], v[60:63]
  v_mfma_f32_16x16x32_bf16 v[64:67], a[92:95], v[72:75], v[64:67]
  ds_read_b128 v[72:75], v3 offset:9216
  s_waitcnt lgkmcnt(4)
  v_mfma_f32_16x16x32_bf16 v[20:23], a[96:99], v[76:79], v[20:23]
  v_mfma_f32_16x16x32_bf16 v[24:27], a[100:103], v[76:79], v[24:27]
  v_mfma_f32_16x16x32_bf16 v[28:31], a[104:107], v[76:79], v[28:31]
  ds_read_b128 v[76:79], v3 offset:25600
  s_waitcnt lgkmcnt(4)
  v_mfma_f32_16x16x32_bf16 v[32:35], a[96:99], v[80:83], v[32:35]
  v_mfma_f32_16x16x32_bf16 v[36:39], a[100:103], v[80:83], v[36:39]
  v_mfma_f32_16x16x32_bf16 v[40:43], a[104:107], v[80:83], v[40:43]
  ds_read_b128 v[80:83], v3 offset:41984
  s_waitcnt lgkmcnt(4)
  v_mfma_f32_16x16x32_bf16 v[44:47], a[96:99], v[84:87], v[44:47]
  v_mfma_f32_16x16x32_bf16 v[48:51], a[100:103], v[84:87], v[48:51]
  v_mfma_f32_16x16x32_bf16 v[52:55], a[104:107], v[84:87], v[52:55]
  ds_read_b128 v[84:87], v3 offset:58368
  s_waitcnt lgkmcnt(4)
  v_mfma_f32_16x16x32_bf16 v[56:59], a[96:99], v[68:71], v[56:59]
  v_mfma_f32_16x16x32_bf16 v[60:63], a[100:103], v[68:71], v[60:63]
  v_mfma_f32_16x16x32_bf16 v[64:67], a[104:107], v[68:71], v[64:67]
  ds_read_b128 v[68:71], v3 offset:10240
  s_waitcnt lgkmcnt(4)
  v_mfma_f32_16x16x32_bf16 v[20:23], a[108:111], v[72:75], v[20:23]
  v_mfma_f32_16x16x32_bf16 v[24:27], a[112:115], v[72:75], v[24:27]
  v_mfma_f32_16x16x32_bf16 v[28:31], a[116:119], v[72:75], v[28:31]
  ds_read_b128 v[72:75], v3 offset:26624
  s_waitcnt lgkmcnt(4)
  v_mfma_f32_16x16x32_bf16 v[32:35], a[108:111], v[76:79], v[32:35]
  v_mfma_f32_16x16x32_bf16 v[36:39], a[112:115], v[76:79], v[36:39]
  v_mfma_f32_16x16x32_bf16 v[40:43], a[116:119], v[76:79], v[40:43]
  ds_read_b128 v[76:79], v3 offset:43008
  s_waitcnt lgkmcnt(4)
  v_mfma_f32_16x16x32_bf16 v[44:47], a[108:111], v[80:83], v[44:47]
  v_mfma_f32_16x16x32_bf16 v[48:51], a[112:115], v[80:83], v[48:51]
  v_mfma_f32_16x16x32_bf16 v[52:55], a[116:119], v[80:83], v[52:55]
  ds_read_b128 v[80:83], v3 offset:59392
  s_waitcnt lgkmcnt(4)
  v_mfma_f32_16x16x32_bf16 v[56:59], a[108:111], v[84:87], v[56:59]
  v_mfma_f32_16x16x32_bf16 v[60:63], a[112:115], v[84:87], v[60:63]
  v_mfma_f32_16x16x32_bf16 v[64:67], a[116:119], v[84:87], v[64:67]
  ds_read_b128 v[84:87], v3 offset:11264
  s_waitcnt lgkmcnt(4)
  v_mfma_f32_16x16x32_bf16 v[20:23], a[120:123], v[68:71], v[20:23]
  s_add_u32 s35, s54, 8355840
  v_mfma_f32_16x16x32_bf16 v[24:27], a[124:127], v[68:71], v[24:27]
  buffer_load_dword v19, v9, s[8:11], s35 offen sc1
  v_mfma_f32_16x16x32_bf16 v[28:31], a[128:131], v[68:71], v[28:31]
  ds_read_b128 v[68:71], v3 offset:27648
  s_waitcnt lgkmcnt(4)
  v_mfma_f32_16x16x32_bf16 v[32:35], a[120:123], v[72:75], v[32:35]
  v_mfma_f32_16x16x32_bf16 v[36:39], a[124:127], v[72:75], v[36:39]
  v_mfma_f32_16x16x32_bf16 v[40:43], a[128:131], v[72:75], v[40:43]
  ds_read_b128 v[72:75], v3 offset:44032
  s_waitcnt lgkmcnt(4)
  v_mfma_f32_16x16x32_bf16 v[44:47], a[120:123], v[76:79], v[44:47]
  v_mfma_f32_16x16x32_bf16 v[48:51], a[124:127], v[76:79], v[48:51]
  v_mfma_f32_16x16x32_bf16 v[52:55], a[128:131], v[76:79], v[52:55]
  ds_read_b128 v[76:79], v3 offset:60416
  s_waitcnt lgkmcnt(4)
  v_mfma_f32_16x16x32_bf16 v[56:59], a[120:123], v[80:83], v[56:59]
  v_mfma_f32_16x16x32_bf16 v[60:63], a[124:127], v[80:83], v[60:63]
  v_mfma_f32_16x16x32_bf16 v[64:67], a[128:131], v[80:83], v[64:67]
  s_waitcnt vmcnt(2)
  s_barrier
  ds_read_b128 v[80:83], v3 offset:12288
  s_waitcnt lgkmcnt(4)
  v_mfma_f32_16x16x32_bf16 v[20:23], a[132:135], v[84:87], v[20:23]
  v_mfma_f32_16x16x32_bf16 v[24:27], a[136:139], v[84:87], v[24:27]
  v_mfma_f32_16x16x32_bf16 v[28:31], a[140:143], v[84:87], v[28:31]
  ds_read_b128 v[84:87], v3 offset:28672
  s_waitcnt lgkmcnt(4)
  v_mfma_f32_16x16x32_bf16 v[32:35], a[132:135], v[68:71], v[32:35]
  v_mfma_f32_16x16x32_bf16 v[36:39], a[136:139], v[68:71], v[36:39]
  v_mfma_f32_16x16x32_bf16 v[40:43], a[140:143], v[68:71], v[40:43]
  ds_read_b128 v[68:71], v3 offset:45056
  s_waitcnt lgkmcnt(4)
  v_mfma_f32_16x16x32_bf16 v[44:47], a[132:135], v[72:75], v[44:47]
  v_mfma_f32_16x16x32_bf16 v[48:51], a[136:139], v[72:75], v[48:51]
  v_mfma_f32_16x16x32_bf16 v[52:55], a[140:143], v[72:75], v[52:55]
  ds_read_b128 v[72:75], v3 offset:61440
  s_waitcnt lgkmcnt(4)
  v_mfma_f32_16x16x32_bf16 v[56:59], a[132:135], v[76:79], v[56:59]
  v_mfma_f32_16x16x32_bf16 v[60:63], a[136:139], v[76:79], v[60:63]
  v_mfma_f32_16x16x32_bf16 v[64:67], a[140:143], v[76:79], v[64:67]
  ds_read_b128 v[76:79], v3 offset:13312
  s_waitcnt lgkmcnt(4)
  v_mfma_f32_16x16x32_bf16 v[20:23], a[144:147], v[80:83], v[20:23]
  v_mfma_f32_16x16x32_bf16 v[24:27], a[148:151], v[80:83], v[24:27]
  v_mfma_f32_16x16x32_bf16 v[28:31], a[152:155], v[80:83], v[28:31]
  ds_read_b128 v[80:83], v3 offset:29696
  s_waitcnt lgkmcnt(4)
  v_mfma_f32_16x16x32_bf16 v[32:35], a[144:147], v[84:87], v[32:35]
  v_mfma_f32_16x16x32_bf16 v[36:39], a[148:151], v[84:87], v[36:39]
  v_mfma_f32_16x16x32_bf16 v[40:43], a[152:155], v[84:87], v[40:43]
  ds_read_b128 v[84:87], v3 offset:46080
  s_waitcnt lgkmcnt(4)
  v_mfma_f32_16x16x32_bf16 v[44:47], a[144:147], v[68:71], v[44:47]
  v_mfma_f32_16x16x32_bf16 v[48:51], a[148:151], v[68:71], v[48:51]
  v_mfma_f32_16x16x32_bf16 v[52:55], a[152:155], v[68:71], v[52:55]
  ds_read_b128 v[68:71], v3 offset:62464
  s_waitcnt lgkmcnt(4)
  v_mfma_f32_16x16x32_bf16 v[56:59], a[144:147], v[72:75], v[56:59]
  v_mfma_f32_16x16x32_bf16 v[60:63], a[148:151], v[72:75], v[60:63]
  v_mfma_f32_16x16x32_bf16 v[64:67], a[152:155], v[72:75], v[64:67]
  ds_read_b128 v[72:75], v3 offset:14336
  s_waitcnt lgkmcnt(4)
  v_mfma_f32_16x16x32_bf16 v[20:23], a[156:159], v[76:79], v[20:23]
  v_mfma_f32_16x16x32_bf16 v[24:27], a[160:163], v[76:79], v[24:27]
  v_mfma_f32_16x16x32_bf16 v[28:31], a[164:167], v[76:79], v[28:31]
  ds_read_b128 v[76:79], v3 offset:30720
  s_waitcnt lgkmcnt(4)
  v_mfma_f32_16x16x32_bf16 v[32:35], a[156:159], v[80:83], v[32:35]
  v_mfma_f32_16x16x32_bf16 v[36:39], a[160:163], v[80:83], v[36:39]
  s_waitcnt vmcnt(0)
  v_cmp_ne_u32 vcc, s61, v19
  s_nop 0
  s_and_b64 vcc, vcc, s[30:31]
  v_mfma_f32_16x16x32_bf16 v[40:43], a[164:167], v[80:83], v[40:43]
  ds_read_b128 v[80:83], v3 offset:47104
  s_waitcnt lgkmcnt(4)
  v_mfma_f32_16x16x32_bf16 v[44:47], a[156:159], v[84:87], v[44:47]
  s_cbranch_vccnz SLOW_15
BACK_15:
  s_barrier
  s_add_u32 s32, s65, 29360128
  v_mfma_f32_16x16x32_bf16 v[48:51], a[160:163], v[84:87], v[48:51]
  buffer_load_dwordx4 v[88:91], v2, s[8:11], s32 offen offset:0 sc1
  v_mfma_f32_16x16x32_bf16 v[52:55], a[164:167], v[84:87], v[52:55]
  ds_read_b128 v[84:87], v3 offset:63488
  s_waitcnt lgkmcnt(4)
  v_mfma_f32_16x16x32_bf16 v[56:59], a[156:159], v[68:71], v[56:59]
  v_mfma_f32_16x16x32_bf16 v[60:63], a[160:163], v[68:71], v[60:63]
  s_add_u32 s32, s65, 29360128
  v_mfma_f32_16x16x32_bf16 v[64:67], a[164:167], v[68:71], v[64:67]
  ds_read_b128 v[68:71], v3 offset:15360
  s_waitcnt lgkmcnt(4)
  v_mfma_f32_16x16x32_bf16 v[20:23], a[168:171], v[72:75], v[20:23]
  buffer_load_dwordx4 v[92:95], v2, s[8:11], s32 offen offset:1024 sc1
  v_mfma_f32_16x16x32_bf16 v[24:27], a[172:175], v[72:75], v[24:27]
  v_mfma_f32_16x16x32_bf16 v[28:31], a[176:179], v[72:75], v[28:31]
  ds_read_b128 v[72:75], v3 offset:31744
  s_waitcnt lgkmcnt(4)
  v_mfma_f32_16x16x32_bf16 v[32:35], a[168:171], v[76:79], v[32:35]
  s_add_u32 s32, s65, 29360128
  v_mfma_f32_16x16x32_bf16 v[36:39], a[172:175], v[76:79], v[36:39]
  buffer_load_dwordx4 v[96:99], v2, s[8:11], s32 offen offset:2048 sc1
  v_mfma_f32_16x16x32_bf16 v[40:43], a[176:179], v[76:79], v[40:43]
  ds_read_b128 v[76:79], v3 offset:48128
  s_waitcnt lgkmcnt(4)
  v_mfma_f32_16x16x32_bf16 v[44:47], a[168:171], v[80:83], v[44:47]
  v_mfma_f32_16x16x32_bf16 v[48:51], a[172:175], v[80:83], v[48:51]
  s_add_u32 s32, s65, 29360128
  v_mfma_f32_16x16x32_bf16 v[52:55], a[176:179], v[80:83], v[52:55]
  ds_read_b128 v[80:83], v3 offset:64512
  s_barrier
  s_waitcnt lgkmcnt(4)
  v_mfma_f32_16x16x32_bf16 v[56:59], a[168:171], v[84:87], v[56:59]
  buffer_load_dwordx4 v[100:103], v2, s[8:11], s32 offen offset:3072 sc1
  v_mfma_f32_16x16x32_bf16 v[60:63], a[172:175], v[84:87], v[60:63]
  v_mfma_f32_16x16x32_bf16 v[64:67], a[176:179], v[84:87], v[64:67]
  s_waitcnt lgkmcnt(3)
  v_mfma_f32_16x16x32_bf16 v[20:23], a[180:183], v[68:71], v[20:23]
  s_add_u32 s32, s47, 14680064
  v_mfma_f32_16x16x32_bf16 v[24:27], a[184:187], v[68:71], v[24:27]
  buffer_load_dwordx4 v[140:143], v2, s[8:11], s32 offen sc1
  v_mfma_f32_16x16x32_bf16 v[28:31], a[188:191], v[68:71], v[28:31]
  ds_read_b128 v[68:71], v15 offset:768
  s_waitcnt lgkmcnt(3)
  v_mfma_f32_16x16x32_bf16 v[32:35], a[180:183], v[72:75], v[32:35]
  v_mfma_f32_16x16x32_bf16 v[36:39], a[184:187], v[72:75], v[36:39]
  s_add_u32 s32, s65, 29364224
  v_mfma_f32_16x16x32_bf16 v[40:43], a[188:191], v[72:75], v[40:43]
  ds_read_b128 v[72:75], v15 offset:832
  s_waitcnt lgkmcnt(3)
  v_mfma_f32_16x16x32_bf16 v[44:47], a[180:183], v[76:79], v[44:47]
  buffer_load_dwordx4 v[104:107], v2, s[8:11], s32 offen offset:0 sc1
  v_mfma_f32_16x16x32_bf16 v[48:51], a[184:187], v[76:79], v[48:51]
  v_mfma_f32_16x16x32_bf16 v[52:55], a[188:191], v[76:79], v[52:55]
  ds_read_b128 v[76:79], v15 offset:896
  s_waitcnt lgkmcnt(3)
  v_mfma_f32_16x16x32_bf16 v[56:59], a[180:183], v[80:83], v[56:59]
  s_add_u32 s32, s65, 29364224
  v_mfma_f32_16x16x32_bf16 v[60:63], a[184:187], v[80:83], v[60:63]
  buffer_load_dwordx4 v[108:111], v2, s[8:11], s32 offen offset:1024 sc1
  v_mfma_f32_16x16x32_bf16 v[64:67], a[188:191], v[80:83], v[64:67]
  ds_read_b64 v[80:81], v13 offset:1024
  s_barrier
  s_add_u32 s32, s65, 29364224
  buffer_load_dwordx4 v[112:115], v2, s[8:11], s32 offen offset:2048 sc1
  s_add_u32 s32, s65, 29364224
  buffer_load_dwordx4 v[116:119], v2, s[8:11], s32 offen offset:3072 sc1
  s_add_u32 s32, s65, 29368320
  buffer_load_dwordx4 v[120:123], v2, s[8:11], s32 offen offset:0 sc1
  s_add_u32 s32, s65, 29368320
  buffer_load_dwordx4 v[124:127], v2, s[8:11], s32 offen offset:1024 sc1
  s_add_u32 s32, s65, 29368320
  buffer_load_dwordx4 v[128:131], v2, s[8:11], s32 offen offset:2048 sc1
  s_add_u32 s32, s64, 29360128
  buffer_load_dwordx4 v[132:135], v2, s[8:11], s32 offen offset:0 sc1
  ds_read_b64 v[82:83], v13 offset:1152
  s_waitcnt lgkmcnt(1)
  v_pk_fma_f32 v[28:29], v[80:81], v[76:77], v[28:29] op_sel_hi:[0,1,1]
  v_pk_fma_f32 v[30:31], v[80:81], v[78:79], v[30:31] op_sel_hi:[0,1,1]
  v_pk_fma_f32 v[20:21], v[80:81], v[68:69], v[20:21] op_sel_hi:[0,1,1]
  v_pk_fma_f32 v[22:23], v[80:81], v[70:71], v[22:23] op_sel_hi:[0,1,1]
  v_pk_fma_f32 v[24:25], v[80:81], v[72:73], v[24:25] op_sel_hi:[0,1,1]
  v_pk_fma_f32 v[26:27], v[80:81], v[74:75], v[26:27] op_sel_hi:[0,1,1]
  v_mul_f32 v84, s99, v81
  v_permlane16_swap_b32 v28, v30
  v_permlane16_swap_b32 v29, v31
  v_pk_mul_f32 v[20:21], v[20:21], v[84:85] op_sel_hi:[1,0]
  v_pk_mul_f32 v[22:23], v[22:23], v[84:85] op_sel_hi:[1,0]
  v_pk_mul_f32 v[28:29], v[28:29], v[84:85] op_sel_hi:[1,0]
  v_exp_f32 v20, v20
  v_exp_f32 v21, v21
  v_exp_f32 v22, v22
  v_exp_f32 v23, v23
  v_exp_f32 v28, v28
  v_exp_f32 v29, v29
  v_pk_mul_f32 v[24:25], v[24:25], v[80:81] op_sel:[0,1] op_sel_hi:[1,1]
  v_pk_mul_f32 v[26:27], v[26:27], v[80:81] op_sel:[0,1] op_sel_hi:[1,1]
  v_pk_mul_f32 v[30:31], v[30:31], v[80:81] op_sel:[0,1] op_sel_hi:[1,1]
  v_pk_add_f32 v[20:21], v[20:21], s[38:39]
  v_pk_add_f32 v[22:23], v[22:23], s[38:39]
  v_pk_add_f32 v[28:29], v[28:29], s[38:39]
  v_rcp_f32 v20, v20
  v_rcp_f32 v21, v21
  v_rcp_f32 v22, v22
  v_rcp_f32 v23, v23
  v_rcp_f32 v28, v28
  v_rcp_f32 v29, v29
  v_pk_mul_f32 v[24:25], v[24:25], v[20:21]
  v_pk_mul_f32 v[26:27], v[26:27], v[22:23]
  v_pk_mul_f32 v[30:31], v[30:31], v[28:29]
  v_cvt_pk_bf16_f32 v20, v24, v25
  v_cvt_pk_bf16_f32 v21, v26, v27
  v_cvt_pk_bf16_f32 v136, v30, v31
  ds_read_b64 v[80:81], v13 offset:1280
  s_waitcnt lgkmcnt(1)
  v_pk_fma_f32 v[40:41], v[82:83], v[76:77], v[40:41] op_sel_hi:[0,1,1]
  v_pk_fma_f32 v[42:43], v[82:83], v[78:79], v[42:43] op_sel_hi:[0,1,1]
  v_pk_fma_f32 v[32:33], v[82:83], v[68:69], v[32:33] op_sel_hi:[0,1,1]
  v_pk_fma_f32 v[34:35], v[82:83], v[70:71], v[34:35] op_sel_hi:[0,1,1]
  v_pk_fma_f32 v[36:37], v[82:83], v[72:73], v[36:37] op_sel_hi:[0,1,1]
  v_pk_fma_f32 v[38:39], v[82:83], v[74:75], v[38:39] op_sel_hi:[0,1,1]
  v_mul_f32 v84, s99, v83
  v_permlane16_swap_b32 v40, v42
  v_permlane16_swap_b32 v41, v43
  v_pk_mul_f32 v[32:33], v[32:33], v[84:85] op_sel_hi:[1,0]
  v_pk_mul_f32 v[34:35], v[34:35], v[84:85] op_sel_hi:[1,0]
  v_pk_mul_f32 v[40:41], v[40:41], v[84:85] op_sel_hi:[1,0]
  v_exp_f32 v32, v32
  v_exp_f32 v33, v33
  v_exp_f32 v34, v34
  v_exp_f32 v35, v35
  v_exp_f32 v40, v40
  v_exp_f32 v41, v41
  v_pk_mul_f32 v[36:37], v[36:37], v[82:83] op_sel:[0,1] op_sel_hi:[1,1]
  v_pk_mul_f32 v[38:39], v[38:39], v[82:83] op_sel:[0,1] op_sel_hi:[1,1]
  v_pk_mul_f32 v[42:43], v[42:43], v[82:83] op_sel:[0,1] op_sel_hi:[1,1]
  v_pk_add_f32 v[32:33], v[32:33], s[38:39]
  v_pk_add_f32 v[34:35], v[34:35], s[38:39]
  v_pk_add_f32 v[40:41], v[40:41], s[38:39]
  v_rcp_f32 v32, v32
  v_rcp_f32 v33, v33
  v_rcp_f32 v34, v34
  v_rcp_f32 v35, v35
  v_rcp_f32 v40, v40
  v_rcp_f32 v41, v41
  v_pk_mul_f32 v[36:37], v[36:37], v[32:33]
  v_pk_mul_f32 v[38:39], v[38:39], v[34:35]
  v_pk_mul_f32 v[42:43], v[42:43], v[40:41]
  v_cvt_pk_bf16_f32 v22, v36, v37
  v_cvt_pk_bf16_f32 v23, v38, v39
  v_cvt_pk_bf16_f32 v137, v42, v43
  ds_read_b64 v[82:83], v13 offset:1408
  s_waitcnt lgkmcnt(1)
  v_pk_fma_f32 v[52:53], v[80:81], v[76:77], v[52:53] op_sel_hi:[0,1,1]
  v_pk_fma_f32 v[54:55], v[80:81], v[78:79], v[54:55] op_sel_hi:[0,1,1]
  v_pk_fma_f32 v[44:45], v[80:81], v[68:69], v[44:45] op_sel_hi:[0,1,1]
  v_pk_fma_f32 v[46:47], v[80:81], v[70:71], v[46:47] op_sel_hi:[0,1,1]
  v_pk_fma_f32 v[48:49], v[80:81], v[72:73], v[48:49] op_sel_hi:[0,1,1]
  v_pk_fma_f32 v[50:51], v[80:81], v[74:75], v[50:51] op_sel_hi:[0,1,1]
  v_mul_f32 v84, s99, v81
  v_permlane16_swap_b32 v52, v54
  v_permlane16_swap_b32 v53, v55
  v_pk_mul_f32 v[44:45], v[44:45], v[84:85] op_sel_hi:[1,0]
  v_pk_mul_f32 v[46:47], v[46:47], v[84:85] op_sel_hi:[1,0]
  v_pk_mul_f32 v[52:53], v[52:53], v[84:85] op_sel_hi:[1,0]
  v_exp_f32 v44, v44
  v_exp_f32 v45, v45
  v_exp_f32 v46, v46
  v_exp_f32 v47, v47
  v_exp_f32 v52, v52
  v_exp_f32 v53, v53
  v_pk_mul_f32 v[48:49], v[48:49], v[80:81] op_sel:[0,1] op_sel_hi:[1,1]
  v_pk_mul_f32 v[50:51], v[50:51], v[80:81] op_sel:[0,1] op_sel_hi:[1,1]
  v_pk_mul_f32 v[54:55], v[54:55], v[80:81] op_sel:[0,1] op_sel_hi:[1,1]
  v_pk_add_f32 v[44:45], v[44:45], s[38:39]
  v_pk_add_f32 v[46:47], v[46:47], s[38:39]
  v_pk_add_f32 v[52:53], v[52:53], s[38:39]
  v_rcp_f32 v44, v44
  v_rcp_f32 v45, v45
  v_rcp_f32 v46, v46
  v_rcp_f32 v47, v47
  v_rcp_f32 v52, v52
  v_rcp_f32 v53, v53
  v_pk_mul_f32 v[48:49], v[48:49], v[44:45]
  v_pk_mul_f32 v[50:51], v[50:51], v[46:47]
  v_pk_mul_f32 v[54:55], v[54:55], v[52:53]
  v_cvt_pk_bf16_f32 v44, v48, v49
  v_cvt_pk_bf16_f32 v45, v50, v51
  v_cvt_pk_bf16_f32 v138, v54, v55
  s_waitcnt lgkmcnt(0)
  v_pk_fma_f32 v[64:65], v[82:83], v[76:77], v[64:65] op_sel_hi:[0,1,1]
  v_pk_fma_f32 v[66:67], v[82:83], v[78:79], v[66:67] op_sel_hi:[0,1,1]
  v_pk_fma_f32 v[56:57], v[82:83], v[68:69], v[56:57] op_sel_hi:[0,1,1]
  v_pk_fma_f32 v[58:59], v[82:83], v[70:71], v[58:59] op_sel_hi:[0,1,1]
  v_pk_fma_f32 v[60:61], v[82:83], v[72:73], v[60:61] op_sel_hi:[0,1,1]
  v_pk_fma_f32 v[62:63], v[82:83], v[74:75], v[62:63] op_sel_hi:[0,1,1]
  v_mul_f32 v84, s99, v83
  v_permlane16_swap_b32 v64, v66
  v_permlane16_swap_b32 v65, v67
  v_pk_mul_f32 v[56:57], v[56:57], v[84:85] op_sel_hi:[1,0]
  v_pk_mul_f32 v[58:59], v[58:59], v[84:85] op_sel_hi:[1,0]
  v_pk_mul_f32 v[64:65], v[64:65], v[84:85] op_sel_hi:[1,0]
  v_exp_f32 v56, v56
  v_exp_f32 v57, v57
  v_exp_f32 v58, v58
  v_exp_f32 v59, v59
  v_exp_f32 v64, v64
  v_exp_f32 v65, v65
  v_pk_mul_f32 v[60:61], v[60:61], v[82:83] op_sel:[0,1] op_sel_hi:[1,1]
  v_pk_mul_f32 v[62:63], v[62:63], v[82:83] op_sel:[0,1] op_sel_hi:[1,1]
  v_pk_mul_f32 v[66:67], v[66:67], v[82:83] op_sel:[0,1] op_sel_hi:[1,1]
  v_pk_add_f32 v[56:57], v[56:57], s[38:39]
  v_pk_add_f32 v[58:59], v[58:59], s[38:39]
  v_pk_add_f32 v[64:65], v[64:65], s[38:39]
  v_rcp_f32 v56, v56
  v_rcp_f32 v57, v57
  v_rcp_f32 v58, v58
  v_rcp_f32 v59, v59
  v_rcp_f32 v64, v64
  v_rcp_f32 v65, v65
  v_pk_mul_f32 v[60:61], v[60:61], v[56:57]
  v_pk_mul_f32 v[62:63], v[62:63], v[58:59]
  v_pk_mul_f32 v[66:67], v[66:67], v[64:65]
  v_cvt_pk_bf16_f32 v46, v60, v61
  v_cvt_pk_bf16_f32 v47, v62, v63
  v_cvt_pk_bf16_f32 v139, v66, v67
  s_add_u32 s58, s48, 32505856
  v_permlane16_swap_b32 v20, v22
  v_permlane16_swap_b32 v21, v23
  buffer_store_dwordx4 v[20:23], v5, s[8:11], s58 offen sc1
  v_permlane16_swap_b32 v44, v46
  v_permlane16_swap_b32 v45, v47
  s_add_u32 s59, s58, 98304
  buffer_store_dwordx4 v[44:47], v5, s[8:11], s59 offen sc1
  v_permlane16_swap_b32 v136, v137
  v_permlane16_swap_b32 v138, v139
  s_nop 1
  v_permlane32_swap_b32 v136, v138
  v_permlane32_swap_b32 v137, v139
  buffer_store_dwordx4 v[136:139], v6, s[8:11], s58 offen sc1
  s_waitcnt vmcnt(15)
  v_mfma_f32_16x16x32_bf16 v[36:39], a[192:195], v[88:91], 0
  v_mfma_f32_16x16x32_bf16 v[40:43], a[196:199], v[88:91], 0
  v_mfma_f32_16x16x32_bf16 v[44:47], a[200:203], v[88:91], 0
  s_add_u32 s3, s64, 29360128
  v_mfma_f32_16x16x32_bf16 v[48:51], a[204:207], v[88:91], 0
  buffer_load_dwordx4 v[88:91], v2, s[8:11], s3 offen offset:1024 sc1
  s_waitcnt vmcnt(15)
  v_mfma_f32_16x16x32_bf16 v[36:39], a[208:211], v[92:95], v[36:39]
  v_mfma_f32_16x16x32_bf16 v[40:43], a[212:215], v[92:95], v[40:43]
  v_mfma_f32_16x16x32_bf16 v[44:47], a[216:219], v[92:95], v[44:47]
  s_add_u32 s3, s64, 29360128
  v_mfma_f32_16x16x32_bf16 v[48:51], a[220:223], v[92:95], v[48:51]
  buffer_load_dwordx4 v[92:95], v2, s[8:11], s3 offen offset:2048 sc1
  s_waitcnt vmcnt(15)
  v_mfma_f32_16x16x32_bf16 v[36:39], a[224:227], v[96:99], v[36:39]
  v_mfma_f32_16x16x32_bf16 v[40:43], a[228:231], v[96:99], v[40:43]
  v_mfma_f32_16x16x32_bf16 v[44:47], a[232:235], v[96:99], v[44:47]
  s_add_u32 s3, s64, 29360128
  v_mfma_f32_16x16x32_bf16 v[48:51], a[236:239], v[96:99], v[48:51]
  buffer_load_dwordx4 v[96:99], v2, s[8:11], s3 offen offset:3072 sc1
  s_waitcnt vmcnt(15)
  v_mfma_f32_16x16x32_bf16 v[36:39], a[240:243], v[100:103], v[36:39]
  v_mfma_f32_16x16x32_bf16 v[40:43], a[244:247], v[100:103], v[40:43]
  v_mfma_f32_16x16x32_bf16 v[44:47], a[248:251], v[100:103], v[44:47]
  s_add_u32 s3, s64, 29364224
  v_mfma_f32_16x16x32_bf16 v[48:51], a[252:255], v[100:103], v[48:51]
  buffer_load_dwordx4 v[100:103], v2, s[8:11], s3 offen offset:0 sc1
  s_waitcnt vmcnt(14)
  v_mfma_f32_16x16x32_bf16 v[36:39], v[144:147], v[104:107], v[36:39]
  v_mfma_f32_16x16x32_bf16 v[40:43], v[148:151], v[104:107], v[40:43]
  v_mfma_f32_16x16x32_bf16 v[44:47], v[152:155], v[104:107], v[44:47]
  s_add_u32 s3, s64, 29364224
  v_mfma_f32_16x16x32_bf16 v[48:51], v[156:159], v[104:107], v[48:51]
  buffer_load_dwordx4 v[104:107], v2, s[8:11], s3 offen offset:1024 sc1
  s_waitcnt vmcnt(14)
  v_mfma_f32_16x16x32_bf16 v[36:39], v[160:163], v[108:111], v[36:39]
  v_mfma_f32_16x16x32_bf16 v[40:43], v[164:167], v[108:111], v[40:43]
  v_mfma_f32_16x16x32_bf16 v[44:47], v[168:171], v[108:111], v[44:47]
  s_add_u32 s3, s64, 29364224
  v_mfma_f32_16x16x32_bf16 v[48:51], v[172:175], v[108:111], v[48:51]
  buffer_load_dwordx4 v[108:111], v2, s[8:11], s3 offen offset:2048 sc1
  s_waitcnt vmcnt(14)
  v_mfma_f32_16x16x32_bf16 v[36:39], v[176:179], v[112:115], v[36:39]
  v_mfma_f32_16x16x32_bf16 v[40:43], v[180:183], v[112:115], v[40:43]
  v_mfma_f32_16x16x32_bf16 v[44:47], v[184:187], v[112:115], v[44:47]
  s_add_u32 s3, s64, 29364224
  v_mfma_f32_16x16x32_bf16 v[48:51], v[188:191], v[112:115], v[48:51]
  buffer_load_dwordx4 v[112:115], v2, s[8:11], s3 offen offset:3072 sc1
  s_waitcnt vmcnt(14)
  v_mfma_f32_16x16x32_bf16 v[36:39], v[192:195], v[116:119], v[36:39]
  v_mfma_f32_16x16x32_bf16 v[40:43], v[196:199], v[116:119], v[40:43]
  v_mfma_f32_16x16x32_bf16 v[44:47], v[200:203], v[116:119], v[44:47]
  s_add_u32 s3, s64, 29368320
  v_mfma_f32_16x16x32_bf16 v[48:51], v[204:207], v[116:119], v[48:51]
  buffer_load_dwordx4 v[116:119], v2, s[8:11], s3 offen offset:0 sc1
  s_waitcnt vmcnt(14)
  v_mfma_f32_16x16x32_bf16 v[36:39], v[208:211], v[120:123], v[36:39]
  v_mfma_f32_16x16x32_bf16 v[40:43], v[212:215], v[120:123], v[40:43]
  v_mfma_f32_16x16x32_bf16 v[44:47], v[216:219], v[120:123], v[44:47]
  s_add_u32 s3, s64, 29368320
  v_mfma_f32_16x16x32_bf16 v[48:51], v[220:223], v[120:123], v[48:51]
  buffer_load_dwordx4 v[120:123], v2, s[8:11], s3 offen offset:1024 sc1
  s_waitcnt vmcnt(14)
  v_mfma_f32_16x16x32_bf16 v[36:39], v[224:227], v[124:127], v[36:39]
  v_mfma_f32_16x16x32_bf16 v[40:43], v[228:231], v[124:127], v[40:43]
  v_mfma_f32_16x16x32_bf16 v[44:47], v[232:235], v[124:127], v[44:47]
  s_add_u32 s3, s64, 29368320
  v_mfma_f32_16x16x32_bf16 v[48:51], v[236:239], v[124:127], v[48:51]
  buffer_load_dwordx4 v[124:127], v2, s[8:11], s3 offen offset:2048 sc1
  s_waitcnt vmcnt(14)
  v_mfma_f32_16x16x32_bf16 v[36:39], v[240:243], v[128:131], v[36:39]
  v_mfma_f32_16x16x32_bf16 v[40:43], v[244:247], v[128:131], v[40:43]
  v_mfma_f32_16x16x32_bf16 v[44:47], v[248:251], v[128:131], v[44:47]
  v_mfma_f32_16x16x32_bf16 v[48:51], v[252:255], v[128:131], v[48:51]
  s_waitcnt vmcnt(13)
  v_mfma_f32_16x16x32_bf16 v[20:23], a[192:195], v[132:135], 0
  v_mfma_f32_16x16x32_bf16 v[24:27], a[196:199], v[132:135], 0
  v_mfma_f32_16x16x32_bf16 v[28:31], a[200:203], v[132:135], 0
  v_mfma_f32_16x16x32_bf16 v[32:35], a[204:207], v[132:135], 0
  s_waitcnt vmcnt(9)
  v_mfma_f32_16x16x32_bf16 v[20:23], a[208:211], v[88:91], v[20:23]
  v_mfma_f32_16x16x32_bf16 v[24:27], a[212:215], v[88:91], v[24:27]
  v_mfma_f32_16x16x32_bf16 v[28:31], a[216:219], v[88:91], v[28:31]
  v_mfma_f32_16x16x32_bf16 v[32:35], a[220:223], v[88:91], v[32:35]
  s_waitcnt vmcnt(8)
  v_mfma_f32_16x16x32_bf16 v[20:23], a[224:227], v[92:95], v[20:23]
  v_mfma_f32_16x16x32_bf16 v[24:27], a[228:231], v[92:95], v[24:27]
  v_xor_b32 v137, 16384, v7
  v_xor_b32 v138, 24576, v7
  v_mfma_f32_16x16x32_bf16 v[28:31], a[232:235], v[92:95], v[28:31]
  ds_write_b128 v137, v[36:39] offset:4096
  ds_write_b128 v137, v[40:43] offset:5120
  v_mfma_f32_16x16x32_bf16 v[32:35], a[236:239], v[92:95], v[32:35]
  ds_write_b128 v138, v[44:47] offset:6144
  ds_write_b128 v138, v[48:51] offset:7168
  s_waitcnt vmcnt(7)
  v_mfma_f32_16x16x32_bf16 v[20:23], a[240:243], v[96:99], v[20:23]
  v_mfma_f32_16x16x32_bf16 v[24:27], a[244:247], v[96:99], v[24:27]
  v_mfma_f32_16x16x32_bf16 v[28:31], a[248:251], v[96:99], v[28:31]
  v_mfma_f32_16x16x32_bf16 v[32:35], a[252:255], v[96:99], v[32:35]
  s_waitcnt vmcnt(6)
  v_mfma_f32_16x16x32_bf16 v[20:23], v[144:147], v[100:103], v[20:23]
  s_barrier
  s_add_u32 s34, s51, 8364032
  v_mfma_f32_16x16x32_bf16 v[24:27], v[148:151], v[100:103], v[24:27]
  s_cmp_eq_u32 s7, 1
  s_cbranch_scc1 IMP_11
  buffer_store_dword v18, v1, s[8:11], s34 offen
IMPB_11:
  v_mfma_f32_16x16x32_bf16 v[28:31], v[152:155], v[100:103], v[28:31]
  v_mfma_f32_16x16x32_bf16 v[32:35], v[156:159], v[100:103], v[32:35]
  s_waitcnt vmcnt(6)
  v_mfma_f32_16x16x32_bf16 v[28:31], v[168:171], v[104:107], v[28:31]
  v_mfma_f32_16x16x32_bf16 v[32:35], v[172:175], v[104:107], v[32:35]
  s_waitcnt vmcnt(5)
  v_mfma_f32_16x16x32_bf16 v[28:31], v[184:187], v[108:111], v[28:31]
  v_mfma_f32_16x16x32_bf16 v[32:35], v[188:191], v[108:111], v[32:35]
  s_waitcnt vmcnt(4)
  v_mfma_f32_16x16x32_bf16 v[28:31], v[200:203], v[112:115], v[28:31]
  v_mfma_f32_16x16x32_bf16 v[32:35], v[204:207], v[112:115], v[32:35]
  s_waitcnt vmcnt(3)
  v_mfma_f32_16x16x32_bf16 v[28:31], v[216:219], v[116:119], v[28:31]
  v_mfma_f32_16x16x32_bf16 v[32:35], v[220:223], v[116:119], v[32:35]
  s_waitcnt vmcnt(2)
  v_mfma_f32_16x16x32_bf16 v[28:31], v[232:235], v[120:123], v[28:31]
  v_mfma_f32_16x16x32_bf16 v[32:35], v[236:239], v[120:123], v[32:35]
  s_waitcnt vmcnt(1)
  v_mfma_f32_16x16x32_bf16 v[28:31], v[248:251], v[124:127], v[28:31]
  v_mfma_f32_16x16x32_bf16 v[32:35], v[252:255], v[124:127], v[32:35]
  v_mfma_f32_16x16x32_bf16 v[20:23], v[160:163], v[104:107], v[20:23]
  v_mfma_f32_16x16x32_bf16 v[24:27], v[164:167], v[104:107], v[24:27]
  v_mfma_f32_16x16x32_bf16 v[20:23], v[176:179], v[108:111], v[20:23]
  v_mfma_f32_16x16x32_bf16 v[24:27], v[180:183], v[108:111], v[24:27]
  v_mfma_f32_16x16x32_bf16 v[20:23], v[192:195], v[112:115], v[20:23]
  v_mfma_f32_16x16x32_bf16 v[24:27], v[196:199], v[112:115], v[24:27]
  v_mfma_f32_16x16x32_bf16 v[20:23], v[208:211], v[116:119], v[20:23]
  v_mfma_f32_16x16x32_bf16 v[24:27], v[212:215], v[116:119], v[24:27]
  v_mfma_f32_16x16x32_bf16 v[20:23], v[224:227], v[120:123], v[20:23]
  v_mfma_f32_16x16x32_bf16 v[24:27], v[228:231], v[120:123], v[24:27]
  v_xor_b32 v136, 8192, v7
  ds_write_b128 v136, v[28:31] offset:2048
  v_mfma_f32_16x16x32_bf16 v[20:23], v[240:243], v[124:127], v[20:23]
  ds_write_b128 v136, v[32:35] offset:3072
  v_mfma_f32_16x16x32_bf16 v[24:27], v[244:247], v[124:127], v[24:27]
  s_add_u32 s35, s54, 8364032
  buffer_load_dword v19, v9, s[8:11], s35 offen sc1
  s_waitcnt lgkmcnt(0)
  s_barrier
  ds_read_b128 v[28:31], v7 offset:2048
  ds_read_b128 v[32:35], v7 offset:3072
  ds_read_b128 v[36:39], v7 offset:4096
  ds_read_b128 v[40:43], v7 offset:5120
  ds_read_b128 v[44:47], v7 offset:6144
  ds_read_b128 v[48:51], v7 offset:7168
  v_lshlrev_b32 v52, 16, v140
  v_and_b32 v53, 0xffff0000, v140
  v_lshlrev_b32 v54, 16, v141
  v_and_b32 v55, 0xffff0000, v141
  v_lshlrev_b32 v56, 16, v142
  v_and_b32 v57, 0xffff0000, v142
  v_lshlrev_b32 v58, 16, v143
  v_and_b32 v59, 0xffff0000, v143
  v_pk_add_f32 v[20:21], v[20:21], v[52:53]
  v_pk_add_f32 v[22:23], v[22:23], v[54:55]
  v_pk_add_f32 v[24:25], v[24:25], v[56:57]
  v_pk_add_f32 v[26:27], v[26:27], v[58:59]
  s_waitcnt lgkmcnt(5)
  v_pk_add_f32 v[20:21], v[20:21], v[28:29]
  v_pk_add_f32 v[22:23], v[22:23], v[30:31]
  s_waitcnt lgkmcnt(4)
  v_pk_add_f32 v[24:25], v[24:25], v[32:33]
  v_pk_add_f32 v[26:27], v[26:27], v[34:35]
  s_waitcnt lgkmcnt(3)
  v_pk_add_f32 v[20:21], v[20:21], v[36:37]
  v_pk_add_f32 v[22:23], v[22:23], v[38:39]
  s_waitcnt lgkmcnt(2)
  v_pk_add_f32 v[24:25], v[24:25], v[40:41]
  v_pk_add_f32 v[26:27], v[26:27], v[42:43]
  s_waitcnt lgkmcnt(1)
  v_pk_add_f32 v[20:21], v[20:21], v[44:45]
  v_pk_add_f32 v[22:23], v[22:23], v[46:47]
  s_waitcnt lgkmcnt(0)
  v_pk_add_f32 v[24:25], v[24:25], v[48:49]
  v_pk_add_f32 v[26:27], v[26:27], v[50:51]
  v_cvt_pk_bf16_f32 v60, v20, v21
  v_cvt_pk_bf16_f32 v61, v22, v23
  v_cvt_pk_bf16_f32 v62, v24, v25
  v_cvt_pk_bf16_f32 v63, v26, v27
  s_add_u32 s58, s56, 0
  v_and_b32 v52, 0xf0, v2
  v_lshlrev_b32 v52, 7, v52
  v_lshrrev_b32 v53, 8, v2
  v_lshl_add_u32 v52, v53, 4, v52
  buffer_store_dwordx4 v[60:63], v52, s[12:15], s58 offen sc1
  s_waitcnt vmcnt(1)
  v_cmp_ne_u32 vcc, s61, v19
  s_nop 0
  s_and_b64 vcc, vcc, s[30:31]
  s_cbranch_vccnz SLOW_16
BACK_16:
  s_barrier
  s_add_u32 s32, s65, 32505856
  buffer_load_dwordx4 v[88:91], v2, s[8:11], s32 offen offset:0 sc1
  s_add_u32 s32, s65, 32505856
  buffer_load_dwordx4 v[92:95], v2, s[8:11], s32 offen offset:1024 sc1
  s_add_u32 s32, s65, 32505856
  buffer_load_dwordx4 v[96:99], v2, s[8:11], s32 offen offset:2048 sc1
  s_add_u32 s32, s65, 32505856
  buffer_load_dwordx4 v[100:103], v2, s[8:11], s32 offen offset:3072 sc1
  s_add_u32 s32, s47, 15728640
  buffer_load_dwordx4 v[140:143], v2, s[8:11], s32 offen sc1
  s_add_u32 s32, s65, 32509952
  buffer_load_dwordx4 v[104:107], v2, s[8:11], s32 offen offset:0 sc1
  s_add_u32 s32, s65, 32509952
  buffer_load_dwordx4 v[108:111], v2, s[8:11], s32 offen offset:1024 sc1
  s_add_u32 s32, s65, 32509952
  buffer_load_dwordx4 v[112:115], v2, s[8:11], s32 offen offset:2048 sc1
  s_add_u32 s32, s65, 32509952
  buffer_load_dwordx4 v[116:119], v2, s[8:11], s32 offen offset:3072 sc1
  s_add_u32 s32, s65, 32514048
  buffer_load_dwordx4 v[120:123], v2, s[8:11], s32 offen offset:0 sc1
  s_add_u32 s32, s65, 32514048
  buffer_load_dwordx4 v[124:127], v2, s[8:11], s32 offen offset:1024 sc1
  s_add_u32 s32, s65, 32514048
  buffer_load_dwordx4 v[128:131], v2, s[8:11], s32 offen offset:2048 sc1
  s_add_u32 s32, s64, 32505856
  buffer_load_dwordx4 v[132:135], v2, s[8:11], s32 offen offset:0 sc1
  s_waitcnt vmcnt(12)
  v_mfma_f32_16x16x32_bf16 v[36:39], a[192:195], v[88:91], 0
  v_mfma_f32_16x16x32_bf16 v[40:43], a[196:199], v[88:91], 0
  v_mfma_f32_16x16x32_bf16 v[44:47], a[200:203], v[88:91], 0
  s_add_u32 s3, s64, 32505856
  v_mfma_f32_16x16x32_bf16 v[48:51], a[204:207], v[88:91], 0
  buffer_load_dwordx4 v[88:91], v2, s[8:11], s3 offen offset:1024 sc1
  s_waitcnt vmcnt(12)
  v_mfma_f32_16x16x32_bf16 v[36:39], a[208:211], v[92:95], v[36:39]
  v_mfma_f32_16x16x32_bf16 v[40:43], a[212:215], v[92:95], v[40:43]
  v_mfma_f32_16x16x32_bf16 v[44:47], a[216:219], v[92:95], v[44:47]
  s_add_u32 s3, s64, 32505856
  v_mfma_f32_16x16x32_bf16 v[48:51], a[220:223], v[92:95], v[48:51]
  buffer_load_dwordx4 v[92:95], v2, s[8:11], s3 offen offset:2048 sc1
  s_waitcnt vmcnt(12)
  v_mfma_f32_16x16x32_bf16 v[36:39], a[224:227], v[96:99], v[36:39]
  v_mfma_f32_16x16x32_bf16 v[40:43], a[228:231], v[96:99], v[40:43]
  v_mfma_f32_16x16x32_bf16 v[44:47], a[232:235], v[96:99], v[44:47]
  s_add_u32 s3, s64, 32505856
  v_mfma_f32_16x16x32_bf16 v[48:51], a[236:239], v[96:99], v[48:51]
  buffer_load_dwordx4 v[96:99], v2, s[8:11], s3 offen offset:3072 sc1
  s_waitcnt vmcnt(12)
  v_mfma_f32_16x16x32_bf16 v[36:39], a[240:243], v[100:103], v[36:39]
  v_mfma_f32_16x16x32_bf16 v[40:43], a[244:247], v[100:103], v[40:43]
  v_mfma_f32_16x16x32_bf16 v[44:47], a[248:251], v[100:103], v[44:47]
  s_add_u32 s3, s64, 32509952
  v_mfma_f32_16x16x32_bf16 v[48:51], a[252:255], v[100:103], v[48:51]
  buffer_load_dwordx4 v[100:103], v2, s[8:11], s3 offen offset:0 sc1
  s_waitcnt vmcnt(11)
  v_mfma_f32_16x16x32_bf16 v[36:39], v[144:147], v[104:107], v[36:39]
  v_mfma_f32_16x16x32_bf16 v[40:43], v[148:151], v[104:107], v[40:43]
  v_mfma_f32_16x16x32_bf16 v[44:47], v[152:155], v[104:107], v[44:47]
  s_add_u32 s3, s64, 32509952
  v_mfma_f32_16x16x32_bf16 v[48:51], v[156:159], v[104:107], v[48:51]
  buffer_load_dwordx4 v[104:107], v2, s[8:11], s3 offen offset:1024 sc1
  s_waitcnt vmcnt(11)
  v_mfma_f32_16x16x32_bf16 v[36:39], v[160:163], v[108:111], v[36:39]
  v_mfma_f32_16x16x32_bf16 v[40:43], v[164:167], v[108:111], v[40:43]
  v_mfma_f32_16x16x32_bf16 v[44:47], v[168:171], v[108:111], v[44:47]
  s_add_u32 s3, s64, 32509952
  v_mfma_f32_16x16x32_bf16 v[48:51], v[172:175], v[108:111], v[48:51]
  buffer_load_dwordx4 v[108:111], v2, s[8:11], s3 offen offset:2048 sc1
  s_waitcnt vmcnt(11)
  v_mfma_f32_16x16x32_bf16 v[36:39], v[176:179], v[112:115], v[36:39]
  v_mfma_f32_16x16x32_bf16 v[40:43], v[180:183], v[112:115], v[40:43]
  v_mfma_f32_16x16x32_bf16 v[44:47], v[184:187], v[112:115], v[44:47]
  s_add_u32 s3, s64, 32509952
  v_mfma_f32_16x16x32_bf16 v[48:51], v[188:191], v[112:115], v[48:51]
  buffer_load_dwordx4 v[112:115], v2, s[8:11], s3 offen offset:3072 sc1
  s_waitcnt vmcnt(11)
  v_mfma_f32_16x16x32_bf16 v[36:39], v[192:195], v[116:119], v[36:39]
  v_mfma_f32_16x16x32_bf16 v[40:43], v[196:199], v[116:119], v[40:43]
  v_mfma_f32_16x16x32_bf16 v[44:47], v[200:203], v[116:119], v[44:47]
  s_add_u32 s3, s64, 32514048
  v_mfma_f32_16x16x32_bf16 v[48:51], v[204:207], v[116:119], v[48:51]
  buffer_load_dwordx4 v[116:119], v2, s[8:11], s3 offen offset:0 sc1
  s_waitcnt vmcnt(11)
  v_mfma_f32_16x16x32_bf16 v[36:39], v[208:211], v[120:123], v[36:39]
  v_mfma_f32_16x16x32_bf16 v[40:43], v[212:215], v[120:123], v[40:43]
  v_mfma_f32_16x16x32_bf16 v[44:47], v[216:219], v[120:123], v[44:47]
  s_add_u32 s3, s64, 32514048
  v_mfma_f32_16x16x32_bf16 v[48:51], v[220:223], v[120:123], v[48:51]
  buffer_load_dwordx4 v[120:123], v2, s[8:11], s3 offen offset:1024 sc1
  s_waitcnt vmcnt(11)
  v_mfma_f32_16x16x32_bf16 v[36:39], v[224:227], v[124:127], v[36:39]
  v_mfma_f32_16x16x32_bf16 v[40:43], v[228:231], v[124:127], v[40:43]
  v_mfma_f32_16x16x32_bf16 v[44:47], v[232:235], v[124:127], v[44:47]
  s_add_u32 s3, s64, 32514048
  v_mfma_f32_16x16x32_bf16 v[48:51], v[236:239], v[124:127], v[48:51]
  buffer_load_dwordx4 v[124:127], v2, s[8:11], s3 offen offset:2048 sc1
  s_waitcnt vmcnt(11)
  v_mfma_f32_16x16x32_bf16 v[36:39], v[240:243], v[128:131], v[36:39]
  v_mfma_f32_16x16x32_bf16 v[40:43], v[244:247], v[128:131], v[40:43]
  v_mfma_f32_16x16x32_bf16 v[44:47], v[248:251], v[128:131], v[44:47]
  v_mfma_f32_16x16x32_bf16 v[48:51], v[252:255], v[128:131], v[48:51]
  s_waitcnt vmcnt(10)
  v_mfma_f32_16x16x32_bf16 v[20:23], a[192:195], v[132:135], 0
  v_mfma_f32_16x16x32_bf16 v[24:27], a[196:199], v[132:135], 0
  v_mfma_f32_16x16x32_bf16 v[28:31], a[200:203], v[132:135], 0
  v_mfma_f32_16x16x32_bf16 v[32:35], a[204:207], v[132:135], 0
  s_waitcnt vmcnt(9)
  v_mfma_f32_16x16x32_bf16 v[20:23], a[208:211], v[88:91], v[20:23]
  v_mfma_f32_16x16x32_bf16 v[24:27], a[212:215], v[88:91], v[24:27]
  v_mfma_f32_16x16x32_bf16 v[28:31], a[216:219], v[88:91], v[28:31]
  v_mfma_f32_16x16x32_bf16 v[32:35], a[220:223], v[88:91], v[32:35]
  s_waitcnt vmcnt(8)
  v_mfma_f32_16x16x32_bf16 v[20:23], a[224:227], v[92:95], v[20:23]
  v_mfma_f32_16x16x32_bf16 v[24:27], a[228:231], v[92:95], v[24:27]
  v_xor_b32 v137, 16384, v7
  v_xor_b32 v138, 24576, v7
  v_mfma_f32_16x16x32_bf16 v[28:31], a[232:235], v[92:95], v[28:31]
  ds_write_b128 v137, v[36:39] offset:36864
  ds_write_b128 v137, v[40:43] offset:37888
  v_mfma_f32_16x16x32_bf16 v[32:35], a[236:239], v[92:95], v[32:35]
  ds_write_b128 v138, v[44:47] offset:38912
  ds_write_b128 v138, v[48:51] offset:39936
  s_waitcnt vmcnt(7)
  v_mfma_f32_16x16x32_bf16 v[20:23], a[240:243], v[96:99], v[20:23]
  v_mfma_f32_16x16x32_bf16 v[24:27], a[244:247], v[96:99], v[24:27]
  v_mfma_f32_16x16x32_bf16 v[28:31], a[248:251], v[96:99], v[28:31]
  v_mfma_f32_16x16x32_bf16 v[32:35], a[252:255], v[96:99], v[32:35]
  s_waitcnt vmcnt(6)
  v_mfma_f32_16x16x32_bf16 v[20:23], v[144:147], v[100:103], v[20:23]
  v_mfma_f32_16x16x32_bf16 v[24:27], v[148:151], v[100:103], v[24:27]
  v_mfma_f32_16x16x32_bf16 v[28:31], v[152:155], v[100:103], v[28:31]
  v_mfma_f32_16x16x32_bf16 v[32:35], v[156:159], v[100:103], v[32:35]
  s_waitcnt vmcnt(5)
  v_mfma_f32_16x16x32_bf16 v[28:31], v[168:171], v[104:107], v[28:31]
  v_mfma_f32_16x16x32_bf16 v[32:35], v[172:175], v[104:107], v[32:35]
  s_waitcnt vmcnt(4)
  v_mfma_f32_16x16x32_bf16 v[28:31], v[184:187], v[108:111], v[28:31]
  v_mfma_f32_16x16x32_bf16 v[32:35], v[188:191], v[108:111], v[32:35]
  s_waitcnt vmcnt(3)
  v_mfma_f32_16x16x32_bf16 v[28:31], v[200:203], v[112:115], v[28:31]
  v_mfma_f32_16x16x32_bf16 v[32:35], v[204:207], v[112:115], v[32:35]
  s_waitcnt vmcnt(2)
  v_mfma_f32_16x16x32_bf16 v[28:31], v[216:219], v[116:119], v[28:31]
  v_mfma_f32_16x16x32_bf16 v[32:35], v[220:223], v[116:119], v[32:35]
  s_waitcnt vmcnt(1)
  v_mfma_f32_16x16x32_bf16 v[28:31], v[232:235], v[120:123], v[28:31]
  v_mfma_f32_16x16x32_bf16 v[32:35], v[236:239], v[120:123], v[32:35]
  s_waitcnt vmcnt(0)
  v_mfma_f32_16x16x32_bf16 v[28:31], v[248:251], v[124:127], v[28:31]
  v_mfma_f32_16x16x32_bf16 v[32:35], v[252:255], v[124:127], v[32:35]
  v_mfma_f32_16x16x32_bf16 v[20:23], v[160:163], v[104:107], v[20:23]
  v_mfma_f32_16x16x32_bf16 v[24:27], v[164:167], v[104:107], v[24:27]
  v_mfma_f32_16x16x32_bf16 v[20:23], v[176:179], v[108:111], v[20:23]
  v_mfma_f32_16x16x32_bf16 v[24:27], v[180:183], v[108:111], v[24:27]
  v_mfma_f32_16x16x32_bf16 v[20:23], v[192:195], v[112:115], v[20:23]
  v_mfma_f32_16x16x32_bf16 v[24:27], v[196:199], v[112:115], v[24:27]
  v_mfma_f32_16x16x32_bf16 v[20:23], v[208:211], v[116:119], v[20:23]
  v_mfma_f32_16x16x32_bf16 v[24:27], v[212:215], v[116:119], v[24:27]
  v_mfma_f32_16x16x32_bf16 v[20:23], v[224:227], v[120:123], v[20:23]
  v_mfma_f32_16x16x32_bf16 v[24:27], v[228:231], v[120:123], v[24:27]
  v_xor_b32 v136, 8192, v7
  ds_write_b128 v136, v[28:31] offset:34816
  v_mfma_f32_16x16x32_bf16 v[20:23], v[240:243], v[124:127], v[20:23]
  ds_write_b128 v136, v[32:35] offset:35840
  v_mfma_f32_16x16x32_bf16 v[24:27], v[244:247], v[124:127], v[24:27]
  s_waitcnt lgkmcnt(0)
  s_barrier
  ds_read_b128 v[28:31], v7 offset:34816
  ds_read_b128 v[32:35], v7 offset:35840
  ds_read_b128 v[36:39], v7 offset:36864
  ds_read_b128 v[40:43], v7 offset:37888
  ds_read_b128 v[44:47], v7 offset:38912
  ds_read_b128 v[48:51], v7 offset:39936
  v_lshlrev_b32 v52, 16, v140
  v_and_b32 v53, 0xffff0000, v140
  v_lshlrev_b32 v54, 16, v141
  v_and_b32 v55, 0xffff0000, v141
  v_lshlrev_b32 v56, 16, v142
  v_and_b32 v57, 0xffff0000, v142
  v_lshlrev_b32 v58, 16, v143
  v_and_b32 v59, 0xffff0000, v143
  v_pk_add_f32 v[20:21], v[20:21], v[52:53]
  v_pk_add_f32 v[22:23], v[22:23], v[54:55]
  v_pk_add_f32 v[24:25], v[24:25], v[56:57]
  v_pk_add_f32 v[26:27], v[26:27], v[58:59]
  s_waitcnt lgkmcnt(5)
  v_pk_add_f32 v[20:21], v[20:21], v[28:29]
  v_pk_add_f32 v[22:23], v[22:23], v[30:31]
  s_waitcnt lgkmcnt(4)
  v_pk_add_f32 v[24:25], v[24:25], v[32:33]
  v_pk_add_f32 v[26:27], v[26:27], v[34:35]
  s_waitcnt lgkmcnt(3)
  v_pk_add_f32 v[20:21], v[20:21], v[36:37]
  v_pk_add_f32 v[22:23], v[22:23], v[38:39]
  s_waitcnt lgkmcnt(2)
  v_pk_add_f32 v[24:25], v[24:25], v[40:41]
  v_pk_add_f32 v[26:27], v[26:27], v[42:43]
  s_waitcnt lgkmcnt(1)
  v_pk_add_f32 v[20:21], v[20:21], v[44:45]
  v_pk_add_f32 v[22:23], v[22:23], v[46:47]
  s_waitcnt lgkmcnt(0)
  v_pk_add_f32 v[24:25], v[24:25], v[48:49]
  v_pk_add_f32 v[26:27], v[26:27], v[50:51]
  v_cvt_pk_bf16_f32 v60, v20, v21
  v_cvt_pk_bf16_f32 v61, v22, v23
  v_cvt_pk_bf16_f32 v62, v24, v25
  v_cvt_pk_bf16_f32 v63, v26, v27
  s_add_u32 s58, s56, 1024
  v_and_b32 v52, 0xf0, v2
  v_lshlrev_b32 v52, 7, v52
  v_lshrrev_b32 v53, 8, v2
  v_lshl_add_u32 v52, v53, 4, v52
  buffer_store_dwordx4 v[60:63], v52, s[12:15], s58 offen sc1
  s_cmp_eq_u32 s2, 0
  s_cbranch_scc0 M_noep
  s_mov_b32 s36, 8241152
  buffer_store_dword v18, v1, s[8:11], s36 offen
M_noep:
  s_waitcnt vmcnt(0)
M_end:
  s_endpgm
SLOW_0:
  s_mov_b32 s40, 0
SPIN_0:
  buffer_load_dword v92, v89, s[8:11], s35 offen sc1
  s_waitcnt vmcnt(0)
  v_cmp_ne_u32 vcc, s61, v92
  s_nop 1
  s_and_b64 vcc, vcc, s[4:5]
  s_cbranch_vccz BACK_0
  s_add_u32 s40, s40, 1
  s_cmp_lt_u32 s40, 1000000
  s_cbranch_scc1 SPIN_0
  s_branch BACK_0
SLOW_1:
  s_mov_b32 s40, 0
SPIN_1:
  buffer_load_dword v111, v110, s[8:11], s5 offen sc1
  s_waitcnt vmcnt(0)
  v_xor_b32 v111, s58, v111
  v_cmp_le_u32 vcc, 16, v111
  s_nop 1
  s_mov_b32 vcc_hi, 0
  s_cbranch_vccz BACK_1
  s_add_u32 s40, s40, 1
  s_cmp_lt_u32 s40, 1000000
  s_cbranch_scc1 SPIN_1
  s_branch BACK_1
IMP_0:
  buffer_store_dword v18, v1, s[8:11], s34 offen sc1
  s_branch IMPB_0
SLOW_2:
  s_mov_b32 s40, 0
SPIN_2:
  buffer_load_dword v19, v9, s[8:11], s35 offen sc1
  s_waitcnt vmcnt(0)
  v_cmp_ne_u32 vcc, s61, v19
  s_nop 1
  s_and_b64 vcc, vcc, s[28:29]
  s_cbranch_vccz BACK_2
  s_add_u32 s40, s40, 1
  s_cmp_lt_u32 s40, 1000000
  s_cbranch_scc1 SPIN_2
  s_branch BACK_2
SLOW_3:
  s_mov_b32 s40, 0
SPIN_3:
  buffer_load_dword v100, v104, s[8:11], s62 offen sc1
  s_waitcnt vmcnt(0)
  v_cmp_ne_u32 vcc, s61, v100
  s_nop 1
  s_and_b64 vcc, vcc, s[4:5]
  s_cbranch_vccz BACK_3
  s_add_u32 s40, s40, 1
  s_cmp_lt_u32 s40, 1000000
  s_cbranch_scc1 SPIN_3
  s_branch BACK_3
IMP_1:
  buffer_store_dword v18, v1, s[8:11], s34 offen sc1
  s_branch IMPB_1
IMP_2:
  buffer_store_dword v18, v1, s[8:11], s34 offen sc1
  s_branch IMPB_2
SLOW_4:
  s_mov_b32 s40, 0
SPIN_4:
  buffer_load_dword v19, v9, s[8:11], s35 offen sc1
  s_waitcnt vmcnt(0)
  v_cmp_ne_u32 vcc, s61, v19
  s_nop 1
  s_and_b64 vcc, vcc, s[28:29]
  s_cbranch_vccz BACK_4
  s_add_u32 s40, s40, 1
  s_cmp_lt_u32 s40, 1000000
  s_cbranch_scc1 SPIN_4
  s_branch BACK_4
SLOW_5:
  s_mov_b32 s40, 0
SPIN_5:
  buffer_load_dword v139, v8, s[8:11], s62 offen sc1
  s_waitcnt vmcnt(0)
  v_cmp_ne_u32 vcc, s61, v139
  s_nop 1
  s_and_b64 vcc, vcc, s[100:101]
  s_cbranch_vccz BACK_5
  s_add_u32 s40, s40, 1
  s_cmp_lt_u32 s40, 1000000
  s_cbranch_scc1 SPIN_5
  s_branch BACK_5
IMP_3:
  buffer_store_dword v18, v1, s[8:11], s34 offen sc1
  s_branch IMPB_3
SLOW_6:
  s_mov_b32 s40, 0
SPIN_6:
  buffer_load_dword v19, v8, s[8:11], s35 offen sc1
  s_waitcnt vmcnt(0)
  v_cmp_ne_u32 vcc, s61, v19
  s_nop 1
  s_and_b64 vcc, vcc, s[100:101]
  s_cbranch_vccz BACK_6
  s_add_u32 s40, s40, 1
  s_cmp_lt_u32 s40, 1000000
  s_cbranch_scc1 SPIN_6
  s_branch BACK_6
IMP_4:
  buffer_store_dword v18, v1, s[8:11], s34 offen sc1
  s_branch IMPB_4
SLOW_7:
  s_mov_b32 s40, 0
SPIN_7:
  buffer_load_dword v19, v9, s[8:11], s35 offen sc1
  s_waitcnt vmcnt(0)
  v_cmp_ne_u32 vcc, s61, v19
  s_nop 1
  s_and_b64 vcc, vcc, s[30:31]
  s_cbranch_vccz BACK_7
  s_add_u32 s40, s40, 1
  s_cmp_lt_u32 s40, 1000000
  s_cbranch_scc1 SPIN_7
  s_branch BACK_7
IMP_5:
  buffer_store_dword v18, v1, s[8:11], s34 offen sc1
  s_branch IMPB_5
SLOW_8:
  s_mov_b32 s40, 0
SPIN_8:
  buffer_load_dword v19, v9, s[8:11], s35 offen sc1
  s_waitcnt vmcnt(0)
  v_cmp_ne_u32 vcc, s61, v19
  s_nop 1
  s_and_b64 vcc, vcc, s[30:31]
  s_cbranch_vccz BACK_8
  s_add_u32 s40, s40, 1
  s_cmp_lt_u32 s40, 1000000
  s_cbranch_scc1 SPIN_8
  s_branch BACK_8
SLOW_9:
  s_mov_b32 s40, 0
SPIN_9:
  buffer_load_dword v139, v0, s[8:11], s62 offen sc1
  s_waitcnt vmcnt(0)
  v_cmp_ne_u32 vcc, s61, v139
  s_nop 1
  s_and_b64 vcc, vcc, s[100:101]
  s_cbranch_vccz BACK_9
  s_add_u32 s40, s40, 1
  s_cmp_lt_u32 s40, 1000000
  s_cbranch_scc1 SPIN_9
  s_branch BACK_9
SLOW_10:
  s_mov_b32 s40, 0
SPIN_10:
  buffer_load_dword v19, v0, s[8:11], s35 offen sc1
  s_waitcnt vmcnt(0)
  v_cmp_ne_u32 vcc, s61, v19
  s_nop 1
  s_and_b64 vcc, vcc, s[100:101]
  s_cbranch_vccz BACK_10
  s_add_u32 s40, s40, 1
  s_cmp_lt_u32 s40, 1000000
  s_cbranch_scc1 SPIN_10
  s_branch BACK_10
IMP_6:
  buffer_store_dword v18, v1, s[8:11], s34 offen sc1
  s_branch IMPB_6
SLOW_11:
  s_mov_b32 s40, 0
SPIN_11:
  buffer_load_dword v19, v9, s[8:11], s35 offen sc1
  s_waitcnt vmcnt(0)
  v_cmp_ne_u32 vcc, s61, v19
  s_nop 1
  s_and_b64 vcc, vcc, s[28:29]
  s_cbranch_vccz BACK_11
  s_add_u32 s40, s40, 1
  s_cmp_lt_u32 s40, 1000000
  s_cbranch_scc1 SPIN_11
  s_branch BACK_11
IMP_7:
  buffer_store_dword v18, v1, s[8:11], s34 offen sc1
  s_branch IMPB_7
IMP_8:
  buffer_store_dword v18, v1, s[8:11], s34 offen sc1
  s_branch IMPB_8
SLOW_12:
  s_mov_b32 s40, 0
SPIN_12:
  buffer_load_dword v19, v9, s[8:11], s35 offen sc1
  s_waitcnt vmcnt(0)
  v_cmp_ne_u32 vcc, s61, v19
  s_nop 1
  s_and_b64 vcc, vcc, s[28:29]
  s_cbranch_vccz BACK_12
  s_add_u32 s40, s40, 1
  s_cmp_lt_u32 s40, 1000000
  s_cbranch_scc1 SPIN_12
  s_branch BACK_12
SLOW_13:
  s_mov_b32 s40, 0
SPIN_13:
  buffer_load_dword v139, v8, s[8:11], s62 offen sc1
  s_waitcnt vmcnt(0)
  v_cmp_ne_u32 vcc, s61, v139
  s_nop 1
  s_and_b64 vcc, vcc, s[100:101]
  s_cbranch_vccz BACK_13
  s_add_u32 s40, s40, 1
  s_cmp_lt_u32 s40, 1000000
  s_cbranch_scc1 SPIN_13
  s_branch BACK_13
IMP_9:
  buffer_store_dword v18, v1, s[8:11], s34 offen sc1
  s_branch IMPB_9
SLOW_14:
  s_mov_b32 s40, 0
SPIN_14:
  buffer_load_dword v19, v8, s[8:11], s35 offen sc1
  s_waitcnt vmcnt(0)
  v_cmp_ne_u32 vcc, s61, v19
  s_nop 1
  s_and_b64 vcc, vcc, s[100:101]
  s_cbranch_vccz BACK_14
  s_add_u32 s40, s40, 1
  s_cmp_lt_u32 s40, 1000000
  s_cbranch_scc1 SPIN_14
  s_branch BACK_14
IMP_10:
  buffer_store_dword v18, v1, s[8:11], s34 offen sc1
  s_branch IMPB_10
SLOW_15:
  s_mov_b32 s40, 0
SPIN_15:
  buffer_load_dword v19, v9, s[8:11], s35 offen sc1
  s_waitcnt vmcnt(0)
  v_cmp_ne_u32 vcc, s61, v19
  s_nop 1
  s_and_b64 vcc, vcc, s[30:31]
  s_cbranch_vccz BACK_15
  s_add_u32 s40, s40, 1
  s_cmp_lt_u32 s40, 1000000
  s_cbranch_scc1 SPIN_15
  s_branch BACK_15
IMP_11:
  buffer_store_dword v18, v1, s[8:11], s34 offen sc1
  s_branch IMPB_11
SLOW_16:
  s_mov_b32 s40, 0
SPIN_16:
  buffer_load_dword v19, v9, s[8:11], s35 offen sc1
  s_waitcnt vmcnt(0)
  v_cmp_ne_u32 vcc, s61, v19
  s_nop 1
  s_and_b64 vcc, vcc, s[30:31]
  s_cbranch_vccz BACK_16
  s_add_u32 s40, s40, 1
  s_cmp_lt_u32 s40, 1000000
  s_cbranch_scc1 SPIN_16
  s_branch BACK_16
M_last:
  s_endpgm
.section .rodata,"a"
.p2align 6

.amdhsa_kernel interleave_layers__sliding_local_dilated__glu_gated_glu__prompt_kernel
  .amdhsa_next_free_vgpr 512
  .amdhsa_next_free_sgpr 102
  .amdhsa_accum_offset 256
  .amdhsa_group_segment_fixed_size 0
  .amdhsa_kernarg_size 80
  .amdhsa_user_sgpr_count 2
  .amdhsa_user_sgpr_kernarg_segment_ptr 1
  .amdhsa_system_sgpr_workgroup_id_x 1
.end_amdhsa_kernel
```
